```python
import torch

def _softmax(x, axis=-1):
    return torch.softmax(x, dim=axis)
def _gelu(x):
    return torch.nn.functional.gelu(x, approximate="tanh")
def _silu(x):
    return torch.nn.functional.silu(x)
def _sigmoid(x):
    return torch.sigmoid(x)
def _layernorm(x, axis=-1, eps=1e-5):
    m = x.mean(dim=axis, keepdim=True)
    v = x.var(dim=axis, keepdim=True, unbiased=False)
    return (x - m) / torch.sqrt(v + eps)
def _scatter_add(tgt, idx, src, axis=0):
    return tgt.clone().index_add_(axis, idx, src)
def _segment_sum(src, seg, n):
    out = torch.zeros((n,) + src.shape[1:], dtype=src.dtype)
    return out.index_add_(0, seg, src)
def _pad(x, pw):
    flat = tuple(v for pair in reversed(pw) for v in pair)
    return torch.nn.functional.pad(x, flat)

kernel_name = 'sequential_preLN__sliding_block__glu_gated_reglu__prompt'

def setup_inputs():

    _w = (lambda a: (lambda t: t.to(torch.bfloat16) if t.is_floating_point() else t)(torch.as_tensor(a)))
    def _A_setup():
        B, S, D = 1, 2048, 512
        return {
            "x": _w((lambda *s: torch.randn(*s, dtype=torch.bfloat16) * 0.05)(B, S, D)),
            "wqkv": _w((lambda *s: torch.randn(*s, dtype=torch.bfloat16) * 0.05)(D, 3 * D)),
            "wo": _w((lambda *s: torch.randn(*s, dtype=torch.bfloat16) * 0.05)(D, D)),
        }
    _A_in = _A_setup()

    def _B_setup():
        B, S, D, F = 1, 2048, 512, 1792
        return {
            "x": _w((lambda *s: torch.randn(*s, dtype=torch.bfloat16) * 0.05)(B, S, D)),
            "W_gate": _w((lambda *s: torch.randn(*s, dtype=torch.bfloat16) * 0.8)(D, F) * (2.0 / D) ** 0.5),
            "W_up": _w((lambda *s: torch.randn(*s, dtype=torch.bfloat16) * 0.8)(D, F) * (2.0 / D) ** 0.5),
            "W_down": _w((lambda *s: torch.randn(*s, dtype=torch.bfloat16) * 0.8)(F, D) * (1.0 / F) ** 0.5),
        }
    _B_in = _B_setup()

    return {
        "A_x": _A_in["x"],
        "A_wqkv": _A_in["wqkv"],
        "A_wo": _A_in["wo"],
        "B_x": _B_in["x"],
        "B_W_gate": _B_in["W_gate"],
        "B_W_up": _B_in["W_up"],
        "B_W_down": _B_in["W_down"],
    }

def reference(A_x, A_wqkv, A_wo, B_x, B_W_gate, B_W_up, B_W_down):
    def _A_ref(x, wqkv, wo):
        B, S, D = x.shape
        H = 32; Dh = D // H; W = 256
        qkv = (lambda x, *d: x.permute(*d))((x @ wqkv).reshape(B, S, 3, H, Dh), 2, 0, 3, 1, 4)
        q, k, v = qkv[0], qkv[1], qkv[2]
        scores = torch.einsum("bhqd,bhkd->bhqk", q, k) * (Dh ** -0.5)
        idx = torch.arange(S)
        mask = (idx[:, None] - idx[None, :] >= 0) & (idx[:, None] - idx[None, :] < W)
        scores = torch.where(mask[None, None], scores, -1e9)
        p = _softmax(scores, axis=-1)
        o = torch.einsum("bhqk,bhkd->bhqd", p, v)
        return (lambda x, *d: x.permute(*d))(o, 0, 2, 1, 3).reshape(B, S, D) @ wo

    def _B_ref(x, W_gate, W_up, W_down):
        gate = torch.einsum("bsd,df->bsf", x, W_gate)
        up = torch.einsum("bsd,df->bsf", x, W_up)
        gate = gate * (lambda x, dt: x.to(dt))(gate > 0, gate.dtype)
        h = gate * up
        return torch.einsum("bsf,fd->bsd", h, W_down)

    x = A_x
    h = x + _A_ref(_layernorm(x, axis=-1), A_wqkv, A_wo)
    h2 = h + _B_ref(_layernorm(h, axis=-1), B_W_gate, B_W_up, B_W_down)
    return h2
```

```asm
; @launch grid=(256,1,1) block=(256,1,1) lds=163840
.amdgcn_target "amdgcn-amd-amdhsa--gfx950"
.text
.globl sequential_preLN__sliding_block__glu_gated_reglu__prompt_kernel
.p2align 8
.type sequential_preLN__sliding_block__glu_gated_reglu__prompt_kernel,@function
sequential_preLN__sliding_block__glu_gated_reglu__prompt_kernel:
    s_cmp_ge_u32 s2, 256
    s_cbranch_scc1 L_end
    s_load_dwordx2 s[8:9], s[0:1], 0
    s_load_dwordx2 s[12:13], s[0:1], 8
    s_load_dwordx2 s[44:45], s[0:1], 72
    s_getpc_b64 s[96:97]
L_pc0:
    s_lshr_b32 s100, s2, 3
    s_mul_i32 s100, s100, 9
    v_add_u32 v20, s100, v0
    v_min_u32 v20, (L_cend-L_pc0)/128-1, v20
    v_lshlrev_b32 v20, 7, v20
    v_mov_b32 v21, s97
    v_add_co_u32 v20, vcc, s96, v20
    s_nop 1
    v_addc_co_u32 v21, vcc, 0, v21, vcc
    v_cmp_gt_u32 vcc, 9, v0
    s_nop 0
    s_and_saveexec_b64 s[98:99], vcc
    s_cbranch_execz L_cpd
    global_load_dword v250, v[20:21], off
L_cpd:
    s_mov_b64 exec, -1
    v_lshrrev_b32 v1, 6, v0
    v_and_b32 v0, 63, v0
    s_and_b32 s4, s2, 7
    v_readfirstlane_b32 s3, v1
    s_lshr_b32 s5, s2, 3
    s_lshr_b32 s6, s5, 3
    s_and_b32 s7, s5, 7
    s_lshl_b32 s10, 1, 21
    s_lshl_b32 s11, 1, 17
    s_lshl_b32 s14, 3, 19
    s_lshl_b32 s15, 1, 17
    s_and_b32 s94, s3, 1
    s_lshr_b32 s95, s3, 1
    v_lshrrev_b32 v6, 3, v0
    v_and_b32 v7, 7, v0
    v_lshrrev_b32 v8, 4, v0
    v_xor_b32 v9, v7, v8
    v_lshlrev_b32 v9, 4, v9
    v_lshl_add_u32 v9, v6, 10, v9
    s_lshl_b32 s50, s4, 18
    s_lshl_b32 s51, s6, 16
    s_add_u32 s50, s50, s51
    s_lshl_b32 s51, s3, 14
    s_add_u32 s50, s50, s51
    v_add_u32 v3, s50, v9
    v_xor_b32 v4, 64, v3
    v_add_u32 v4, 7168, v4
    v_lshlrev_b32 v9, 1, v8
    v_xor_b32 v9, v7, v9
    v_lshlrev_b32 v10, 4, v9
    v_and_b32 v9, 4, v6
    v_add_u32 v9, v9, v6
    v_mul_u32_u24 v9, 3072, v9
    v_add_u32 v9, v9, v10
    s_lshl_b32 s50, s94, 2
    s_add_u32 s50, s50, s95
    s_mul_i32 s50, s50, 12288
    s_lshl_b32 s51, s7, 7
    s_add_u32 s50, s50, s51
    v_add_u32 v5, s50, v9
    s_add_u32 s52, s6, s7
    s_and_b32 s52, s52, 3
    s_and_b32 s50, s7, 4
    s_or_b32 s52, s52, s50
    s_lshl_b32 s53, s3, 11
    s_xor_b32 s55, s52, 0
    s_add_u32 s55, s55, s4
    s_and_b32 s55, s55, 7
    s_add_u32 m0, s53, 0
    s_lshl_b32 s56, s55, 7
    s_mul_i32 s55, s55, 196608
    s_waitcnt lgkmcnt(0)
    buffer_load_dwordx4 v3, s[8:11], s56 offen lds
    buffer_load_dwordx4 v4, s[8:11], s56 offen offset:1024 lds
    s_addk_i32 m0, 7168
    s_add_u32 s57, s55, 98304
    buffer_load_dwordx4 v5, s[12:15], s55 offen offset:1024 lds
    buffer_load_dwordx4 v5, s[12:15], s55 offen offset:2048 lds
    s_addk_i32 m0, 8192
    s_nop 0
    buffer_load_dwordx4 v5, s[12:15], s57 offen offset:1024 lds
    buffer_load_dwordx4 v5, s[12:15], s57 offen offset:2048 lds
    s_load_dwordx2 s[16:17], s[0:1], 64
    s_load_dwordx2 s[24:25], s[0:1], 16
    s_load_dwordx2 s[28:29], s[0:1], 32
    s_load_dwordx2 s[32:33], s[0:1], 40
    s_load_dwordx2 s[36:37], s[0:1], 48
    s_load_dwordx2 s[40:41], s[0:1], 56
    s_memrealtime s[48:49]
    s_mov_b32 s26, 0x80000
    s_mov_b32 s27, 0x20000
    s_mov_b32 s30, 0x1c0000
    s_mov_b32 s31, 0x20000
    s_mov_b32 s34, 0x1c0000
    s_mov_b32 s35, 0x20000
    s_mov_b32 s38, 0x1c0000
    s_mov_b32 s39, 0x20000
    s_mov_b32 s42, 0x200000
    s_mov_b32 s43, 0x20000
    s_mov_b32 s46, 0x1200000
    s_mov_b32 s47, 0x20000
    s_mov_b32 s18, 0x100
    s_mov_b32 s19, 0x20000
    s_waitcnt lgkmcnt(0)
    v_lshlrev_b32 v1, 4, v0
    s_or_b32 s48, s48, 1
    s_getreg_b32 s23, hwreg(HW_REG_XCC_ID, 0, 4)
    s_min_u32 s23, s23, 8
    s_cmp_lg_u32 s3, 0
    s_cbranch_scc1 L_p0
    s_mul_i32 s50, s23, 6
    s_lshl_b64 s[50:51], 1, s50
    s_or_b32 s51, s51, 0x04000000
    s_lshl_b32 s55, s4, 5
    s_mov_b64 exec, 1
    v_mov_b32 v12, s50
    v_mov_b32 v13, s51
    v_mov_b32 v14, s55
    buffer_atomic_add_x2 v[12:13], v14, s[16:19], 0 offen offset:16 sc1
    s_cmp_lg_u32 s2, 0
    s_cbranch_scc1 L_p0b
    v_mov_b32 v16, s48
    v_mov_b32 v17, s49
    buffer_store_dwordx2 v[16:17], v14, s[16:19], 0 offen sc1
L_p0b:
    s_mov_b64 exec, -1
L_p0:
    v_and_b32 v11, 31, v0
    v_lshrrev_b32 v12, 5, v0
    v_and_b32 v13, 15, v0
    v_bfe_u32 v14, v0, 1, 3
    v_xor_b32 v14, v14, v8
    v_lshlrev_b32 v14, 4, v14
    v_lshl_add_u32 v14, v13, 7, v14
    s_lshl_b32 s50, s94, 11
    s_lshl_b32 s51, s95, 6
    s_or_b32 s50, s50, s51
    v_xor_b32 v14, s50, v14
    v_xor_b32 v20, 0, v14
    v_xor_b32 v21, 2048, v14
    v_xor_b32 v22, 64, v14
    v_xor_b32 v23, 2112, v14
    v_bfe_u32 v14, v0, 2, 3
    v_lshlrev_b32 v14, 7, v14
    v_bfe_u32 v15, v0, 3, 2
    v_lshl_add_u32 v14, v15, 5, v14
    v_and_b32 v15, 3, v0
    v_lshl_add_u32 v18, v15, 3, v14
    v_lshl_add_u32 v14, v12, 11, v18
    s_lshl_b32 s50, s3, 5
    v_xor_b32 v17, s50, v14
    s_lshl_b32 s50, s95, 13
    s_add_u32 s51, s50, 8192
    s_sub_u32 s50, 16384, s50
    v_add_u32 v24, s51, v17
    v_add_u32 v25, s50, v17
    v_add_u32 v26, 49152, v20
    v_add_u32 v27, 49152, v21
    v_add_u32 v28, 49152, v22
    v_add_u32 v29, 49152, v23
    v_add_u32 v30, 49152, v24
    v_add_u32 v31, 49152, v25
    v_mov_b32 v104, 0x3f803f80
    v_mov_b32 v105, 0x3f803f80
    v_mov_b32 v106, 0x3f803f80
    v_mov_b32 v107, 0x3f803f80
    s_add_u32 s60, s4, 1
    s_lshl_b32 s60, s60, 21
    s_lshl_b32 s58, s3, 13
    s_lshl_b32 s61, s6, 1
    s_add_u32 s61, s61, s94
    v_and_b32 v9, 1, v8
    v_lshlrev_b32 v9, 2, v9
    v_xor_b32 v9, v7, v9
    v_lshlrev_b32 v9, 4, v9
    v_lshl_add_u32 v19, v6, 10, v9
    s_lshl_b32 s50, s3, 16
    s_lshl_b32 s51, s7, 7
    s_add_u32 s50, s50, s51
    v_add_u32 v19, s50, v19
    s_sub_u32 s92, s5, s6
    s_add_u32 s50, s6, 28
    s_cmp_gt_u32 s7, 3
    s_subb_u32 s92, s92, 0
    s_cmp_eq_u32 s7, 3
    s_cselect_b32 s92, s50, s92
    v_mul_u32_u24 v16, 3584, v6
    v_add_u32 v16, v16, v10
    s_lshl_b32 s50, s94, 1
    s_add_u32 s50, s50, s95
    s_mul_i32 s50, s50, 28672
    s_lshl_b32 s51, s92, 7
    s_add_u32 s50, s50, s51
    s_cmp_lt_u32 s92, 28
    s_cselect_b32 s50, s50, 0x40000000
    v_add_u32 v248, s50, v16
    s_and_b32 s2, s4, 7
    s_lshl_b32 s2, s2, 1
    s_bfe_u32 s50, s92, 0x10001
    s_mul_i32 s50, s50, 896
    s_lshl_b32 s51, s95, 6
    s_add_u32 s50, s50, s51
    s_lshl_b32 s51, s94, 4
    s_add_u32 s50, s50, s51
    s_lshl_b32 s50, s50, 10
    v_lshrrev_b32 v14, 2, v0
    v_lshlrev_b32 v14, 10, v14
    v_and_b32 v15, 3, v0
    v_lshl_add_u32 v14, v15, 7, v14
    v_add_u32 v249, s50, v14
    s_xor_b32 s55, s52, 1
    s_add_u32 s55, s55, s4
    s_and_b32 s55, s55, 7
    s_add_u32 m0, s53, 24576
    s_lshl_b32 s56, s55, 7
    s_mul_i32 s55, s55, 196608
    buffer_load_dwordx4 v3, s[8:11], s56 offen lds
    buffer_load_dwordx4 v4, s[8:11], s56 offen offset:1024 lds
    s_addk_i32 m0, 7168
    s_add_u32 s57, s55, 98304
    buffer_load_dwordx4 v5, s[12:15], s55 offen offset:1024 lds
    buffer_load_dwordx4 v5, s[12:15], s55 offen offset:2048 lds
    s_addk_i32 m0, 8192
    s_nop 0
    buffer_load_dwordx4 v5, s[12:15], s57 offen offset:1024 lds
    buffer_load_dwordx4 v5, s[12:15], s57 offen offset:2048 lds
    s_lshl_b32 s50, s94, 4
    v_xor_b32 v14, s50, v11
    v_lshlrev_b32 v15, 2, v12
    v_sub_u32 v14, v14, v15
    v_subrev_u32 v15, s50, v14
    v_add_u32 v14, s50, v14
    v_mov_b32 v16, 0xff800000
    v_cmp_le_i32 vcc, 0, v15
    s_nop 1
    v_cndmask_b32_e64 v128, v16, 0, vcc
    v_cndmask_b32 v144, 0, v16, vcc
    v_cmp_le_i32 vcc, 1, v15
    s_nop 1
    v_cndmask_b32_e64 v129, v16, 0, vcc
    v_cndmask_b32 v145, 0, v16, vcc
    v_cmp_le_i32 vcc, 2, v15
    s_nop 1
    v_cndmask_b32_e64 v130, v16, 0, vcc
    v_cndmask_b32 v146, 0, v16, vcc
    v_cmp_le_i32 vcc, 3, v15
    s_nop 1
    v_cndmask_b32_e64 v131, v16, 0, vcc
    v_cndmask_b32 v147, 0, v16, vcc
    v_cmp_le_i32 vcc, 8, v15
    s_nop 1
    v_cndmask_b32_e64 v132, v16, 0, vcc
    v_cndmask_b32 v148, 0, v16, vcc
    v_cmp_le_i32 vcc, 9, v15
    s_nop 1
    v_cndmask_b32_e64 v133, v16, 0, vcc
    v_cndmask_b32 v149, 0, v16, vcc
    v_cmp_le_i32 vcc, 10, v15
    s_nop 1
    v_cndmask_b32_e64 v134, v16, 0, vcc
    v_cndmask_b32 v150, 0, v16, vcc
    v_cmp_le_i32 vcc, 11, v15
    s_nop 1
    v_cndmask_b32_e64 v135, v16, 0, vcc
    v_cndmask_b32 v151, 0, v16, vcc
    v_cmp_le_i32 vcc, 16, v14
    s_nop 1
    v_cndmask_b32_e64 v136, v16, 0, vcc
    v_cndmask_b32 v152, 0, v16, vcc
    v_cmp_le_i32 vcc, 17, v14
    s_nop 1
    v_cndmask_b32_e64 v137, v16, 0, vcc
    v_cndmask_b32 v153, 0, v16, vcc
    v_cmp_le_i32 vcc, 18, v14
    s_nop 1
    v_cndmask_b32_e64 v138, v16, 0, vcc
    v_cndmask_b32 v154, 0, v16, vcc
    v_cmp_le_i32 vcc, 19, v14
    s_nop 1
    v_cndmask_b32_e64 v139, v16, 0, vcc
    v_cndmask_b32 v155, 0, v16, vcc
    v_cmp_le_i32 vcc, 24, v14
    s_nop 1
    v_cndmask_b32_e64 v140, v16, 0, vcc
    v_cndmask_b32 v156, 0, v16, vcc
    v_cmp_le_i32 vcc, 25, v14
    s_nop 1
    v_cndmask_b32_e64 v141, v16, 0, vcc
    v_cndmask_b32 v157, 0, v16, vcc
    v_cmp_le_i32 vcc, 26, v14
    s_nop 1
    v_cndmask_b32_e64 v142, v16, 0, vcc
    v_cndmask_b32 v158, 0, v16, vcc
    v_cmp_le_i32 vcc, 27, v14
    s_nop 1
    v_cndmask_b32_e64 v143, v16, 0, vcc
    v_cndmask_b32 v159, 0, v16, vcc
    s_lshl_b32 s54, s4, 2
    s_add_u32 s54, s54, s6
    v_mov_b32 v160, v104
    v_mov_b32 v161, v104
    v_mov_b32 v162, v104
    v_mov_b32 v163, v104
    v_mov_b32 v164, v104
    v_mov_b32 v165, v104
    v_mov_b32 v166, v104
    v_mov_b32 v167, v104
    v_mov_b32 v168, v104
    v_mov_b32 v169, v104
    v_mov_b32 v170, v104
    v_mov_b32 v171, v104
    v_mov_b32 v172, v104
    v_mov_b32 v173, v104
    v_mov_b32 v174, v104
    v_mov_b32 v175, v104
    s_cmp_ge_u32 s54, 1
    s_cselect_b32 s50, 0x3f803f80, 0
    v_mov_b32 v176, s50
    v_mov_b32 v177, s50
    v_mov_b32 v178, s50
    v_mov_b32 v179, s50
    v_mov_b32 v180, s50
    v_mov_b32 v181, s50
    v_mov_b32 v182, s50
    v_mov_b32 v183, s50
    v_mov_b32 v184, s50
    v_mov_b32 v185, s50
    v_mov_b32 v186, s50
    v_mov_b32 v187, s50
    v_mov_b32 v188, s50
    v_mov_b32 v189, s50
    v_mov_b32 v190, s50
    v_mov_b32 v191, s50
    s_cmp_ge_u32 s54, 2
    s_cselect_b32 s50, 0x3f803f80, 0
    v_mov_b32 v192, s50
    v_mov_b32 v193, s50
    v_mov_b32 v194, s50
    v_mov_b32 v195, s50
    v_mov_b32 v196, s50
    v_mov_b32 v197, s50
    v_mov_b32 v198, s50
    v_mov_b32 v199, s50
    v_mov_b32 v200, s50
    v_mov_b32 v201, s50
    v_mov_b32 v202, s50
    v_mov_b32 v203, s50
    v_mov_b32 v204, s50
    v_mov_b32 v205, s50
    v_mov_b32 v206, s50
    v_mov_b32 v207, s50
    s_cmp_ge_u32 s54, 3
    s_cselect_b32 s50, 0x3f803f80, 0
    v_mov_b32 v208, s50
    v_mov_b32 v209, s50
    v_mov_b32 v210, s50
    v_mov_b32 v211, s50
    v_mov_b32 v212, s50
    v_mov_b32 v213, s50
    v_mov_b32 v214, s50
    v_mov_b32 v215, s50
    v_mov_b32 v216, s50
    v_mov_b32 v217, s50
    v_mov_b32 v218, s50
    v_mov_b32 v219, s50
    v_mov_b32 v220, s50
    v_mov_b32 v221, s50
    v_mov_b32 v222, s50
    v_mov_b32 v223, s50
    s_cmp_ge_u32 s54, 4
    s_cselect_b32 s50, 0x3f803f80, 0
    v_mov_b32 v224, s50
    v_mov_b32 v225, s50
    v_mov_b32 v226, s50
    v_mov_b32 v227, s50
    v_mov_b32 v228, s50
    v_mov_b32 v229, s50
    v_mov_b32 v230, s50
    v_mov_b32 v231, s50
    v_mov_b32 v232, s50
    v_mov_b32 v233, s50
    v_mov_b32 v234, s50
    v_mov_b32 v235, s50
    v_mov_b32 v236, s50
    v_mov_b32 v237, s50
    v_mov_b32 v238, s50
    v_mov_b32 v239, s50
    s_lshl_b32 s50, s94, 8
    v_xor_b32 v251, s50, v1
    s_xor_b32 s55, s52, 2
    s_add_u32 s55, s55, s4
    s_and_b32 s55, s55, 7
    s_add_u32 m0, s53, 49152
    s_lshl_b32 s56, s55, 7
    s_mul_i32 s55, s55, 196608
    buffer_load_dwordx4 v3, s[8:11], s56 offen lds
    buffer_load_dwordx4 v4, s[8:11], s56 offen offset:1024 lds
    s_addk_i32 m0, 7168
    s_add_u32 s57, s55, 98304
    buffer_load_dwordx4 v5, s[12:15], s55 offen offset:1024 lds
    buffer_load_dwordx4 v5, s[12:15], s55 offen offset:2048 lds
    s_addk_i32 m0, 8192
    s_nop 0
    buffer_load_dwordx4 v5, s[12:15], s57 offen offset:1024 lds
    buffer_load_dwordx4 v5, s[12:15], s57 offen offset:2048 lds
    s_waitcnt vmcnt(12)
    s_barrier
    ds_read_b64_tr_b16 v[32:33], v24 offset:0
    ds_read_b64_tr_b16 v[34:35], v24 offset:4096
    ds_read_b128 a[0:3], v20 offset:0
    ds_read_b128 a[4:7], v21 offset:0
    ds_read_b128 a[8:11], v20 offset:4096
    ds_read_b128 a[12:15], v21 offset:4096
    ds_read_b64_tr_b16 v[36:37], v24 offset:1024
    ds_read_b64_tr_b16 v[38:39], v24 offset:5120
    s_waitcnt lgkmcnt(0)
    v_mfma_f32_16x16x32_bf16 v[88:91], a[0:3], a[0:3], 0
    s_xor_b32 s55, s52, 3
    s_add_u32 s55, s55, s4
    s_and_b32 s55, s55, 7
    s_add_u32 m0, s53, 73728
    s_lshl_b32 s56, s55, 7
    s_mul_i32 s55, s55, 196608
    buffer_load_dwordx4 v3, s[8:11], s56 offen lds
    ds_read_b64_tr_b16 v[40:41], v25 offset:0
    v_mfma_f32_16x16x32_bf16 v[96:99], v[104:107], a[0:3], 0
    ds_read_b64_tr_b16 v[42:43], v25 offset:4096
    ds_read_b128 a[16:19], v22 offset:0
    v_mfma_f32_16x16x32_bf16 v[48:51], v[32:35], a[0:3], 0
    ds_read_b128 a[20:23], v23 offset:0
    ds_read_b128 a[24:27], v22 offset:4096
    v_mfma_f32_16x16x32_bf16 v[52:55], v[32:35], a[4:7], 0
    ds_read_b128 a[28:31], v23 offset:4096
    ds_read_b64_tr_b16 v[44:45], v25 offset:1024
    v_mfma_f32_16x16x32_bf16 v[56:59], v[32:35], a[8:11], 0
    buffer_load_dwordx4 v4, s[8:11], s56 offen offset:1024 lds
    ds_read_b64_tr_b16 v[46:47], v25 offset:5120
    v_mfma_f32_16x16x32_bf16 v[60:63], v[32:35], a[12:15], 0
    s_addk_i32 m0, 7168
    s_add_u32 s57, s55, 98304
    v_mfma_f32_16x16x32_bf16 v[80:83], v[32:35], v[104:107], 0
    v_mfma_f32_16x16x32_bf16 v[64:67], a[0:3], v[36:39], 0
    v_mfma_f32_16x16x32_bf16 v[68:71], a[4:7], v[36:39], 0
    buffer_load_dwordx4 v5, s[12:15], s55 offen offset:1024 lds
    v_mfma_f32_16x16x32_bf16 v[72:75], a[8:11], v[36:39], 0
    v_mfma_f32_16x16x32_bf16 v[76:79], a[12:15], v[36:39], 0
    v_mfma_f32_16x16x32_bf16 v[84:87], v[104:107], v[36:39], 0
    s_waitcnt lgkmcnt(0)
    v_mfma_f32_16x16x32_bf16 v[92:95], a[24:27], a[24:27], 0
    s_waitcnt vmcnt(9)
    s_barrier
    buffer_load_dwordx4 v5, s[12:15], s55 offen offset:2048 lds
    ds_read_b64_tr_b16 v[32:33], v24 offset:24576
    v_mfma_f32_16x16x32_bf16 v[100:103], v[104:107], a[24:27], 0
    s_addk_i32 m0, 8192
    ds_read_b64_tr_b16 v[34:35], v24 offset:28672
    ds_read_b128 a[32:35], v20 offset:24576
    v_mfma_f32_16x16x32_bf16 v[48:51], v[40:43], a[16:19], v[48:51]
    s_nop 0
    ds_read_b128 a[36:39], v21 offset:24576
    ds_read_b128 a[40:43], v20 offset:28672
    v_mfma_f32_16x16x32_bf16 v[52:55], v[40:43], a[20:23], v[52:55]
    ds_read_b128 a[44:47], v21 offset:28672
    ds_read_b64_tr_b16 v[36:37], v24 offset:25600
    v_mfma_f32_16x16x32_bf16 v[56:59], v[40:43], a[24:27], v[56:59]
    buffer_load_dwordx4 v5, s[12:15], s57 offen offset:1024 lds
    ds_read_b64_tr_b16 v[38:39], v24 offset:29696
    v_mfma_f32_16x16x32_bf16 v[60:63], v[40:43], a[28:31], v[60:63]
    v_mfma_f32_16x16x32_bf16 v[80:83], v[40:43], v[104:107], v[80:83]
    v_mfma_f32_16x16x32_bf16 v[64:67], a[16:19], v[44:47], v[64:67]
    v_mfma_f32_16x16x32_bf16 v[68:71], a[20:23], v[44:47], v[68:71]
    buffer_load_dwordx4 v5, s[12:15], s57 offen offset:2048 lds
    v_mfma_f32_16x16x32_bf16 v[72:75], a[24:27], v[44:47], v[72:75]
    s_xor_b32 s55, s52, 4
    s_add_u32 s55, s55, s4
    v_mfma_f32_16x16x32_bf16 v[76:79], a[28:31], v[44:47], v[76:79]
    s_and_b32 s55, s55, 7
    s_add_u32 m0, s53, 0
    v_mfma_f32_16x16x32_bf16 v[84:87], v[104:107], v[44:47], v[84:87]
    s_lshl_b32 s56, s55, 7
    s_mul_i32 s55, s55, 196608
    s_waitcnt lgkmcnt(0)
    v_mfma_f32_16x16x32_bf16 v[88:91], a[32:35], a[32:35], v[88:91]
    buffer_load_dwordx4 v3, s[8:11], s56 offen lds
    ds_read_b64_tr_b16 v[40:41], v25 offset:24576
    v_mfma_f32_16x16x32_bf16 v[96:99], v[104:107], a[32:35], v[96:99]
    ds_read_b64_tr_b16 v[42:43], v25 offset:28672
    ds_read_b128 a[48:51], v22 offset:24576
    v_mfma_f32_16x16x32_bf16 v[48:51], v[32:35], a[32:35], v[48:51]
    ds_read_b128 a[52:55], v23 offset:24576
    ds_read_b128 a[56:59], v22 offset:28672
    v_mfma_f32_16x16x32_bf16 v[52:55], v[32:35], a[36:39], v[52:55]
    ds_read_b128 a[60:63], v23 offset:28672
    ds_read_b64_tr_b16 v[44:45], v25 offset:25600
    v_mfma_f32_16x16x32_bf16 v[56:59], v[32:35], a[40:43], v[56:59]
    buffer_load_dwordx4 v4, s[8:11], s56 offen offset:1024 lds
    ds_read_b64_tr_b16 v[46:47], v25 offset:29696
    v_mfma_f32_16x16x32_bf16 v[60:63], v[32:35], a[44:47], v[60:63]
    s_addk_i32 m0, 7168
    s_add_u32 s57, s55, 98304
    v_mfma_f32_16x16x32_bf16 v[80:83], v[32:35], v[104:107], v[80:83]
    v_mfma_f32_16x16x32_bf16 v[64:67], a[32:35], v[36:39], v[64:67]
    v_mfma_f32_16x16x32_bf16 v[68:71], a[36:39], v[36:39], v[68:71]
    buffer_load_dwordx4 v5, s[12:15], s55 offen offset:1024 lds
    v_mfma_f32_16x16x32_bf16 v[72:75], a[40:43], v[36:39], v[72:75]
    v_mfma_f32_16x16x32_bf16 v[76:79], a[44:47], v[36:39], v[76:79]
    v_mfma_f32_16x16x32_bf16 v[84:87], v[104:107], v[36:39], v[84:87]
    s_waitcnt lgkmcnt(0)
    v_mfma_f32_16x16x32_bf16 v[92:95], a[56:59], a[56:59], v[92:95]
    s_waitcnt vmcnt(9)
    s_barrier
    buffer_load_dwordx4 v5, s[12:15], s55 offen offset:2048 lds
    ds_read_b64_tr_b16 v[32:33], v30 offset:0
    v_mfma_f32_16x16x32_bf16 v[100:103], v[104:107], a[56:59], v[100:103]
    s_addk_i32 m0, 8192
    ds_read_b64_tr_b16 v[34:35], v30 offset:4096
    ds_read_b128 a[64:67], v26 offset:0
    v_mfma_f32_16x16x32_bf16 v[48:51], v[40:43], a[48:51], v[48:51]
    s_nop 0
    ds_read_b128 a[68:71], v27 offset:0
    ds_read_b128 a[72:75], v26 offset:4096
    v_mfma_f32_16x16x32_bf16 v[52:55], v[40:43], a[52:55], v[52:55]
    ds_read_b128 a[76:79], v27 offset:4096
    ds_read_b64_tr_b16 v[36:37], v30 offset:1024
    v_mfma_f32_16x16x32_bf16 v[56:59], v[40:43], a[56:59], v[56:59]
    buffer_load_dwordx4 v5, s[12:15], s57 offen offset:1024 lds
    ds_read_b64_tr_b16 v[38:39], v30 offset:5120
    v_mfma_f32_16x16x32_bf16 v[60:63], v[40:43], a[60:63], v[60:63]
    v_mfma_f32_16x16x32_bf16 v[80:83], v[40:43], v[104:107], v[80:83]
    v_mfma_f32_16x16x32_bf16 v[64:67], a[48:51], v[44:47], v[64:67]
    v_mfma_f32_16x16x32_bf16 v[68:71], a[52:55], v[44:47], v[68:71]
    buffer_load_dwordx4 v5, s[12:15], s57 offen offset:2048 lds
    v_mfma_f32_16x16x32_bf16 v[72:75], a[56:59], v[44:47], v[72:75]
    s_xor_b32 s55, s52, 5
    s_add_u32 s55, s55, s4
    v_mfma_f32_16x16x32_bf16 v[76:79], a[60:63], v[44:47], v[76:79]
    s_and_b32 s55, s55, 7
    s_add_u32 m0, s53, 24576
    v_mfma_f32_16x16x32_bf16 v[84:87], v[104:107], v[44:47], v[84:87]
    s_lshl_b32 s56, s55, 7
    s_mul_i32 s55, s55, 196608
    s_waitcnt lgkmcnt(0)
    v_mfma_f32_16x16x32_bf16 v[88:91], a[64:67], a[64:67], v[88:91]
    buffer_load_dwordx4 v3, s[8:11], s56 offen lds
    ds_read_b64_tr_b16 v[40:41], v31 offset:0
    v_mfma_f32_16x16x32_bf16 v[96:99], v[104:107], a[64:67], v[96:99]
    ds_read_b64_tr_b16 v[42:43], v31 offset:4096
    ds_read_b128 a[80:83], v28 offset:0
    v_mfma_f32_16x16x32_bf16 v[48:51], v[32:35], a[64:67], v[48:51]
    ds_read_b128 a[84:87], v29 offset:0
    ds_read_b128 a[88:91], v28 offset:4096
    v_mfma_f32_16x16x32_bf16 v[52:55], v[32:35], a[68:71], v[52:55]
    ds_read_b128 a[92:95], v29 offset:4096
    ds_read_b64_tr_b16 v[44:45], v31 offset:1024
    v_mfma_f32_16x16x32_bf16 v[56:59], v[32:35], a[72:75], v[56:59]
    buffer_load_dwordx4 v4, s[8:11], s56 offen offset:1024 lds
    ds_read_b64_tr_b16 v[46:47], v31 offset:5120
    v_mfma_f32_16x16x32_bf16 v[60:63], v[32:35], a[76:79], v[60:63]
    s_addk_i32 m0, 7168
    s_add_u32 s57, s55, 98304
    v_mfma_f32_16x16x32_bf16 v[80:83], v[32:35], v[104:107], v[80:83]
    v_mfma_f32_16x16x32_bf16 v[64:67], a[64:67], v[36:39], v[64:67]
    v_mfma_f32_16x16x32_bf16 v[68:71], a[68:71], v[36:39], v[68:71]
    buffer_load_dwordx4 v5, s[12:15], s55 offen offset:1024 lds
    v_mfma_f32_16x16x32_bf16 v[72:75], a[72:75], v[36:39], v[72:75]
    v_mfma_f32_16x16x32_bf16 v[76:79], a[76:79], v[36:39], v[76:79]
    v_mfma_f32_16x16x32_bf16 v[84:87], v[104:107], v[36:39], v[84:87]
    s_waitcnt lgkmcnt(0)
    v_mfma_f32_16x16x32_bf16 v[92:95], a[88:91], a[88:91], v[92:95]
    s_waitcnt vmcnt(9)
    s_barrier
    buffer_load_dwordx4 v5, s[12:15], s55 offen offset:2048 lds
    ds_read_b64_tr_b16 v[32:33], v30 offset:24576
    v_mfma_f32_16x16x32_bf16 v[100:103], v[104:107], a[88:91], v[100:103]
    s_addk_i32 m0, 8192
    ds_read_b64_tr_b16 v[34:35], v30 offset:28672
    ds_read_b128 a[96:99], v26 offset:24576
    v_mfma_f32_16x16x32_bf16 v[48:51], v[40:43], a[80:83], v[48:51]
    s_nop 0
    ds_read_b128 a[100:103], v27 offset:24576
    ds_read_b128 a[104:107], v26 offset:28672
    v_mfma_f32_16x16x32_bf16 v[52:55], v[40:43], a[84:87], v[52:55]
    ds_read_b128 a[108:111], v27 offset:28672
    ds_read_b64_tr_b16 v[36:37], v30 offset:25600
    v_mfma_f32_16x16x32_bf16 v[56:59], v[40:43], a[88:91], v[56:59]
    buffer_load_dwordx4 v5, s[12:15], s57 offen offset:1024 lds
    ds_read_b64_tr_b16 v[38:39], v30 offset:29696
    v_mfma_f32_16x16x32_bf16 v[60:63], v[40:43], a[92:95], v[60:63]
    v_mfma_f32_16x16x32_bf16 v[80:83], v[40:43], v[104:107], v[80:83]
    v_mfma_f32_16x16x32_bf16 v[64:67], a[80:83], v[44:47], v[64:67]
    v_mfma_f32_16x16x32_bf16 v[68:71], a[84:87], v[44:47], v[68:71]
    buffer_load_dwordx4 v5, s[12:15], s57 offen offset:2048 lds
    v_mfma_f32_16x16x32_bf16 v[72:75], a[88:91], v[44:47], v[72:75]
    s_xor_b32 s55, s52, 6
    s_add_u32 s55, s55, s4
    v_mfma_f32_16x16x32_bf16 v[76:79], a[92:95], v[44:47], v[76:79]
    s_and_b32 s55, s55, 7
    s_add_u32 m0, s53, 49152
    v_mfma_f32_16x16x32_bf16 v[84:87], v[104:107], v[44:47], v[84:87]
    s_lshl_b32 s56, s55, 7
    s_mul_i32 s55, s55, 196608
    s_waitcnt lgkmcnt(0)
    v_mfma_f32_16x16x32_bf16 v[88:91], a[96:99], a[96:99], v[88:91]
    buffer_load_dwordx4 v3, s[8:11], s56 offen lds
    ds_read_b64_tr_b16 v[40:41], v31 offset:24576
    v_mfma_f32_16x16x32_bf16 v[96:99], v[104:107], a[96:99], v[96:99]
    ds_read_b64_tr_b16 v[42:43], v31 offset:28672
    ds_read_b128 a[112:115], v28 offset:24576
    v_mfma_f32_16x16x32_bf16 v[48:51], v[32:35], a[96:99], v[48:51]
    ds_read_b128 a[116:119], v29 offset:24576
    ds_read_b128 a[120:123], v28 offset:28672
    v_mfma_f32_16x16x32_bf16 v[52:55], v[32:35], a[100:103], v[52:55]
    ds_read_b128 a[124:127], v29 offset:28672
    ds_read_b64_tr_b16 v[44:45], v31 offset:25600
    v_mfma_f32_16x16x32_bf16 v[56:59], v[32:35], a[104:107], v[56:59]
    buffer_load_dwordx4 v4, s[8:11], s56 offen offset:1024 lds
    ds_read_b64_tr_b16 v[46:47], v31 offset:29696
    v_mfma_f32_16x16x32_bf16 v[60:63], v[32:35], a[108:111], v[60:63]
    s_addk_i32 m0, 7168
    s_add_u32 s57, s55, 98304
    v_mfma_f32_16x16x32_bf16 v[80:83], v[32:35], v[104:107], v[80:83]
    v_mfma_f32_16x16x32_bf16 v[64:67], a[96:99], v[36:39], v[64:67]
    v_mfma_f32_16x16x32_bf16 v[68:71], a[100:103], v[36:39], v[68:71]
    buffer_load_dwordx4 v5, s[12:15], s55 offen offset:1024 lds
    v_mfma_f32_16x16x32_bf16 v[72:75], a[104:107], v[36:39], v[72:75]
    v_mfma_f32_16x16x32_bf16 v[76:79], a[108:111], v[36:39], v[76:79]
    v_mfma_f32_16x16x32_bf16 v[84:87], v[104:107], v[36:39], v[84:87]
    s_waitcnt lgkmcnt(0)
    v_mfma_f32_16x16x32_bf16 v[92:95], a[120:123], a[120:123], v[92:95]
    s_waitcnt vmcnt(9)
    s_barrier
    buffer_load_dwordx4 v5, s[12:15], s55 offen offset:2048 lds
    ds_read_b64_tr_b16 v[32:33], v24 offset:0
    v_mfma_f32_16x16x32_bf16 v[100:103], v[104:107], a[120:123], v[100:103]
    s_addk_i32 m0, 8192
    ds_read_b64_tr_b16 v[34:35], v24 offset:4096
    ds_read_b128 a[128:131], v20 offset:0
    v_mfma_f32_16x16x32_bf16 v[48:51], v[40:43], a[112:115], v[48:51]
    s_nop 0
    ds_read_b128 a[132:135], v21 offset:0
    ds_read_b128 a[136:139], v20 offset:4096
    v_mfma_f32_16x16x32_bf16 v[52:55], v[40:43], a[116:119], v[52:55]
    ds_read_b128 a[140:143], v21 offset:4096
    ds_read_b64_tr_b16 v[36:37], v24 offset:1024
    v_mfma_f32_16x16x32_bf16 v[56:59], v[40:43], a[120:123], v[56:59]
    buffer_load_dwordx4 v5, s[12:15], s57 offen offset:1024 lds
    ds_read_b64_tr_b16 v[38:39], v24 offset:5120
    v_mfma_f32_16x16x32_bf16 v[60:63], v[40:43], a[124:127], v[60:63]
    v_mfma_f32_16x16x32_bf16 v[80:83], v[40:43], v[104:107], v[80:83]
    v_mfma_f32_16x16x32_bf16 v[64:67], a[112:115], v[44:47], v[64:67]
    v_mfma_f32_16x16x32_bf16 v[68:71], a[116:119], v[44:47], v[68:71]
    buffer_load_dwordx4 v5, s[12:15], s57 offen offset:2048 lds
    v_mfma_f32_16x16x32_bf16 v[72:75], a[120:123], v[44:47], v[72:75]
    s_xor_b32 s55, s52, 7
    s_add_u32 s55, s55, s4
    v_mfma_f32_16x16x32_bf16 v[76:79], a[124:127], v[44:47], v[76:79]
    s_and_b32 s55, s55, 7
    s_add_u32 m0, s53, 73728
    v_mfma_f32_16x16x32_bf16 v[84:87], v[104:107], v[44:47], v[84:87]
    s_lshl_b32 s56, s55, 7
    s_mul_i32 s55, s55, 196608
    s_waitcnt lgkmcnt(0)
    v_mfma_f32_16x16x32_bf16 v[88:91], a[128:131], a[128:131], v[88:91]
    buffer_load_dwordx4 v3, s[8:11], s56 offen lds
    ds_read_b64_tr_b16 v[40:41], v25 offset:0
    v_mfma_f32_16x16x32_bf16 v[96:99], v[104:107], a[128:131], v[96:99]
    ds_read_b64_tr_b16 v[42:43], v25 offset:4096
    ds_read_b128 a[144:147], v22 offset:0
    v_mfma_f32_16x16x32_bf16 v[48:51], v[32:35], a[128:131], v[48:51]
    ds_read_b128 a[148:151], v23 offset:0
    ds_read_b128 a[152:155], v22 offset:4096
    v_mfma_f32_16x16x32_bf16 v[52:55], v[32:35], a[132:135], v[52:55]
    ds_read_b128 a[156:159], v23 offset:4096
    ds_read_b64_tr_b16 v[44:45], v25 offset:1024
    v_mfma_f32_16x16x32_bf16 v[56:59], v[32:35], a[136:139], v[56:59]
    buffer_load_dwordx4 v4, s[8:11], s56 offen offset:1024 lds
    ds_read_b64_tr_b16 v[46:47], v25 offset:5120
    v_mfma_f32_16x16x32_bf16 v[60:63], v[32:35], a[140:143], v[60:63]
    s_addk_i32 m0, 7168
    s_add_u32 s57, s55, 98304
    v_mfma_f32_16x16x32_bf16 v[80:83], v[32:35], v[104:107], v[80:83]
    v_mfma_f32_16x16x32_bf16 v[64:67], a[128:131], v[36:39], v[64:67]
    v_mfma_f32_16x16x32_bf16 v[68:71], a[132:135], v[36:39], v[68:71]
    buffer_load_dwordx4 v5, s[12:15], s55 offen offset:1024 lds
    v_mfma_f32_16x16x32_bf16 v[72:75], a[136:139], v[36:39], v[72:75]
    v_mfma_f32_16x16x32_bf16 v[76:79], a[140:143], v[36:39], v[76:79]
    v_mfma_f32_16x16x32_bf16 v[84:87], v[104:107], v[36:39], v[84:87]
    s_waitcnt lgkmcnt(0)
    v_mfma_f32_16x16x32_bf16 v[92:95], a[152:155], a[152:155], v[92:95]
    s_waitcnt vmcnt(9)
    s_barrier
    buffer_load_dwordx4 v5, s[12:15], s55 offen offset:2048 lds
    ds_read_b64_tr_b16 v[32:33], v24 offset:24576
    v_mfma_f32_16x16x32_bf16 v[100:103], v[104:107], a[152:155], v[100:103]
    s_addk_i32 m0, 8192
    ds_read_b64_tr_b16 v[34:35], v24 offset:28672
    ds_read_b128 a[160:163], v20 offset:24576
    v_mfma_f32_16x16x32_bf16 v[48:51], v[40:43], a[144:147], v[48:51]
    s_nop 0
    ds_read_b128 a[164:167], v21 offset:24576
    ds_read_b128 a[168:171], v20 offset:28672
    v_mfma_f32_16x16x32_bf16 v[52:55], v[40:43], a[148:151], v[52:55]
    ds_read_b128 a[172:175], v21 offset:28672
    ds_read_b64_tr_b16 v[36:37], v24 offset:25600
    v_mfma_f32_16x16x32_bf16 v[56:59], v[40:43], a[152:155], v[56:59]
    buffer_load_dwordx4 v5, s[12:15], s57 offen offset:1024 lds
    ds_read_b64_tr_b16 v[38:39], v24 offset:29696
    v_mfma_f32_16x16x32_bf16 v[60:63], v[40:43], a[156:159], v[60:63]
    v_mfma_f32_16x16x32_bf16 v[80:83], v[40:43], v[104:107], v[80:83]
    v_mfma_f32_16x16x32_bf16 v[64:67], a[144:147], v[44:47], v[64:67]
    v_mfma_f32_16x16x32_bf16 v[68:71], a[148:151], v[44:47], v[68:71]
    buffer_load_dwordx4 v5, s[12:15], s57 offen offset:2048 lds
    v_mfma_f32_16x16x32_bf16 v[72:75], a[152:155], v[44:47], v[72:75]
    s_xor_b32 s55, s52, 0
    s_add_u32 s55, s55, s4
    v_mfma_f32_16x16x32_bf16 v[76:79], a[156:159], v[44:47], v[76:79]
    s_and_b32 s55, s55, 7
    s_add_u32 m0, s53, 98304
    v_mfma_f32_16x16x32_bf16 v[84:87], v[104:107], v[44:47], v[84:87]
    s_mul_i32 s55, s55, 196608
    s_add_u32 s57, s55, 97280
    s_waitcnt lgkmcnt(0)
    v_mfma_f32_16x16x32_bf16 v[88:91], a[160:163], a[160:163], v[88:91]
    buffer_load_dwordx4 v5, s[12:15], s55 offen lds
    ds_read_b64_tr_b16 v[40:41], v25 offset:24576
    v_mfma_f32_16x16x32_bf16 v[96:99], v[104:107], a[160:163], v[96:99]
    ds_read_b64_tr_b16 v[42:43], v25 offset:28672
    ds_read_b128 a[176:179], v22 offset:24576
    v_mfma_f32_16x16x32_bf16 v[48:51], v[32:35], a[160:163], v[48:51]
    ds_read_b128 a[180:183], v23 offset:24576
    ds_read_b128 a[184:187], v22 offset:28672
    v_mfma_f32_16x16x32_bf16 v[52:55], v[32:35], a[164:167], v[52:55]
    ds_read_b128 a[188:191], v23 offset:28672
    ds_read_b64_tr_b16 v[44:45], v25 offset:25600
    v_mfma_f32_16x16x32_bf16 v[56:59], v[32:35], a[168:171], v[56:59]
    buffer_load_dwordx4 v5, s[12:15], s57 offen offset:1024 lds
    ds_read_b64_tr_b16 v[46:47], v25 offset:29696
    v_mfma_f32_16x16x32_bf16 v[60:63], v[32:35], a[172:175], v[60:63]
    s_xor_b32 s55, s52, 4
    s_add_u32 s55, s55, s4
    v_mfma_f32_16x16x32_bf16 v[80:83], v[32:35], v[104:107], v[80:83]
    s_and_b32 s55, s55, 7
    s_add_u32 m0, s53, 131072
    v_mfma_f32_16x16x32_bf16 v[64:67], a[160:163], v[36:39], v[64:67]
    s_mul_i32 s55, s55, 196608
    s_add_u32 s57, s55, 97280
    v_mfma_f32_16x16x32_bf16 v[68:71], a[164:167], v[36:39], v[68:71]
    buffer_load_dwordx4 v5, s[12:15], s55 offen lds
    v_mfma_f32_16x16x32_bf16 v[72:75], a[168:171], v[36:39], v[72:75]
    v_mfma_f32_16x16x32_bf16 v[76:79], a[172:175], v[36:39], v[76:79]
    v_mfma_f32_16x16x32_bf16 v[84:87], v[104:107], v[36:39], v[84:87]
    s_waitcnt lgkmcnt(0)
    v_mfma_f32_16x16x32_bf16 v[92:95], a[184:187], a[184:187], v[92:95]
    s_waitcnt vmcnt(9)
    s_barrier
    buffer_load_dwordx4 v5, s[12:15], s57 offen offset:1024 lds
    ds_read_b64_tr_b16 v[32:33], v30 offset:0
    v_mfma_f32_16x16x32_bf16 v[100:103], v[104:107], a[184:187], v[100:103]
    s_lshl_b32 s55, s7, 16
    ds_read_b64_tr_b16 v[34:35], v30 offset:4096
    ds_read_b128 a[192:195], v26 offset:0
    v_mfma_f32_16x16x32_bf16 v[48:51], v[40:43], a[176:179], v[48:51]
    s_lshl_b32 s56, s3, 14
    ds_read_b128 a[196:199], v27 offset:0
    ds_read_b128 a[200:203], v26 offset:4096
    v_mfma_f32_16x16x32_bf16 v[52:55], v[40:43], a[180:183], v[52:55]
    s_add_u32 s55, s55, s56
    ds_read_b128 a[204:207], v27 offset:4096
    ds_read_b64_tr_b16 v[36:37], v30 offset:1024
    v_mfma_f32_16x16x32_bf16 v[56:59], v[40:43], a[184:187], v[56:59]
    s_lshl_b32 s56, s6, 12
    s_add_u32 s55, s55, s56
    buffer_load_dwordx4 v[108:111], v1, s[24:27], s55 offen offset:0
    ds_read_b64_tr_b16 v[38:39], v30 offset:5120
    v_mfma_f32_16x16x32_bf16 v[60:63], v[40:43], a[188:191], v[60:63]
    v_mfma_f32_16x16x32_bf16 v[80:83], v[40:43], v[104:107], v[80:83]
    v_mfma_f32_16x16x32_bf16 v[64:67], a[176:179], v[44:47], v[64:67]
    v_mfma_f32_16x16x32_bf16 v[68:71], a[180:183], v[44:47], v[68:71]
    buffer_load_dwordx4 v[112:115], v1, s[24:27], s55 offen offset:1024
    v_mfma_f32_16x16x32_bf16 v[72:75], a[184:187], v[44:47], v[72:75]
    v_mfma_f32_16x16x32_bf16 v[76:79], a[188:191], v[44:47], v[76:79]
    v_mfma_f32_16x16x32_bf16 v[84:87], v[104:107], v[44:47], v[84:87]
    s_waitcnt lgkmcnt(0)
    v_mfma_f32_16x16x32_bf16 v[88:91], a[192:195], a[192:195], v[88:91]
    buffer_load_dwordx4 v[116:119], v1, s[24:27], s55 offen offset:2048
    ds_read_b64_tr_b16 v[40:41], v31 offset:0
    v_mfma_f32_16x16x32_bf16 v[96:99], v[104:107], a[192:195], v[96:99]
    ds_read_b64_tr_b16 v[42:43], v31 offset:4096
    ds_read_b128 a[208:211], v28 offset:0
    v_mfma_f32_16x16x32_bf16 v[48:51], v[32:35], a[192:195], v[48:51]
    ds_read_b128 a[212:215], v29 offset:0
    ds_read_b128 a[216:219], v28 offset:4096
    v_mfma_f32_16x16x32_bf16 v[52:55], v[32:35], a[196:199], v[52:55]
    ds_read_b128 a[220:223], v29 offset:4096
    ds_read_b64_tr_b16 v[44:45], v31 offset:1024
    v_mfma_f32_16x16x32_bf16 v[56:59], v[32:35], a[200:203], v[56:59]
    buffer_load_dwordx4 v[120:123], v1, s[24:27], s55 offen offset:3072
    ds_read_b64_tr_b16 v[46:47], v31 offset:5120
    v_mfma_f32_16x16x32_bf16 v[60:63], v[32:35], a[204:207], v[60:63]
    s_lshl_b32 s55, s4, 5
    v_mfma_f32_16x16x32_bf16 v[80:83], v[32:35], v[104:107], v[80:83]
    v_mfma_f32_16x16x32_bf16 v[64:67], a[192:195], v[36:39], v[64:67]
    v_mfma_f32_16x16x32_bf16 v[68:71], a[196:199], v[36:39], v[68:71]
    buffer_load_dwordx2 v[124:125], off, s[16:19], 0 sc1
    v_mfma_f32_16x16x32_bf16 v[72:75], a[200:203], v[36:39], v[72:75]
    v_mfma_f32_16x16x32_bf16 v[76:79], a[204:207], v[36:39], v[76:79]
    v_mfma_f32_16x16x32_bf16 v[84:87], v[104:107], v[36:39], v[84:87]
    s_waitcnt lgkmcnt(0)
    v_mfma_f32_16x16x32_bf16 v[92:95], a[216:219], a[216:219], v[92:95]
    s_waitcnt vmcnt(9)
    s_barrier
    buffer_load_dwordx2 v[126:127], off, s[16:19], s55 offset:16 sc1
    ds_read_b64_tr_b16 v[32:33], v30 offset:24576
    v_mfma_f32_16x16x32_bf16 v[100:103], v[104:107], a[216:219], v[100:103]
    s_lshl_b32 s55, s6, 12
    ds_read_b64_tr_b16 v[34:35], v30 offset:28672
    ds_read_b128 a[224:227], v26 offset:24576
    v_mfma_f32_16x16x32_bf16 v[48:51], v[40:43], a[208:211], v[48:51]
    s_lshl_b32 s56, s7, 9
    ds_read_b128 a[228:231], v27 offset:24576
    ds_read_b128 a[232:235], v26 offset:28672
    v_mfma_f32_16x16x32_bf16 v[52:55], v[40:43], a[212:215], v[52:55]
    s_add_u32 s55, s55, s56
    ds_read_b128 a[236:239], v27 offset:28672
    ds_read_b64_tr_b16 v[36:37], v30 offset:25600
    v_mfma_f32_16x16x32_bf16 v[56:59], v[40:43], a[216:219], v[56:59]
    s_lshl_b32 s56, s3, 7
    s_add_u32 s55, s55, s56
    s_lshl_b32 s56, s5, 7
    s_sub_u32 s56, s56, s55
    s_add_u32 s56, s56, 16384
    s_add_u32 s55, s55, s60
    s_add_u32 s55, s55, 0x1ec000
    v_min_u32 v14, 1, v0
    v_mul_u32_u24 v14, s56, v14
    buffer_load_dword v250, v14, s[44:47], s55 offen sc1
    ds_read_b64_tr_b16 v[38:39], v30 offset:29696
    v_mfma_f32_16x16x32_bf16 v[60:63], v[40:43], a[220:223], v[60:63]
    s_xor_b32 s55, s52, 1
    s_add_u32 s55, s55, s4
    s_mov_b32 s96, 0xaaaaaaaa
    s_mov_b32 s97, 0xaaaaaaaa
    v_mfma_f32_16x16x32_bf16 v[80:83], v[40:43], v[104:107], v[80:83]
    s_and_b32 s55, s55, 7
    s_add_u32 m0, s53, 106496
    s_mov_b32 s98, 0xcccccccc
    s_mov_b32 s99, 0xcccccccc
    v_mfma_f32_16x16x32_bf16 v[64:67], a[208:211], v[44:47], v[64:67]
    s_mul_i32 s55, s55, 196608
    s_add_u32 s57, s55, 97280
    s_lshl_b32 s50, s95, 9
    s_lshl_b32 s51, s94, 7
    v_mfma_f32_16x16x32_bf16 v[68:71], a[212:215], v[44:47], v[68:71]
    buffer_load_dwordx4 v5, s[12:15], s55 offen lds
    v_mfma_f32_16x16x32_bf16 v[72:75], a[216:219], v[44:47], v[72:75]
    s_add_u32 s51, s51, 65536
    s_add_u32 s50, s50, s51
    v_mfma_f32_16x16x32_bf16 v[76:79], a[220:223], v[44:47], v[76:79]
    v_lshl_add_u32 v14, v13, 3, s50
    v_lshl_add_u32 v15, v13, 3, s51
    v_mfma_f32_16x16x32_bf16 v[84:87], v[104:107], v[44:47], v[84:87]
    v_xor_b32 v16, 128, v15
    s_lshl_b32 s50, s6, 17
    s_waitcnt lgkmcnt(0)
    v_mfma_f32_16x16x32_bf16 v[88:91], a[224:227], a[224:227], v[88:91]
    buffer_load_dwordx4 v5, s[12:15], s57 offen offset:1024 lds
    ds_read_b64_tr_b16 v[40:41], v31 offset:24576
    v_mfma_f32_16x16x32_bf16 v[96:99], v[104:107], a[224:227], v[96:99]
    s_xor_b32 s55, s52, 2
    ds_read_b64_tr_b16 v[42:43], v31 offset:28672
    ds_read_b128 a[240:243], v28 offset:24576
    v_mfma_f32_16x16x32_bf16 v[48:51], v[32:35], a[224:227], v[48:51]
    s_add_u32 s55, s55, s4
    ds_read_b128 a[244:247], v29 offset:24576
    ds_read_b128 a[248:251], v28 offset:28672
    v_mfma_f32_16x16x32_bf16 v[52:55], v[32:35], a[228:231], v[52:55]
    s_and_b32 s55, s55, 7
    ds_read_b128 a[252:255], v29 offset:28672
    ds_read_b64_tr_b16 v[44:45], v31 offset:25600
    v_mfma_f32_16x16x32_bf16 v[56:59], v[32:35], a[232:235], v[56:59]
    s_add_u32 m0, s53, 114688
    s_mul_i32 s55, s55, 196608
    s_add_u32 s57, s55, 97280
    buffer_load_dwordx4 v5, s[12:15], s55 offen lds
    ds_read_b64_tr_b16 v[46:47], v31 offset:29696
    v_mfma_f32_16x16x32_bf16 v[60:63], v[32:35], a[236:239], v[60:63]
    s_lshl_b32 s51, s7, 14
    s_add_u32 s50, s50, s51
    v_mfma_f32_16x16x32_bf16 v[80:83], v[32:35], v[104:107], v[80:83]
    s_lshl_b32 s51, s3, 12
    s_add_u32 s50, s50, s51
    v_mfma_f32_16x16x32_bf16 v[64:67], a[224:227], v[36:39], v[64:67]
    s_add_u32 s100, s50, s60
    s_lshl_b32 s50, s3, 9
    v_mfma_f32_16x16x32_bf16 v[68:71], a[228:231], v[36:39], v[68:71]
    buffer_load_dwordx4 v5, s[12:15], s57 offen offset:1024 lds
    v_mfma_f32_16x16x32_bf16 v[72:75], a[232:235], v[36:39], v[72:75]
    s_xor_b32 s55, s52, 3
    s_add_u32 s55, s55, s4
    s_add_u32 s50, s50, 66560
    v_lshl_add_u32 v6, v13, 2, s50
    v_mfma_f32_16x16x32_bf16 v[76:79], a[236:239], v[36:39], v[76:79]
    s_and_b32 s55, s55, 7
    s_add_u32 m0, s53, 122880
    v_lshl_add_u32 v9, v8, 4, s50
    s_lshl_b32 s51, s94, 4
    v_mfma_f32_16x16x32_bf16 v[84:87], v[104:107], v[36:39], v[84:87]
    s_mul_i32 s55, s55, 196608
    s_add_u32 s57, s55, 97280
    s_lshl_b32 s62, s94, 7
    s_add_u32 s50, s50, s62
    s_waitcnt lgkmcnt(0)
    v_mfma_f32_16x16x32_bf16 v[92:95], a[248:251], a[248:251], v[92:95]
    buffer_load_dwordx4 v5, s[12:15], s55 offen lds
    v_mfma_f32_16x16x32_bf16 v[100:103], v[104:107], a[248:251], v[100:103]
    v_xor_b32 v10, s51, v11
    v_lshl_add_u32 v10, v10, 2, s50
    v_mfma_f32_16x16x32_bf16 v[48:51], v[40:43], a[240:243], v[48:51]
    v_mov_b32 v7, 0x3727c5ac
    v_mfma_f32_16x16x32_bf16 v[52:55], v[40:43], a[244:247], v[52:55]
    v_mfma_f32_16x16x32_bf16 v[56:59], v[40:43], a[248:251], v[56:59]
    buffer_load_dwordx4 v5, s[12:15], s57 offen offset:1024 lds
    v_mfma_f32_16x16x32_bf16 v[60:63], v[40:43], a[252:255], v[60:63]
    s_xor_b32 s55, s52, 5
    s_add_u32 s55, s55, s4
    v_cndmask_b32 v88, v88, v89, s[96:97]
    v_cndmask_b32 v90, v90, v91, s[96:97]
    v_mfma_f32_16x16x32_bf16 v[80:83], v[40:43], v[104:107], v[80:83]
    s_and_b32 s55, s55, 7
    s_add_u32 m0, s53, 139264
    v_cndmask_b32 v97, v88, v90, s[98:99]
    v_cndmask_b32 v92, v92, v93, s[96:97]
    v_mfma_f32_16x16x32_bf16 v[64:67], a[240:243], v[44:47], v[64:67]
    s_mul_i32 s55, s55, 196608
    s_add_u32 s57, s55, 97280
    v_cndmask_b32 v94, v94, v95, s[96:97]
    v_cndmask_b32 v101, v92, v94, s[98:99]
    v_mfma_f32_16x16x32_bf16 v[68:71], a[244:247], v[44:47], v[68:71]
    buffer_load_dwordx4 v5, s[12:15], s55 offen lds
    v_mfma_f32_16x16x32_bf16 v[72:75], a[248:251], v[44:47], v[72:75]
    s_mov_b32 exec_lo, 0x00f0000f
    s_mov_b32 exec_hi, 0xf0000f00
    ds_write_b64 v14, v[96:97] offset:0
    ds_write_b64 v14, v[100:101] offset:256
    s_mov_b64 exec, -1
    v_mfma_f32_16x16x32_bf16 v[76:79], a[252:255], v[44:47], v[76:79]
    v_mfma_f32_16x16x32_bf16 v[84:87], v[104:107], v[44:47], v[84:87]
    s_waitcnt lgkmcnt(0)
    s_barrier
    ds_read_b64 v[32:33], v15 offset:0
    ds_read_b64 v[34:35], v15 offset:512
    ds_read_b64 v[36:37], v16 offset:0
    ds_read_b64 v[38:39], v16 offset:512
    ds_read_b64 v[40:41], v15 offset:256
    ds_read_b64 v[42:43], v15 offset:768
    ds_read_b64 v[44:45], v16 offset:256
    ds_read_b64 v[46:47], v16 offset:768
    buffer_load_dwordx4 v5, s[12:15], s57 offen offset:1024 lds
    s_waitcnt lgkmcnt(6)
    v_add_f32 v32, v32, v34
    v_add_f32 v33, v33, v35
    s_waitcnt lgkmcnt(4)
    v_add_f32 v36, v36, v38
    v_add_f32 v37, v37, v39
    s_waitcnt lgkmcnt(2)
    v_add_f32 v40, v40, v42
    v_add_f32 v41, v41, v43
    s_waitcnt lgkmcnt(0)
    s_xor_b32 s55, s52, 6
    s_add_u32 s55, s55, s4
    s_and_b32 s55, s55, 7
    s_add_u32 m0, s53, 147456
    s_mul_i32 s55, s55, 196608
    s_add_u32 s57, s55, 97280
    buffer_load_dwordx4 v5, s[12:15], s55 offen lds
    v_add_f32 v44, v44, v46
    v_add_f32 v45, v45, v47
    v_mul_f32 v20, 0xbb000000, v32
    v_mul_f32 v21, 0xbb000000, v36
    v_mul_f32 v22, 0xbb000000, v40
    v_mul_f32 v23, 0xbb000000, v44
    v_mul_f32 v33, 0x3b000000, v33
    v_mul_f32 v37, 0x3b000000, v37
    v_mul_f32 v41, 0x3b000000, v41
    v_mul_f32 v45, 0x3b000000, v45
    buffer_load_dwordx4 v5, s[12:15], s57 offen offset:1024 lds
    v_fma_f32 v33, -v20, v20, v33
    v_fma_f32 v37, -v21, v21, v37
    v_fma_f32 v41, -v22, v22, v41
    v_fma_f32 v45, -v23, v23, v45
    v_max_f32 v33, 0, v33
    v_max_f32 v37, 0, v37
    v_max_f32 v41, 0, v41
    v_max_f32 v45, 0, v45
    v_add_f32 v33, v7, v33
    v_add_f32 v37, v7, v37
    v_add_f32 v41, v7, v41
    v_add_f32 v45, v7, v45
    v_rsq_f32 v24, v33
    v_rsq_f32 v25, v37
    v_rsq_f32 v26, v41
    v_rsq_f32 v27, v45
    ds_write2_b32 v6, v20, v24 offset0:0 offset1:64
    ds_write2_b32 v6, v21, v25 offset0:16 offset1:80
    ds_write2_b32 v6, v22, v26 offset0:32 offset1:96
    ds_write2_b32 v6, v23, v27 offset0:48 offset1:112
    ds_read_b128 v[32:35], v9 offset:0
    ds_read_b128 v[36:39], v9 offset:64
    ds_read_b128 v[40:43], v9 offset:128
    ds_read_b128 v[44:47], v9 offset:192
    ds_read_b128 v[88:91], v9 offset:256
    ds_read_b128 v[92:95], v9 offset:320
    ds_read_b128 v[96:99], v9 offset:384
    ds_read_b128 v[100:103], v9 offset:448
    ds_read_b32 v2, v10
    v_pk_fma_f32 v[48:49], v[20:21], v[80:81], v[48:49] op_sel:[0,0,0] op_sel_hi:[0,1,1]
    v_pk_fma_f32 v[50:51], v[20:21], v[82:83], v[50:51] op_sel:[0,0,0] op_sel_hi:[0,1,1]
    v_pk_fma_f32 v[52:53], v[20:21], v[80:81], v[52:53] op_sel:[1,0,0] op_sel_hi:[1,1,1]
    v_pk_fma_f32 v[54:55], v[20:21], v[82:83], v[54:55] op_sel:[1,0,0] op_sel_hi:[1,1,1]
    v_pk_mul_f32 v[48:49], v[24:25], v[48:49] op_sel:[0,0] op_sel_hi:[0,1]
    v_pk_mul_f32 v[50:51], v[24:25], v[50:51] op_sel:[0,0] op_sel_hi:[0,1]
    v_pk_mul_f32 v[52:53], v[24:25], v[52:53] op_sel:[1,0] op_sel_hi:[1,1]
    v_pk_mul_f32 v[54:55], v[24:25], v[54:55] op_sel:[1,0] op_sel_hi:[1,1]
    v_cvt_pk_bf16_f32 v240, v48, v49
    v_cvt_pk_bf16_f32 v241, v50, v51
    v_cvt_pk_bf16_f32 v242, v52, v53
    v_cvt_pk_bf16_f32 v243, v54, v55
    s_nop 0
    v_permlane16_swap_b32 v240, v242
    v_permlane16_swap_b32 v241, v243
    buffer_store_dwordx4 v[240:243], v1, s[44:47], s100 offen offset:0 sc1
    v_pk_fma_f32 v[56:57], v[22:23], v[80:81], v[56:57] op_sel:[0,0,0] op_sel_hi:[0,1,1]
    v_pk_fma_f32 v[58:59], v[22:23], v[82:83], v[58:59] op_sel:[0,0,0] op_sel_hi:[0,1,1]
    v_pk_fma_f32 v[60:61], v[22:23], v[80:81], v[60:61] op_sel:[1,0,0] op_sel_hi:[1,1,1]
    v_pk_fma_f32 v[62:63], v[22:23], v[82:83], v[62:63] op_sel:[1,0,0] op_sel_hi:[1,1,1]
    v_pk_mul_f32 v[56:57], v[26:27], v[56:57] op_sel:[0,0] op_sel_hi:[0,1]
    v_pk_mul_f32 v[58:59], v[26:27], v[58:59] op_sel:[0,0] op_sel_hi:[0,1]
    v_pk_mul_f32 v[60:61], v[26:27], v[60:61] op_sel:[1,0] op_sel_hi:[1,1]
    v_pk_mul_f32 v[62:63], v[26:27], v[62:63] op_sel:[1,0] op_sel_hi:[1,1]
    v_cvt_pk_bf16_f32 v244, v56, v57
    v_cvt_pk_bf16_f32 v245, v58, v59
    v_cvt_pk_bf16_f32 v246, v60, v61
    v_cvt_pk_bf16_f32 v247, v62, v63
    s_nop 0
    v_permlane16_swap_b32 v244, v246
    v_permlane16_swap_b32 v245, v247
    buffer_store_dwordx4 v[244:247], v1, s[44:47], s100 offen offset:2048 sc1
    s_lshl_b32 s50, s3, 11
    s_add_u32 s50, s50, 73728
    v_add_u32 v15, s50, v1
    s_waitcnt lgkmcnt(0)
    v_pk_fma_f32 v[64:65], v[32:33], v[84:85], v[64:65] op_sel:[0,0,0] op_sel_hi:[1,0,1]
    v_pk_fma_f32 v[66:67], v[34:35], v[84:85], v[66:67] op_sel:[0,0,0] op_sel_hi:[1,0,1]
    v_pk_fma_f32 v[68:69], v[36:37], v[84:85], v[68:69] op_sel:[0,0,0] op_sel_hi:[1,0,1]
    v_pk_fma_f32 v[70:71], v[38:39], v[84:85], v[70:71] op_sel:[0,0,0] op_sel_hi:[1,0,1]
    v_pk_mul_f32 v[64:65], v[88:89], v[64:65] op_sel:[0,0] op_sel_hi:[1,1]
    v_pk_mul_f32 v[66:67], v[90:91], v[66:67] op_sel:[0,0] op_sel_hi:[1,1]
    v_pk_mul_f32 v[68:69], v[92:93], v[68:69] op_sel:[0,0] op_sel_hi:[1,1]
    v_pk_mul_f32 v[70:71], v[94:95], v[70:71] op_sel:[0,0] op_sel_hi:[1,1]
    v_cvt_pk_bf16_f32 v64, v64, v65
    v_cvt_pk_bf16_f32 v65, v66, v67
    v_cvt_pk_bf16_f32 v66, v68, v69
    v_cvt_pk_bf16_f32 v67, v70, v71
    s_nop 0
    v_permlane32_swap_b32 v64, v66
    v_permlane32_swap_b32 v65, v67
    buffer_store_dwordx4 v[64:67], v1, s[44:47], s100 offen offset:1024 sc1
    ds_write_b128 v15, v[64:67] offset:0
    v_pk_fma_f32 v[72:73], v[40:41], v[84:85], v[72:73] op_sel:[0,0,0] op_sel_hi:[1,0,1]
    v_pk_fma_f32 v[74:75], v[42:43], v[84:85], v[74:75] op_sel:[0,0,0] op_sel_hi:[1,0,1]
    v_pk_fma_f32 v[76:77], v[44:45], v[84:85], v[76:77] op_sel:[0,0,0] op_sel_hi:[1,0,1]
    v_pk_fma_f32 v[78:79], v[46:47], v[84:85], v[78:79] op_sel:[0,0,0] op_sel_hi:[1,0,1]
    v_pk_mul_f32 v[72:73], v[96:97], v[72:73] op_sel:[0,0] op_sel_hi:[1,1]
    v_pk_mul_f32 v[74:75], v[98:99], v[74:75] op_sel:[0,0] op_sel_hi:[1,1]
    v_pk_mul_f32 v[76:77], v[100:101], v[76:77] op_sel:[0,0] op_sel_hi:[1,1]
    v_pk_mul_f32 v[78:79], v[102:103], v[78:79] op_sel:[0,0] op_sel_hi:[1,1]
    v_cvt_pk_bf16_f32 v68, v72, v73
    v_cvt_pk_bf16_f32 v69, v74, v75
    v_cvt_pk_bf16_f32 v70, v76, v77
    v_cvt_pk_bf16_f32 v71, v78, v79
    s_nop 0
    v_permlane32_swap_b32 v68, v70
    v_permlane32_swap_b32 v69, v71
    buffer_store_dwordx4 v[68:71], v1, s[44:47], s100 offen offset:3072 sc1
    ds_write_b128 v15, v[68:71] offset:1024
    v_lshlrev_b32 v16, 4, v13
    v_lshl_add_u32 v16, v12, 8, v16
    v_add_u32 v15, s50, v16
    s_mov_b32 exec_lo, 0xffff
    s_mov_b32 exec_hi, 0xffff
    ds_read_b128 v[168:171], v15 offset:0
    ds_read_b128 v[172:175], v15 offset:512
    ds_read_b128 v[160:163], v15 offset:1024
    ds_read_b128 v[164:167], v15 offset:1536
    s_mov_b64 exec, -1
    s_lshl_b32 s50, s95, 10
    s_add_u32 s50, s50, 98304
    v_add_u32 v28, s50, v17
    v_xor_b32 v29, 1024, v28
    s_waitcnt vmcnt(4)
    s_barrier
    ds_read_b64_tr_b16 v[32:33], v28 offset:0
    ds_read_b64_tr_b16 v[34:35], v28 offset:4096
    ds_read_b64_tr_b16 v[36:37], v29 offset:0
    ds_read_b64_tr_b16 v[38:39], v29 offset:4096
    ds_read_b64_tr_b16 v[40:41], v28 offset:8192
    ds_read_b64_tr_b16 v[42:43], v28 offset:12288
    s_mov_b32 s50, 0
    s_lshl_b32 s55, s4, 5
L_s1n:
    v_readfirstlane_b32 s48, v124
    v_readfirstlane_b32 s49, v125
    v_readfirstlane_b32 s56, v126
    v_readfirstlane_b32 s57, v127
    s_nop 0
    s_lshr_b32 s51, s57, 26
    s_cmp_eq_u32 s51, 32
    s_cselect_b32 s51, s48, 0
    s_cmp_lg_u32 s51, 0
    s_cbranch_scc1 L_s1nd
    s_add_u32 s50, s50, 1
    s_cmp_gt_u32 s50, 65536
    s_cbranch_scc1 L_s1nd
    buffer_load_dwordx2 v[124:125], off, s[16:19], 0 sc1
    buffer_load_dwordx2 v[126:127], off, s[16:19], s55 offset:16 sc1
    s_waitcnt vmcnt(0)
    s_branch L_s1n
L_s1nd:
    s_mul_i32 s51, s23, 6
    s_lshr_b64 s[56:57], s[56:57], s51
    s_and_b32 s56, s56, 63
    s_cmp_lt_u32 s23, 8
    s_cselect_b32 s56, s56, 0
    s_cmp_lg_u32 s56, 32
    s_cselect_b32 s93, 1, 0
    s_waitcnt lgkmcnt(4)
    v_mfma_f32_16x16x32_bf16 v[48:51], v[32:35], a[0:3], 0
    v_dot2_f32_bf16 v84, v108, v104, 0
    v_dot2_f32_bf16 v85, v112, v104, 0
    v_mfma_f32_16x16x32_bf16 v[52:55], v[32:35], a[4:7], 0
    s_xor_b32 s55, s52, 7
    s_add_u32 s55, s55, s4
    s_and_b32 s55, s55, 7
    s_add_u32 m0, s53, 155648
    s_mul_i32 s55, s55, 196608
    s_add_u32 s57, s55, 97280
    buffer_load_dwordx4 v5, s[12:15], s55 offen lds
    v_mfma_f32_16x16x32_bf16 v[56:59], v[32:35], a[8:11], 0
    ds_read_b64_tr_b16 v[44:45], v29 offset:8192
    ds_read_b64_tr_b16 v[46:47], v29 offset:12288
    v_mfma_f32_16x16x32_bf16 v[60:63], v[32:35], a[12:15], 0
    buffer_load_dwordx4 v5, s[12:15], s57 offen offset:1024 lds
    v_mfma_f32_16x16x32_bf16 v[80:83], v[32:35], v[104:107], 0
    v_dot2_f32_bf16 v86, v116, v104, 0
    v_dot2_f32_bf16 v87, v120, v104, 0
    s_waitcnt lgkmcnt(4)
    v_mfma_f32_16x16x32_bf16 v[48:51], v[36:39], a[16:19], v[48:51]
    v_dot2_f32_bf16 v84, v109, v104, v84
    v_dot2_f32_bf16 v85, v113, v104, v85
    v_mfma_f32_16x16x32_bf16 v[52:55], v[36:39], a[20:23], v[52:55]
    s_xor_b32 s55, s6, 0
    s_lshr_b32 s56, s55, 1
    s_and_b32 s55, s55, 1
    s_lshl_b32 s56, s56, 3
    s_add_u32 s56, s56, s55
    s_lshl_b32 s55, s56, 15
    s_lshl_b32 s56, s56, 12
    s_add_u32 m0, s56, s58
    s_nop 0
    buffer_load_dwordx4 v19, s[24:27], s55 offen lds
    v_mfma_f32_16x16x32_bf16 v[56:59], v[36:39], a[24:27], v[56:59]
    ds_read_b64_tr_b16 v[32:33], v28 offset:16384
    ds_read_b64_tr_b16 v[34:35], v28 offset:20480
    v_mfma_f32_16x16x32_bf16 v[60:63], v[36:39], a[28:31], v[60:63]
    s_addk_i32 m0, 0x400
    s_addk_i32 s55, 0x2000
    buffer_load_dwordx4 v19, s[24:27], s55 offen lds
    v_mfma_f32_16x16x32_bf16 v[80:83], v[36:39], v[104:107], v[80:83]
    v_dot2_f32_bf16 v86, v117, v104, v86
    v_dot2_f32_bf16 v87, v121, v104, v87
    s_waitcnt lgkmcnt(4)
    v_mfma_f32_16x16x32_bf16 v[48:51], v[40:43], a[32:35], v[48:51]
    v_dot2_f32_bf16 v84, v110, v104, v84
    v_dot2_f32_bf16 v85, v114, v104, v85
    v_mfma_f32_16x16x32_bf16 v[52:55], v[40:43], a[36:39], v[52:55]
    s_addk_i32 m0, 0x400
    s_addk_i32 s55, 0x2000
    buffer_load_dwordx4 v19, s[24:27], s55 offen lds
    v_mfma_f32_16x16x32_bf16 v[56:59], v[40:43], a[40:43], v[56:59]
    ds_read_b64_tr_b16 v[36:37], v29 offset:16384
    ds_read_b64_tr_b16 v[38:39], v29 offset:20480
    v_mfma_f32_16x16x32_bf16 v[60:63], v[40:43], a[44:47], v[60:63]
    s_addk_i32 m0, 0x400
    s_addk_i32 s55, 0x2000
    buffer_load_dwordx4 v19, s[24:27], s55 offen lds
    v_mfma_f32_16x16x32_bf16 v[80:83], v[40:43], v[104:107], v[80:83]
    v_dot2_f32_bf16 v86, v118, v104, v86
    v_dot2_f32_bf16 v87, v122, v104, v87
    s_waitcnt lgkmcnt(4)
    v_mfma_f32_16x16x32_bf16 v[48:51], v[44:47], a[48:51], v[48:51]
    v_dot2_f32_bf16 v84, v111, v104, v84
    v_dot2_f32_bf16 v85, v115, v104, v85
    v_mfma_f32_16x16x32_bf16 v[52:55], v[44:47], a[52:55], v[52:55]
    s_xor_b32 s55, s6, 1
    s_lshr_b32 s56, s55, 1
    s_and_b32 s55, s55, 1
    s_lshl_b32 s56, s56, 3
    s_add_u32 s56, s56, s55
    s_lshl_b32 s55, s56, 15
    s_lshl_b32 s56, s56, 12
    s_add_u32 m0, s56, s58
    s_nop 0
    buffer_load_dwordx4 v19, s[24:27], s55 offen lds
    v_mfma_f32_16x16x32_bf16 v[56:59], v[44:47], a[56:59], v[56:59]
    ds_read_b64_tr_b16 v[40:41], v28 offset:24576
    ds_read_b64_tr_b16 v[42:43], v28 offset:28672
    v_mfma_f32_16x16x32_bf16 v[60:63], v[44:47], a[60:63], v[60:63]
    s_addk_i32 m0, 0x400
    s_addk_i32 s55, 0x2000
    buffer_load_dwordx4 v19, s[24:27], s55 offen lds
    v_mfma_f32_16x16x32_bf16 v[80:83], v[44:47], v[104:107], v[80:83]
    v_dot2_f32_bf16 v86, v119, v104, v86
    v_dot2_f32_bf16 v87, v123, v104, v87
    s_waitcnt lgkmcnt(4)
    v_mfma_f32_16x16x32_bf16 v[48:51], v[32:35], a[64:67], v[48:51]
    v_mov_b32 v124, s48
    v_mov_b32 v125, s49
    v_mfma_f32_16x16x32_bf16 v[52:55], v[32:35], a[68:71], v[52:55]
    s_addk_i32 m0, 0x400
    s_addk_i32 s55, 0x2000
    buffer_load_dwordx4 v19, s[24:27], s55 offen lds
    v_mfma_f32_16x16x32_bf16 v[56:59], v[32:35], a[72:75], v[56:59]
    ds_read_b64_tr_b16 v[44:45], v29 offset:24576
    ds_read_b64_tr_b16 v[46:47], v29 offset:28672
    v_mfma_f32_16x16x32_bf16 v[60:63], v[32:35], a[76:79], v[60:63]
    s_addk_i32 m0, 0x400
    s_addk_i32 s55, 0x2000
    buffer_load_dwordx4 v19, s[24:27], s55 offen lds
    v_mfma_f32_16x16x32_bf16 v[80:83], v[32:35], v[104:107], v[80:83]
    v_add_u32 v14, s54, v0
    v_add_f32_dpp v84, v84, v84 row_shr:1 bound_ctrl:0
    s_waitcnt lgkmcnt(4)
    v_mfma_f32_16x16x32_bf16 v[48:51], v[36:39], a[80:83], v[48:51]
    v_add_f32_dpp v85, v85, v85 row_shr:1 bound_ctrl:0
    v_add_f32_dpp v86, v86, v86 row_shr:1 bound_ctrl:0
    v_mfma_f32_16x16x32_bf16 v[52:55], v[36:39], a[84:87], v[52:55]
    s_xor_b32 s55, s6, 2
    s_lshr_b32 s56, s55, 1
    s_and_b32 s55, s55, 1
    s_lshl_b32 s56, s56, 3
    s_add_u32 s56, s56, s55
    s_lshl_b32 s55, s56, 15
    s_lshl_b32 s56, s56, 12
    s_add_u32 m0, s56, s58
    s_nop 0
    buffer_load_dwordx4 v19, s[24:27], s55 offen lds
    v_mfma_f32_16x16x32_bf16 v[56:59], v[36:39], a[88:91], v[56:59]
    ds_read_b64_tr_b16 v[32:33], v28 offset:32768
    ds_read_b64_tr_b16 v[34:35], v28 offset:36864
    v_mfma_f32_16x16x32_bf16 v[60:63], v[36:39], a[92:95], v[60:63]
    s_addk_i32 m0, 0x400
    s_addk_i32 s55, 0x2000
    buffer_load_dwordx4 v19, s[24:27], s55 offen lds
    v_mfma_f32_16x16x32_bf16 v[80:83], v[36:39], v[104:107], v[80:83]
    v_add_f32_dpp v87, v87, v87 row_shr:1 bound_ctrl:0
    v_add_f32_dpp v84, v84, v84 row_shr:2 bound_ctrl:0
    s_waitcnt lgkmcnt(4)
    v_mfma_f32_16x16x32_bf16 v[48:51], v[40:43], a[96:99], v[48:51]
    v_add_f32_dpp v85, v85, v85 row_shr:2 bound_ctrl:0
    v_add_f32_dpp v86, v86, v86 row_shr:2 bound_ctrl:0
    v_mfma_f32_16x16x32_bf16 v[52:55], v[40:43], a[100:103], v[52:55]
    s_addk_i32 m0, 0x400
    s_addk_i32 s55, 0x2000
    buffer_load_dwordx4 v19, s[24:27], s55 offen lds
    v_mfma_f32_16x16x32_bf16 v[56:59], v[40:43], a[104:107], v[56:59]
    ds_read_b64_tr_b16 v[36:37], v29 offset:32768
    ds_read_b64_tr_b16 v[38:39], v29 offset:36864
    v_mfma_f32_16x16x32_bf16 v[60:63], v[40:43], a[108:111], v[60:63]
    s_addk_i32 m0, 0x400
    s_addk_i32 s55, 0x2000
    buffer_load_dwordx4 v19, s[24:27], s55 offen lds
    v_mfma_f32_16x16x32_bf16 v[80:83], v[40:43], v[104:107], v[80:83]
    v_add_f32_dpp v87, v87, v87 row_shr:2 bound_ctrl:0
    v_add_f32_dpp v84, v84, v84 row_shr:4 bound_ctrl:0
    s_waitcnt lgkmcnt(4)
    v_mfma_f32_16x16x32_bf16 v[48:51], v[44:47], a[112:115], v[48:51]
    v_add_f32_dpp v85, v85, v85 row_shr:4 bound_ctrl:0
    v_add_f32_dpp v86, v86, v86 row_shr:4 bound_ctrl:0
    v_mfma_f32_16x16x32_bf16 v[52:55], v[44:47], a[116:119], v[52:55]
    s_xor_b32 s55, s6, 3
    s_lshr_b32 s56, s55, 1
    s_and_b32 s55, s55, 1
    s_lshl_b32 s56, s56, 3
    s_add_u32 s56, s56, s55
    s_lshl_b32 s55, s56, 15
    s_lshl_b32 s56, s56, 12
    s_add_u32 m0, s56, s58
    s_nop 0
    buffer_load_dwordx4 v19, s[24:27], s55 offen lds
    v_mfma_f32_16x16x32_bf16 v[56:59], v[44:47], a[120:123], v[56:59]
    ds_read_b64_tr_b16 v[40:41], v28 offset:40960
    ds_read_b64_tr_b16 v[42:43], v28 offset:45056
    v_mfma_f32_16x16x32_bf16 v[60:63], v[44:47], a[124:127], v[60:63]
    s_addk_i32 m0, 0x400
    s_addk_i32 s55, 0x2000
    buffer_load_dwordx4 v19, s[24:27], s55 offen lds
    v_mfma_f32_16x16x32_bf16 v[80:83], v[44:47], v[104:107], v[80:83]
    v_add_f32_dpp v87, v87, v87 row_shr:4 bound_ctrl:0
    v_add_f32_dpp v84, v84, v84 row_shr:8 bound_ctrl:0
    s_waitcnt lgkmcnt(4)
    v_mfma_f32_16x16x32_bf16 v[48:51], v[32:35], a[128:131], v[48:51]
    v_add_f32_dpp v85, v85, v85 row_shr:8 bound_ctrl:0
    v_add_f32_dpp v86, v86, v86 row_shr:8 bound_ctrl:0
    v_mfma_f32_16x16x32_bf16 v[52:55], v[32:35], a[132:135], v[52:55]
    s_addk_i32 m0, 0x400
    s_addk_i32 s55, 0x2000
    buffer_load_dwordx4 v19, s[24:27], s55 offen lds
    v_mfma_f32_16x16x32_bf16 v[56:59], v[32:35], a[136:139], v[56:59]
    ds_read_b64_tr_b16 v[44:45], v29 offset:40960
    ds_read_b64_tr_b16 v[46:47], v29 offset:45056
    v_mfma_f32_16x16x32_bf16 v[60:63], v[32:35], a[140:143], v[60:63]
    s_addk_i32 m0, 0x400
    s_addk_i32 s55, 0x2000
    buffer_load_dwordx4 v19, s[24:27], s55 offen lds
    v_mfma_f32_16x16x32_bf16 v[80:83], v[32:35], v[104:107], v[80:83]
    v_add_f32_dpp v87, v87, v87 row_shr:8 bound_ctrl:0
    v_add_f32_dpp v84, v84, v84 row_bcast:15 row_mask:0xa
    s_waitcnt lgkmcnt(4)
    v_mfma_f32_16x16x32_bf16 v[48:51], v[36:39], a[144:147], v[48:51]
    v_add_f32_dpp v85, v85, v85 row_bcast:15 row_mask:0xa
    v_add_f32_dpp v86, v86, v86 row_bcast:15 row_mask:0xa
    v_mfma_f32_16x16x32_bf16 v[52:55], v[36:39], a[148:151], v[52:55]
    s_add_u32 m0, s53, 65536
    s_xor_b32 s63, s2, 0
    s_mul_i32 s63, s63, 114688
    buffer_load_dwordx4 v248, s[28:31], s63 offen lds
    v_mfma_f32_16x16x32_bf16 v[56:59], v[36:39], a[152:155], v[56:59]
    ds_read_b64_tr_b16 v[32:33], v28 offset:49152
    ds_read_b64_tr_b16 v[34:35], v28 offset:53248
    v_mfma_f32_16x16x32_bf16 v[60:63], v[36:39], a[156:159], v[60:63]
    v_add_f32_dpp v87, v87, v87 row_bcast:15 row_mask:0xa
    v_add_f32_dpp v84, v84, v84 row_bcast:31 row_mask:0xc
    v_mfma_f32_16x16x32_bf16 v[80:83], v[36:39], v[104:107], v[80:83]
    v_add_f32_dpp v85, v85, v85 row_bcast:31 row_mask:0xc
    v_add_f32_dpp v86, v86, v86 row_bcast:31 row_mask:0xc
    s_waitcnt lgkmcnt(4)
    v_add_f32_dpp v87, v87, v87 row_bcast:31 row_mask:0xc
    v_mul_f32 v84, 0x3b000000, v84
    v_mul_f32 v85, 0x3b000000, v85
    v_mul_f32 v86, 0x3b000000, v86
    v_mul_f32 v87, 0x3b000000, v87
    v_cvt_pk_bf16_f32 v84, v84, v85
    v_cvt_pk_bf16_f32 v85, v86, v87
    v_add_u32 v14, 1, v14
    v_bfe_u32 v15, v14, 2, 3
    v_and_b32 v14, 3, v14
    v_readlane_b32 s96, v84, 63
    v_readlane_b32 s97, v85, 63
    v_lshlrev_b32 v15, 21, v15
    v_lshl_add_u32 v14, v14, 12, v15
    s_lshl_b32 s98, s7, 9
    s_lshl_b32 s99, s3, 7
    s_add_u32 s98, s98, s99
    s_add_u32 s98, s98, 0x1ec000
    s_lshl_b32 s99, s6, 4
    s_add_u32 s99, s99, s98
    s_add_u32 s99, s99, 0x200000
    v_mov_b32 v126, s96
    v_mov_b32 v127, s97
    s_lshl_b32 s101, s6, 12
    s_add_u32 s101, s101, s98
    s_add_u32 s101, s101, s60
    s_waitcnt vmcnt(19)
    s_mov_b64 exec, 15
    buffer_store_dwordx4 v[124:127], v14, s[44:47], s99 offen sc1
    s_mov_b64 exec, -1
    v_mfma_f32_16x16x32_bf16 v[48:51], v[40:43], a[160:163], v[48:51]
    v_lshlrev_b32 v31, 10, v11
    v_lshl_add_u32 v31, v12, 3, v31
    v_mfma_f32_16x16x32_bf16 v[52:55], v[40:43], a[164:167], v[52:55]
    ds_read_b64_tr_b16 v[36:37], v29 offset:49152
    ds_read_b64_tr_b16 v[38:39], v29 offset:53248
    v_mfma_f32_16x16x32_bf16 v[56:59], v[40:43], a[168:171], v[56:59]
    s_lshl_b32 s96, s4, 18
    s_lshl_b32 s97, s61, 15
    v_mfma_f32_16x16x32_bf16 v[60:63], v[40:43], a[172:175], v[60:63]
    s_add_u32 s96, s96, s97
    s_lshl_b32 s97, s7, 7
    v_mfma_f32_16x16x32_bf16 v[80:83], v[40:43], v[104:107], v[80:83]
    s_add_u32 s59, s96, s97
    s_lshl_b32 s97, s95, 6
    s_waitcnt lgkmcnt(4)
    v_mfma_f32_16x16x32_bf16 v[48:51], v[44:47], a[176:179], v[48:51]
    s_waitcnt vmcnt(18)
    s_barrier
    s_add_u32 s96, s59, s97
    buffer_load_dwordx2 a[128:129], v31, s[8:11], s96 offen offset:0
    v_mfma_f32_16x16x32_bf16 v[52:55], v[44:47], a[180:183], v[52:55]
    ds_read_b64_tr_b16 v[40:41], v28 offset:57344
    ds_read_b64_tr_b16 v[42:43], v28 offset:61440
    v_mfma_f32_16x16x32_bf16 v[56:59], v[44:47], a[184:187], v[56:59]
    buffer_load_dwordx2 a[130:131], v31, s[8:11], s96 offen offset:16
    buffer_load_dwordx2 a[132:133], v31, s[8:11], s96 offen offset:32
    v_mfma_f32_16x16x32_bf16 v[60:63], v[44:47], a[188:191], v[60:63]
    buffer_load_dwordx2 a[134:135], v31, s[8:11], s96 offen offset:48
    v_mfma_f32_16x16x32_bf16 v[80:83], v[44:47], v[104:107], v[80:83]
    s_waitcnt lgkmcnt(4)
    v_mfma_f32_16x16x32_bf16 v[48:51], v[32:35], a[192:195], v[48:51]
    v_mfma_f32_16x16x32_bf16 v[52:55], v[32:35], a[196:199], v[52:55]
    s_add_u32 m0, s53, 66560
    s_nop 0
    buffer_load_dwordx4 v248, s[32:35], s63 offen lds
    v_mfma_f32_16x16x32_bf16 v[56:59], v[32:35], a[200:203], v[56:59]
    ds_read_b64_tr_b16 v[44:45], v29 offset:57344
    ds_read_b64_tr_b16 v[46:47], v29 offset:61440
    v_mfma_f32_16x16x32_bf16 v[60:63], v[32:35], a[204:207], v[60:63]
    v_mfma_f32_16x16x32_bf16 v[80:83], v[32:35], v[104:107], v[80:83]
    s_waitcnt lgkmcnt(4)
    v_mfma_f32_16x16x32_bf16 v[48:51], v[36:39], a[208:211], v[48:51]
    v_mfma_f32_16x16x32_bf16 v[52:55], v[36:39], a[212:215], v[52:55]
    v_mfma_f32_16x16x32_bf16 v[56:59], v[36:39], a[216:219], v[56:59]
    v_mfma_f32_16x16x32_bf16 v[60:63], v[36:39], a[220:223], v[60:63]
    v_mfma_f32_16x16x32_bf16 v[80:83], v[36:39], v[104:107], v[80:83]
    s_waitcnt lgkmcnt(2)
    v_mfma_f32_16x16x32_bf16 v[48:51], v[40:43], a[224:227], v[48:51]
    v_mfma_f32_16x16x32_bf16 v[52:55], v[40:43], a[228:231], v[52:55]
    v_mfma_f32_16x16x32_bf16 v[56:59], v[40:43], a[232:235], v[56:59]
    v_mfma_f32_16x16x32_bf16 v[60:63], v[40:43], a[236:239], v[60:63]
    v_mfma_f32_16x16x32_bf16 v[80:83], v[40:43], v[104:107], v[80:83]
    s_waitcnt lgkmcnt(0)
    s_lshl_b32 s50, s4, 5
    s_add_u32 s50, s50, s5
    s_lshl_b32 s50, s50, 2
    s_add_u32 s50, s50, s3
    s_mul_i32 s50, s50, 1792
    v_lshlrev_b32 v30, 7, v0
    s_mov_b64 exec, 0x3fff
    buffer_load_dword v250, v30, s[36:39], s50 offen
    s_mov_b64 exec, -1
    v_mfma_f32_16x16x32_bf16 v[48:51], v[44:47], a[240:243], v[48:51]
    v_mfma_f32_16x16x32_bf16 v[52:55], v[44:47], a[244:247], v[52:55]
    v_mfma_f32_16x16x32_bf16 v[56:59], v[44:47], a[248:251], v[56:59]
    v_mfma_f32_16x16x32_bf16 v[60:63], v[44:47], a[252:255], v[60:63]
    v_mfma_f32_16x16x32_bf16 v[80:83], v[44:47], v[104:107], v[80:83]
    s_buffer_load_dwordx16 s[8:23], s[44:47], s101 glc
    v_mul_f32 v24, 0x3eb8aa3b, v24
    v_mul_f32 v25, 0x3eb8aa3b, v25
    v_mul_f32 v26, 0x3eb8aa3b, v26
    v_mul_f32 v27, 0x3eb8aa3b, v27
    s_nop 2
    v_pk_fma_f32 v[48:49], v[20:21], v[80:81], v[48:49] op_sel:[0,0,0] op_sel_hi:[0,1,1]
    v_pk_fma_f32 v[50:51], v[20:21], v[82:83], v[50:51] op_sel:[0,0,0] op_sel_hi:[0,1,1]
    v_pk_fma_f32 v[52:53], v[20:21], v[80:81], v[52:53] op_sel:[1,0,0] op_sel_hi:[1,1,1]
    v_pk_fma_f32 v[54:55], v[20:21], v[82:83], v[54:55] op_sel:[1,0,0] op_sel_hi:[1,1,1]
    v_pk_mul_f32 v[48:49], v[24:25], v[48:49] op_sel:[0,0] op_sel_hi:[0,1]
    v_pk_mul_f32 v[50:51], v[24:25], v[50:51] op_sel:[0,0] op_sel_hi:[0,1]
    v_pk_mul_f32 v[52:53], v[24:25], v[52:53] op_sel:[1,0] op_sel_hi:[1,1]
    v_pk_mul_f32 v[54:55], v[24:25], v[54:55] op_sel:[1,0] op_sel_hi:[1,1]
    v_cvt_pk_bf16_f32 v112, v48, v49
    v_cvt_pk_bf16_f32 v113, v50, v51
    v_cvt_pk_bf16_f32 v114, v52, v53
    v_cvt_pk_bf16_f32 v115, v54, v55
    s_nop 0
    v_permlane16_swap_b32 v112, v114
    v_permlane16_swap_b32 v113, v115
    v_pk_fma_f32 v[56:57], v[22:23], v[80:81], v[56:57] op_sel:[0,0,0] op_sel_hi:[0,1,1]
    v_pk_fma_f32 v[58:59], v[22:23], v[82:83], v[58:59] op_sel:[0,0,0] op_sel_hi:[0,1,1]
    v_pk_fma_f32 v[60:61], v[22:23], v[80:81], v[60:61] op_sel:[1,0,0] op_sel_hi:[1,1,1]
    v_pk_fma_f32 v[62:63], v[22:23], v[82:83], v[62:63] op_sel:[1,0,0] op_sel_hi:[1,1,1]
    v_pk_mul_f32 v[56:57], v[26:27], v[56:57] op_sel:[0,0] op_sel_hi:[0,1]
    v_pk_mul_f32 v[58:59], v[26:27], v[58:59] op_sel:[0,0] op_sel_hi:[0,1]
    v_pk_mul_f32 v[60:61], v[26:27], v[60:61] op_sel:[1,0] op_sel_hi:[1,1]
    v_pk_mul_f32 v[62:63], v[26:27], v[62:63] op_sel:[1,0] op_sel_hi:[1,1]
    v_cvt_pk_bf16_f32 v116, v56, v57
    v_cvt_pk_bf16_f32 v117, v58, v59
    v_cvt_pk_bf16_f32 v118, v60, v61
    v_cvt_pk_bf16_f32 v119, v62, v63
    s_nop 0
    v_permlane16_swap_b32 v116, v118
    v_permlane16_swap_b32 v117, v119
    s_sub_u32 s50, s98, 0x1ec000
    s_lshl_b32 s50, s50, 5
    s_add_u32 s50, s50, 0x200000
    s_sub_u32 s51, s54, 1
    s_cselect_b32 s55, 0x40000000, s50
    s_and_b32 s51, s51, 31
    s_lshr_b32 s56, s51, 2
    s_lshl_b32 s56, s56, 21
    s_and_b32 s51, s51, 3
    s_lshl_b32 s51, s51, 17
    s_add_u32 s51, s51, s56
    s_add_u32 s96, s51, s55
    s_sub_u32 s51, s54, 2
    s_cselect_b32 s55, 0x40000000, s50
    s_and_b32 s51, s51, 31
    s_lshr_b32 s56, s51, 2
    s_lshl_b32 s56, s56, 21
    s_and_b32 s51, s51, 3
    s_lshl_b32 s51, s51, 17
    s_add_u32 s51, s51, s56
    s_add_u32 s97, s51, s55
    s_sub_u32 s51, s54, 3
    s_cselect_b32 s55, 0x40000000, s50
    s_and_b32 s51, s51, 31
    s_lshr_b32 s56, s51, 2
    s_lshl_b32 s56, s56, 21
    s_and_b32 s51, s51, 3
    s_lshl_b32 s51, s51, 17
    s_add_u32 s51, s51, s56
    s_add_u32 s98, s51, s55
    s_sub_u32 s51, s54, 4
    s_cselect_b32 s55, 0x40000000, s50
    s_and_b32 s51, s51, 31
    s_lshr_b32 s56, s51, 2
    s_lshl_b32 s56, s56, 21
    s_and_b32 s51, s51, 3
    s_lshl_b32 s51, s51, 17
    s_add_u32 s51, s51, s56
    s_add_u32 s99, s51, s55
    s_mov_b32 s56, 0xffff
    s_mov_b32 s57, 0xffff
    v_mfma_f32_32x32x16_bf16 v[48:63], v[240:243], v[112:115], v[128:143]
    v_mfma_f32_32x32x16_bf16 v[64:79], v[244:247], v[116:119], v[128:143]
    s_nop 10
    v_exp_f32 v48, v48
    v_exp_f32 v49, v49
    v_exp_f32 v50, v50
    v_exp_f32 v51, v51
    v_cvt_pk_bf16_f32 v32, v48, v49
    v_exp_f32 v52, v52
    v_exp_f32 v53, v53
    v_cvt_pk_bf16_f32 v33, v50, v51
    v_exp_f32 v54, v54
    v_exp_f32 v55, v55
    v_cvt_pk_bf16_f32 v34, v52, v53
    v_exp_f32 v56, v56
    v_exp_f32 v57, v57
    v_cvt_pk_bf16_f32 v35, v54, v55
    v_exp_f32 v58, v58
    v_exp_f32 v59, v59
    v_cvt_pk_bf16_f32 v36, v56, v57
    v_exp_f32 v60, v60
    v_exp_f32 v61, v61
    v_cvt_pk_bf16_f32 v37, v58, v59
    v_exp_f32 v62, v62
    v_exp_f32 v63, v63
    v_cvt_pk_bf16_f32 v38, v60, v61
    v_cvt_pk_bf16_f32 v39, v62, v63
    v_mfma_f32_32x32x16_bf16 v[48:63], v[240:243], v[116:119], 0
    v_exp_f32 v64, v64
    v_exp_f32 v65, v65
    v_exp_f32 v66, v66
    v_exp_f32 v67, v67
    v_cvt_pk_bf16_f32 v40, v64, v65
    v_exp_f32 v68, v68
    v_exp_f32 v69, v69
    v_cvt_pk_bf16_f32 v41, v66, v67
    v_mfma_f32_32x32x16_bf16 v[80:95], v[168:171], v[32:35], 0
    v_exp_f32 v70, v70
    v_exp_f32 v71, v71
    v_cvt_pk_bf16_f32 v42, v68, v69
    v_exp_f32 v72, v72
    v_exp_f32 v73, v73
    v_cvt_pk_bf16_f32 v43, v70, v71
    v_exp_f32 v74, v74
    v_exp_f32 v75, v75
    v_mfma_f32_32x32x16_bf16 v[80:95], v[172:175], v[36:39], v[80:95]
    v_cvt_pk_bf16_f32 v44, v72, v73
    v_exp_f32 v76, v76
    v_exp_f32 v77, v77
    v_cvt_pk_bf16_f32 v45, v74, v75
    v_exp_f32 v78, v78
    v_exp_f32 v79, v79
    v_cvt_pk_bf16_f32 v46, v76, v77
    v_cvt_pk_bf16_f32 v47, v78, v79
    v_mfma_f32_32x32x16_bf16 v[96:111], v[160:163], v[40:43], 0
    s_buffer_load_dwordx16 s[8:23], s[44:47], s101 glc
    v_exp_f32 v48, v48
    v_exp_f32 v49, v49
    v_exp_f32 v50, v50
    v_exp_f32 v51, v51
    v_cvt_pk_bf16_f32 v32, v48, v49
    v_exp_f32 v52, v52
    v_exp_f32 v53, v53
    v_cvt_pk_bf16_f32 v33, v50, v51
    v_exp_f32 v54, v54
    v_exp_f32 v55, v55
    v_cvt_pk_bf16_f32 v34, v52, v53
    v_exp_f32 v56, v56
    v_mfma_f32_32x32x16_bf16 v[96:111], v[164:167], v[44:47], v[96:111]
    v_exp_f32 v57, v57
    v_cvt_pk_bf16_f32 v35, v54, v55
    v_exp_f32 v58, v58
    v_exp_f32 v59, v59
    v_cvt_pk_bf16_f32 v36, v56, v57
    v_exp_f32 v60, v60
    v_exp_f32 v61, v61
    v_cvt_pk_bf16_f32 v37, v58, v59
    v_exp_f32 v62, v62
    v_exp_f32 v63, v63
    v_cvt_pk_bf16_f32 v38, v60, v61
    v_cvt_pk_bf16_f32 v39, v62, v63
    v_mfma_f32_32x32x16_bf16 v[96:111], v[168:171], v[32:35], v[96:111]
    s_nop 0
    v_mfma_f32_32x32x16_bf16 v[96:111], v[172:175], v[36:39], v[96:111]
    s_mov_b32 s50, 0
L_kc:
    s_waitcnt lgkmcnt(0)
    s_cmp_eq_u64 s[8:9], s[48:49]
    s_cbranch_scc0 L_kr
    s_cmp_eq_u64 s[12:13], s[48:49]
    s_cbranch_scc0 L_kr
    s_cmp_eq_u64 s[16:17], s[48:49]
    s_cbranch_scc0 L_kr
    s_cmp_eq_u64 s[20:21], s[48:49]
    s_cbranch_scc1 L_kd
L_kr:
    s_add_u32 s50, s50, 1
    s_cmp_gt_u32 s50, 2048
    s_cbranch_scc1 L_kv
    s_buffer_load_dwordx16 s[8:23], s[44:47], s101 glc
    s_branch L_kc
L_kd:
    buffer_load_dwordx4 a[136:139], v1, s[44:47], s96 offen offset:2048 sc1
    s_mov_b64 exec, s[56:57]
    buffer_load_dwordx4 v[176:179], v16, s[44:47], s96 offen offset:3072 sc1
    buffer_load_dwordx4 v[180:183], v16, s[44:47], s96 offen offset:3584 sc1
    s_mov_b64 exec, -1
    buffer_load_dwordx4 a[140:143], v1, s[44:47], s96 offen offset:0 sc1
    s_mov_b64 exec, s[56:57]
    buffer_load_dwordx4 v[184:187], v16, s[44:47], s96 offen offset:1024 sc1
    buffer_load_dwordx4 v[188:191], v16, s[44:47], s96 offen offset:1536 sc1
    s_mov_b64 exec, -1
    buffer_load_dwordx4 a[144:147], v1, s[44:47], s97 offen offset:2048 sc1
    s_mov_b64 exec, s[56:57]
    buffer_load_dwordx4 v[192:195], v16, s[44:47], s97 offen offset:3072 sc1
    buffer_load_dwordx4 v[196:199], v16, s[44:47], s97 offen offset:3584 sc1
    s_mov_b64 exec, -1
    buffer_load_dwordx4 a[148:151], v1, s[44:47], s97 offen offset:0 sc1
    s_mov_b64 exec, s[56:57]
    buffer_load_dwordx4 v[200:203], v16, s[44:47], s97 offen offset:1024 sc1
    buffer_load_dwordx4 v[204:207], v16, s[44:47], s97 offen offset:1536 sc1
    s_mov_b64 exec, -1
    v_bfe_u32 v14, v0, 2, 2
    v_lshlrev_b32 v14, 7, v14
    v_bfe_u32 v15, v0, 4, 1
    v_lshl_add_u32 v14, v15, 5, v14
    v_and_b32 v15, 3, v0
    v_lshl_add_u32 v14, v15, 3, v14
    v_bfe_u32 v15, v0, 3, 1
    v_lshl_add_u32 v14, v15, 6, v14
    v_lshl_add_u32 v14, v12, 9, v14
    s_mul_i32 s50, s95, 0x8040
    v_xor_b32 v7, s50, v14
    v_xor_b32 v6, 64, v7
    v_mov_b32 v252, s10
    v_mov_b32 v253, s11
    v_mov_b32 v254, s18
    v_mov_b32 v255, s19
    s_mov_b32 exec_lo, 0
    v_mov_b32 v252, s14
    v_mov_b32 v253, s15
    v_mov_b32 v254, s22
    v_mov_b32 v255, s23
    s_mov_b32 exec_lo, -1
    s_waitcnt vmcnt(20)
    s_barrier
    ds_read_b64_tr_b16 a[0:1], v6 offset:0
    ds_read_b64_tr_b16 a[2:3], v6 offset:1024
    ds_read_b64_tr_b16 a[4:5], v7 offset:0
    ds_read_b64_tr_b16 a[6:7], v7 offset:1024
    ds_read_b64_tr_b16 a[8:9], v6 offset:2048
    ds_read_b64_tr_b16 a[10:11], v6 offset:3072
    ds_read_b64_tr_b16 a[12:13], v7 offset:2048
    ds_read_b64_tr_b16 a[14:15], v7 offset:3072
    ds_read_b64_tr_b16 a[16:17], v6 offset:4096
    ds_read_b64_tr_b16 a[18:19], v6 offset:5120
    ds_read_b64_tr_b16 a[20:21], v7 offset:4096
    ds_read_b64_tr_b16 a[22:23], v7 offset:5120
    ds_read_b64_tr_b16 a[24:25], v6 offset:6144
    ds_read_b64_tr_b16 a[26:27], v6 offset:7168
    ds_read_b64_tr_b16 a[28:29], v7 offset:6144
    ds_read_b64_tr_b16 a[30:31], v7 offset:7168
    ds_read_b64_tr_b16 a[32:33], v6 offset:8192
    ds_read_b64_tr_b16 a[34:35], v6 offset:9216
    ds_read_b64_tr_b16 a[36:37], v7 offset:8192
    ds_read_b64_tr_b16 a[38:39], v7 offset:9216
    ds_read_b64_tr_b16 a[40:41], v6 offset:10240
    ds_read_b64_tr_b16 a[42:43], v6 offset:11264
    ds_read_b64_tr_b16 a[44:45], v7 offset:10240
    ds_read_b64_tr_b16 a[46:47], v7 offset:11264
    ds_read_b64_tr_b16 a[48:49], v6 offset:12288
    ds_read_b64_tr_b16 a[50:51], v6 offset:13312
    ds_read_b64_tr_b16 a[52:53], v7 offset:12288
    ds_read_b64_tr_b16 a[54:55], v7 offset:13312
    ds_read_b64_tr_b16 a[56:57], v6 offset:14336
    ds_read_b64_tr_b16 a[58:59], v6 offset:15360
    ds_read_b64_tr_b16 a[60:61], v7 offset:14336
    ds_read_b64_tr_b16 a[62:63], v7 offset:15360
    s_waitcnt vmcnt(11)
    v_mfma_f32_32x32x16_bf16 v[48:63], a[136:139], v[116:119], 0
    v_mfma_f32_32x32x16_bf16 v[64:79], a[136:139], v[112:115], 0
    s_nop 10
    v_exp_f32 v48, v48
    v_exp_f32 v49, v49
    v_exp_f32 v50, v50
    buffer_load_dwordx4 a[152:155], v1, s[44:47], s98 offen offset:2048 sc1
    v_exp_f32 v51, v51
    v_cvt_pk_bf16_f32 v32, v48, v49
    v_exp_f32 v52, v52
    v_exp_f32 v53, v53
    v_cvt_pk_bf16_f32 v33, v50, v51
    v_exp_f32 v54, v54
    v_exp_f32 v55, v55
    v_cvt_pk_bf16_f32 v34, v52, v53
    v_exp_f32 v56, v56
    v_exp_f32 v57, v57
    v_cvt_pk_bf16_f32 v35, v54, v55
    v_exp_f32 v58, v58
    s_mov_b64 exec, s[56:57]
    buffer_load_dwordx4 v[208:211], v16, s[44:47], s98 offen offset:3072 sc1
    buffer_load_dwordx4 v[212:215], v16, s[44:47], s98 offen offset:3584 sc1
    s_mov_b64 exec, -1
    v_exp_f32 v59, v59
    v_cvt_pk_bf16_f32 v36, v56, v57
    v_exp_f32 v60, v60
    v_exp_f32 v61, v61
    v_cvt_pk_bf16_f32 v37, v58, v59
    v_exp_f32 v62, v62
    v_exp_f32 v63, v63
    v_cvt_pk_bf16_f32 v38, v60, v61
    v_cvt_pk_bf16_f32 v39, v62, v63
    s_waitcnt vmcnt(11)
    v_mfma_f32_32x32x16_bf16 v[48:63], a[140:143], v[116:119], 0
    v_exp_f32 v64, v64
    v_exp_f32 v65, v65
    v_exp_f32 v66, v66
    buffer_load_dwordx4 a[156:159], v1, s[44:47], s98 offen offset:0 sc1
    v_exp_f32 v67, v67
    v_cvt_pk_bf16_f32 v40, v64, v65
    v_exp_f32 v68, v68
    v_exp_f32 v69, v69
    v_cvt_pk_bf16_f32 v41, v66, v67
    v_mfma_f32_32x32x16_bf16 v[96:111], v[176:179], v[32:35], v[96:111]
    v_exp_f32 v70, v70
    v_exp_f32 v71, v71
    v_cvt_pk_bf16_f32 v42, v68, v69
    v_exp_f32 v72, v72
    v_exp_f32 v73, v73
    v_cvt_pk_bf16_f32 v43, v70, v71
    v_exp_f32 v74, v74
    s_mov_b64 exec, s[56:57]
    buffer_load_dwordx4 v[216:219], v16, s[44:47], s98 offen offset:1024 sc1
    buffer_load_dwordx4 v[220:223], v16, s[44:47], s98 offen offset:1536 sc1
    s_mov_b64 exec, -1
    v_exp_f32 v75, v75
    v_mfma_f32_32x32x16_bf16 v[96:111], v[180:183], v[36:39], v[96:111]
    v_cvt_pk_bf16_f32 v44, v72, v73
    v_exp_f32 v76, v76
    v_exp_f32 v77, v77
    v_cvt_pk_bf16_f32 v45, v74, v75
    v_exp_f32 v78, v78
    v_exp_f32 v79, v79
    v_cvt_pk_bf16_f32 v46, v76, v77
    v_cvt_pk_bf16_f32 v47, v78, v79
    v_mfma_f32_32x32x16_bf16 v[64:79], a[140:143], v[112:115], 0
    v_exp_f32 v48, v48
    v_exp_f32 v49, v49
    v_exp_f32 v50, v50
    buffer_load_dwordx4 a[160:163], v1, s[44:47], s99 offen offset:2048 sc1
    v_exp_f32 v51, v51
    v_cvt_pk_bf16_f32 v32, v48, v49
    v_exp_f32 v52, v52
    v_exp_f32 v53, v53
    v_cvt_pk_bf16_f32 v33, v50, v51
    v_mfma_f32_32x32x16_bf16 v[80:95], v[176:179], v[40:43], v[80:95]
    v_exp_f32 v54, v54
    v_exp_f32 v55, v55
    v_cvt_pk_bf16_f32 v34, v52, v53
    v_exp_f32 v56, v56
    v_exp_f32 v57, v57
    v_cvt_pk_bf16_f32 v35, v54, v55
    v_exp_f32 v58, v58
    s_mov_b64 exec, s[56:57]
    buffer_load_dwordx4 v[224:227], v16, s[44:47], s99 offen offset:3072 sc1
    buffer_load_dwordx4 v[228:231], v16, s[44:47], s99 offen offset:3584 sc1
    s_mov_b64 exec, -1
    v_exp_f32 v59, v59
    v_mfma_f32_32x32x16_bf16 v[80:95], v[180:183], v[44:47], v[80:95]
    v_cvt_pk_bf16_f32 v36, v56, v57
    v_exp_f32 v60, v60
    v_exp_f32 v61, v61
    v_cvt_pk_bf16_f32 v37, v58, v59
    v_exp_f32 v62, v62
    v_exp_f32 v63, v63
    v_cvt_pk_bf16_f32 v38, v60, v61
    v_cvt_pk_bf16_f32 v39, v62, v63
    s_waitcnt vmcnt(14)
    v_mfma_f32_32x32x16_bf16 v[48:63], a[144:147], v[116:119], 0
    v_exp_f32 v64, v64
    v_exp_f32 v65, v65
    v_exp_f32 v66, v66
    buffer_load_dwordx4 a[164:167], v1, s[44:47], s99 offen offset:0 sc1
    v_exp_f32 v67, v67
    v_cvt_pk_bf16_f32 v40, v64, v65
    v_exp_f32 v68, v68
    v_exp_f32 v69, v69
    v_cvt_pk_bf16_f32 v41, v66, v67
    v_mfma_f32_32x32x16_bf16 v[96:111], v[184:187], v[32:35], v[96:111]
    v_exp_f32 v70, v70
    v_exp_f32 v71, v71
    v_cvt_pk_bf16_f32 v42, v68, v69
    v_exp_f32 v72, v72
    v_exp_f32 v73, v73
    v_cvt_pk_bf16_f32 v43, v70, v71
    v_exp_f32 v74, v74
    s_mov_b64 exec, s[56:57]
    buffer_load_dwordx4 v[232:235], v16, s[44:47], s99 offen offset:1024 sc1
    buffer_load_dwordx4 v[236:239], v16, s[44:47], s99 offen offset:1536 sc1
    s_mov_b64 exec, -1
    v_exp_f32 v75, v75
    v_mfma_f32_32x32x16_bf16 v[96:111], v[188:191], v[36:39], v[96:111]
    v_cvt_pk_bf16_f32 v44, v72, v73
    v_exp_f32 v76, v76
    v_exp_f32 v77, v77
    v_cvt_pk_bf16_f32 v45, v74, v75
    v_exp_f32 v78, v78
    v_exp_f32 v79, v79
    v_cvt_pk_bf16_f32 v46, v76, v77
    v_cvt_pk_bf16_f32 v47, v78, v79
    v_mfma_f32_32x32x16_bf16 v[64:79], a[144:147], v[112:115], 0
    v_exp_f32 v48, v48
    v_exp_f32 v49, v49
    v_exp_f32 v50, v50
    s_add_u32 m0, s53, 73728
    s_xor_b32 s63, s2, 1
    s_mul_i32 s63, s63, 114688
    buffer_load_dwordx4 v248, s[28:31], s63 offen lds
    v_exp_f32 v51, v51
    v_cvt_pk_bf16_f32 v32, v48, v49
    v_exp_f32 v52, v52
    v_exp_f32 v53, v53
    v_cvt_pk_bf16_f32 v33, v50, v51
    v_mfma_f32_32x32x16_bf16 v[80:95], v[184:187], v[40:43], v[80:95]
    v_exp_f32 v54, v54
    v_exp_f32 v55, v55
    v_cvt_pk_bf16_f32 v34, v52, v53
    v_exp_f32 v56, v56
    v_exp_f32 v57, v57
    v_cvt_pk_bf16_f32 v35, v54, v55
    v_exp_f32 v58, v58
    s_add_u32 m0, s53, 74752
    s_nop 0
    buffer_load_dwordx4 v248, s[32:35], s63 offen lds
    v_exp_f32 v59, v59
    v_mfma_f32_32x32x16_bf16 v[80:95], v[188:191], v[44:47], v[80:95]
    v_cvt_pk_bf16_f32 v36, v56, v57
    v_exp_f32 v60, v60
    v_exp_f32 v61, v61
    v_cvt_pk_bf16_f32 v37, v58, v59
    v_exp_f32 v62, v62
    v_exp_f32 v63, v63
    v_cvt_pk_bf16_f32 v38, v60, v61
    v_cvt_pk_bf16_f32 v39, v62, v63
    s_waitcnt vmcnt(16)
    v_mfma_f32_32x32x16_bf16 v[48:63], a[148:151], v[116:119], 0
    v_exp_f32 v64, v64
    v_exp_f32 v65, v65
    v_exp_f32 v66, v66
    s_add_u32 m0, s53, 81920
    s_xor_b32 s63, s2, 2
    s_mul_i32 s63, s63, 114688
    buffer_load_dwordx4 v248, s[28:31], s63 offen lds
    v_exp_f32 v67, v67
    v_cvt_pk_bf16_f32 v40, v64, v65
    v_exp_f32 v68, v68
    v_exp_f32 v69, v69
    v_cvt_pk_bf16_f32 v41, v66, v67
    v_mfma_f32_32x32x16_bf16 v[96:111], v[192:195], v[32:35], v[96:111]
    v_exp_f32 v70, v70
    v_exp_f32 v71, v71
    v_cvt_pk_bf16_f32 v42, v68, v69
    v_exp_f32 v72, v72
    v_exp_f32 v73, v73
    v_cvt_pk_bf16_f32 v43, v70, v71
    v_exp_f32 v74, v74
    s_add_u32 m0, s53, 82944
    s_nop 0
    buffer_load_dwordx4 v248, s[32:35], s63 offen lds
    v_exp_f32 v75, v75
    v_mfma_f32_32x32x16_bf16 v[96:111], v[196:199], v[36:39], v[96:111]
    v_cvt_pk_bf16_f32 v44, v72, v73
    v_exp_f32 v76, v76
    v_exp_f32 v77, v77
    v_cvt_pk_bf16_f32 v45, v74, v75
    v_exp_f32 v78, v78
    v_exp_f32 v79, v79
    v_cvt_pk_bf16_f32 v46, v76, v77
    v_cvt_pk_bf16_f32 v47, v78, v79
    v_mfma_f32_32x32x16_bf16 v[64:79], a[148:151], v[112:115], 0
    v_exp_f32 v48, v48
    v_exp_f32 v49, v49
    v_exp_f32 v50, v50
    s_add_u32 m0, s53, 90112
    s_xor_b32 s63, s2, 3
    s_mul_i32 s63, s63, 114688
    buffer_load_dwordx4 v248, s[28:31], s63 offen lds
    v_exp_f32 v51, v51
    v_cvt_pk_bf16_f32 v32, v48, v49
    v_exp_f32 v52, v52
    v_exp_f32 v53, v53
    v_cvt_pk_bf16_f32 v33, v50, v51
    v_mfma_f32_32x32x16_bf16 v[80:95], v[192:195], v[40:43], v[80:95]
    v_exp_f32 v54, v54
    v_exp_f32 v55, v55
    v_cvt_pk_bf16_f32 v34, v52, v53
    v_exp_f32 v56, v56
    v_exp_f32 v57, v57
    v_cvt_pk_bf16_f32 v35, v54, v55
    v_exp_f32 v58, v58
    s_add_u32 m0, s53, 91136
    s_nop 0
    buffer_load_dwordx4 v248, s[32:35], s63 offen lds
    v_exp_f32 v59, v59
    v_mfma_f32_32x32x16_bf16 v[80:95], v[196:199], v[44:47], v[80:95]
    v_cvt_pk_bf16_f32 v36, v56, v57
    v_exp_f32 v60, v60
    v_exp_f32 v61, v61
    v_cvt_pk_bf16_f32 v37, v58, v59
    v_exp_f32 v62, v62
    v_exp_f32 v63, v63
    v_cvt_pk_bf16_f32 v38, v60, v61
    v_cvt_pk_bf16_f32 v39, v62, v63
    s_waitcnt vmcnt(17)
    v_mfma_f32_32x32x16_bf16 v[48:63], a[152:155], v[116:119], 0
    v_exp_f32 v64, v64
    v_exp_f32 v65, v65
    v_exp_f32 v66, v66
    s_add_u32 m0, s53, 98304
    s_xor_b32 s63, s2, 4
    s_mul_i32 s63, s63, 114688
    buffer_load_dwordx4 v248, s[28:31], s63 offen lds
    v_exp_f32 v67, v67
    v_cvt_pk_bf16_f32 v40, v64, v65
    v_exp_f32 v68, v68
    v_exp_f32 v69, v69
    v_cvt_pk_bf16_f32 v41, v66, v67
    v_mfma_f32_32x32x16_bf16 v[96:111], v[200:203], v[32:35], v[96:111]
    v_exp_f32 v70, v70
    v_exp_f32 v71, v71
    v_cvt_pk_bf16_f32 v42, v68, v69
    v_exp_f32 v72, v72
    v_exp_f32 v73, v73
    v_cvt_pk_bf16_f32 v43, v70, v71
    v_exp_f32 v74, v74
    s_add_u32 m0, s53, 99328
    s_nop 0
    buffer_load_dwordx4 v248, s[32:35], s63 offen lds
    v_exp_f32 v75, v75
    v_mfma_f32_32x32x16_bf16 v[96:111], v[204:207], v[36:39], v[96:111]
    v_cvt_pk_bf16_f32 v44, v72, v73
    v_exp_f32 v76, v76
    v_exp_f32 v77, v77
    v_cvt_pk_bf16_f32 v45, v74, v75
    v_exp_f32 v78, v78
    v_exp_f32 v79, v79
    v_cvt_pk_bf16_f32 v46, v76, v77
    v_cvt_pk_bf16_f32 v47, v78, v79
    v_mfma_f32_32x32x16_bf16 v[64:79], a[152:155], v[112:115], 0
    v_exp_f32 v48, v48
    v_exp_f32 v49, v49
    v_exp_f32 v50, v50
    s_add_u32 m0, s53, 106496
    s_xor_b32 s63, s2, 5
    s_mul_i32 s63, s63, 114688
    buffer_load_dwordx4 v248, s[28:31], s63 offen lds
    v_exp_f32 v51, v51
    v_cvt_pk_bf16_f32 v32, v48, v49
    v_exp_f32 v52, v52
    v_exp_f32 v53, v53
    v_cvt_pk_bf16_f32 v33, v50, v51
    v_mfma_f32_32x32x16_bf16 v[80:95], v[200:203], v[40:43], v[80:95]
    v_exp_f32 v54, v54
    v_exp_f32 v55, v55
    v_cvt_pk_bf16_f32 v34, v52, v53
    v_exp_f32 v56, v56
    v_exp_f32 v57, v57
    v_cvt_pk_bf16_f32 v35, v54, v55
    v_exp_f32 v58, v58
    s_add_u32 m0, s53, 107520
    s_nop 0
    buffer_load_dwordx4 v248, s[32:35], s63 offen lds
    v_exp_f32 v59, v59
    v_mfma_f32_32x32x16_bf16 v[80:95], v[204:207], v[44:47], v[80:95]
    v_cvt_pk_bf16_f32 v36, v56, v57
    v_exp_f32 v60, v60
    v_exp_f32 v61, v61
    v_cvt_pk_bf16_f32 v37, v58, v59
    v_exp_f32 v62, v62
    v_exp_f32 v63, v63
    v_cvt_pk_bf16_f32 v38, v60, v61
    v_cvt_pk_bf16_f32 v39, v62, v63
    s_waitcnt vmcnt(18)
    v_mfma_f32_32x32x16_bf16 v[48:63], a[156:159], v[116:119], 0
    v_exp_f32 v64, v64
    v_exp_f32 v65, v65
    v_exp_f32 v66, v66
    s_add_u32 m0, s53, 114688
    s_xor_b32 s63, s2, 6
    s_mul_i32 s63, s63, 114688
    buffer_load_dwordx4 v248, s[28:31], s63 offen lds
    v_exp_f32 v67, v67
    v_cvt_pk_bf16_f32 v40, v64, v65
    v_exp_f32 v68, v68
    v_exp_f32 v69, v69
    v_cvt_pk_bf16_f32 v41, v66, v67
    v_mfma_f32_32x32x16_bf16 v[96:111], v[208:211], v[32:35], v[96:111]
    v_exp_f32 v70, v70
    v_exp_f32 v71, v71
    v_cvt_pk_bf16_f32 v42, v68, v69
    v_exp_f32 v72, v72
    v_exp_f32 v73, v73
    v_cvt_pk_bf16_f32 v43, v70, v71
    v_exp_f32 v74, v74
    s_add_u32 m0, s53, 115712
    s_nop 0
    buffer_load_dwordx4 v248, s[32:35], s63 offen lds
    v_exp_f32 v75, v75
    v_mfma_f32_32x32x16_bf16 v[96:111], v[212:215], v[36:39], v[96:111]
    v_cvt_pk_bf16_f32 v44, v72, v73
    v_exp_f32 v76, v76
    v_exp_f32 v77, v77
    v_cvt_pk_bf16_f32 v45, v74, v75
    v_exp_f32 v78, v78
    v_exp_f32 v79, v79
    v_cvt_pk_bf16_f32 v46, v76, v77
    v_cvt_pk_bf16_f32 v47, v78, v79
    v_mfma_f32_32x32x16_bf16 v[64:79], a[156:159], v[112:115], 0
    v_exp_f32 v48, v48
    v_exp_f32 v49, v49
    v_exp_f32 v50, v50
    s_add_u32 m0, s53, 122880
    s_xor_b32 s63, s2, 7
    s_mul_i32 s63, s63, 114688
    buffer_load_dwordx4 v248, s[28:31], s63 offen lds
    v_exp_f32 v51, v51
    v_cvt_pk_bf16_f32 v32, v48, v49
    v_exp_f32 v52, v52
    v_exp_f32 v53, v53
    v_cvt_pk_bf16_f32 v33, v50, v51
    v_mfma_f32_32x32x16_bf16 v[80:95], v[208:211], v[40:43], v[80:95]
    v_exp_f32 v54, v54
    v_exp_f32 v55, v55
    v_cvt_pk_bf16_f32 v34, v52, v53
    v_exp_f32 v56, v56
    v_exp_f32 v57, v57
    v_cvt_pk_bf16_f32 v35, v54, v55
    v_exp_f32 v58, v58
    v_exp_f32 v59, v59
    v_mfma_f32_32x32x16_bf16 v[80:95], v[212:215], v[44:47], v[80:95]
    v_cvt_pk_bf16_f32 v36, v56, v57
    v_exp_f32 v60, v60
    v_exp_f32 v61, v61
    v_cvt_pk_bf16_f32 v37, v58, v59
    v_exp_f32 v62, v62
    v_exp_f32 v63, v63
    v_cvt_pk_bf16_f32 v38, v60, v61
    v_cvt_pk_bf16_f32 v39, v62, v63
    s_waitcnt vmcnt(18)
    v_mfma_f32_32x32x16_bf16 v[48:63], a[160:163], v[116:119], v[144:159]
    v_exp_f32 v64, v64
    v_exp_f32 v65, v65
    v_exp_f32 v66, v66
    s_add_u32 m0, s53, 123904
    s_nop 0
    buffer_load_dwordx4 v248, s[32:35], s63 offen lds
    v_exp_f32 v67, v67
    v_cvt_pk_bf16_f32 v40, v64, v65
    v_exp_f32 v68, v68
    v_exp_f32 v69, v69
    v_cvt_pk_bf16_f32 v41, v66, v67
    v_mfma_f32_32x32x16_bf16 v[96:111], v[216:219], v[32:35], v[96:111]
    v_exp_f32 v70, v70
    v_exp_f32 v71, v71
    v_cvt_pk_bf16_f32 v42, v68, v69
    v_exp_f32 v72, v72
    v_exp_f32 v73, v73
    v_cvt_pk_bf16_f32 v43, v70, v71
    v_exp_f32 v74, v74
    v_exp_f32 v75, v75
    v_mfma_f32_32x32x16_bf16 v[96:111], v[220:223], v[36:39], v[96:111]
    v_cvt_pk_bf16_f32 v44, v72, v73
    v_exp_f32 v76, v76
    v_exp_f32 v77, v77
    v_cvt_pk_bf16_f32 v45, v74, v75
    v_exp_f32 v78, v78
    v_exp_f32 v79, v79
    v_cvt_pk_bf16_f32 v46, v76, v77
    v_cvt_pk_bf16_f32 v47, v78, v79
    v_mfma_f32_32x32x16_bf16 v[64:79], a[160:163], v[112:115], 0
    v_exp_f32 v48, v48
    v_exp_f32 v49, v49
    v_exp_f32 v50, v50
    v_exp_f32 v51, v51
    v_cvt_pk_bf16_f32 v32, v48, v49
    v_exp_f32 v52, v52
    v_exp_f32 v53, v53
    v_cvt_pk_bf16_f32 v33, v50, v51
    v_mfma_f32_32x32x16_bf16 v[80:95], v[216:219], v[40:43], v[80:95]
    v_exp_f32 v54, v54
    v_exp_f32 v55, v55
    v_cvt_pk_bf16_f32 v34, v52, v53
    v_exp_f32 v56, v56
    v_exp_f32 v57, v57
    v_cvt_pk_bf16_f32 v35, v54, v55
    v_exp_f32 v58, v58
    v_exp_f32 v59, v59
    v_mfma_f32_32x32x16_bf16 v[80:95], v[220:223], v[44:47], v[80:95]
    v_cvt_pk_bf16_f32 v36, v56, v57
    v_exp_f32 v60, v60
    v_exp_f32 v61, v61
    v_cvt_pk_bf16_f32 v37, v58, v59
    v_exp_f32 v62, v62
    v_exp_f32 v63, v63
    v_cvt_pk_bf16_f32 v38, v60, v61
    v_cvt_pk_bf16_f32 v39, v62, v63
    s_waitcnt vmcnt(16)
    v_mfma_f32_32x32x16_bf16 v[48:63], a[164:167], v[112:115], v[144:159]
    v_exp_f32 v64, v64
    v_exp_f32 v65, v65
    v_exp_f32 v66, v66
    v_exp_f32 v67, v67
    v_cvt_pk_bf16_f32 v40, v64, v65
    v_exp_f32 v68, v68
    v_exp_f32 v69, v69
    v_cvt_pk_bf16_f32 v41, v66, v67
    v_mfma_f32_32x32x16_bf16 v[96:111], v[224:227], v[32:35], v[96:111]
    v_exp_f32 v70, v70
    v_exp_f32 v71, v71
    v_cvt_pk_bf16_f32 v42, v68, v69
    v_exp_f32 v72, v72
    v_exp_f32 v73, v73
    v_cvt_pk_bf16_f32 v43, v70, v71
    v_exp_f32 v74, v74
    v_exp_f32 v75, v75
    v_mfma_f32_32x32x16_bf16 v[96:111], v[228:231], v[36:39], v[96:111]
    v_cvt_pk_bf16_f32 v44, v72, v73
    v_exp_f32 v76, v76
    v_exp_f32 v77, v77
    v_cvt_pk_bf16_f32 v45, v74, v75
    v_exp_f32 v78, v78
    v_exp_f32 v79, v79
    v_cvt_pk_bf16_f32 v46, v76, v77
    v_cvt_pk_bf16_f32 v47, v78, v79
    v_mfma_f32_32x32x16_bf16 v[80:95], v[224:227], v[40:43], v[80:95]
    v_exp_f32 v48, v48
    v_exp_f32 v49, v49
    v_exp_f32 v50, v50
    v_exp_f32 v51, v51
    v_cvt_pk_bf16_f32 v32, v48, v49
    v_exp_f32 v52, v52
    v_exp_f32 v53, v53
    v_cvt_pk_bf16_f32 v33, v50, v51
    v_exp_f32 v54, v54
    v_exp_f32 v55, v55
    v_cvt_pk_bf16_f32 v34, v52, v53
    v_exp_f32 v56, v56
    v_mfma_f32_32x32x16_bf16 v[80:95], v[228:231], v[44:47], v[80:95]
    v_exp_f32 v57, v57
    v_cvt_pk_bf16_f32 v35, v54, v55
    v_exp_f32 v58, v58
    v_exp_f32 v59, v59
    v_cvt_pk_bf16_f32 v36, v56, v57
    v_exp_f32 v60, v60
    v_exp_f32 v61, v61
    v_cvt_pk_bf16_f32 v37, v58, v59
    v_exp_f32 v62, v62
    v_exp_f32 v63, v63
    v_cvt_pk_bf16_f32 v38, v60, v61
    v_cvt_pk_bf16_f32 v39, v62, v63
    s_waitcnt vmcnt(14)
    v_mfma_f32_32x32x16_bf16 v[80:95], v[232:235], v[32:35], v[80:95]
    v_mfma_f32_32x32x16_bf16 v[80:95], v[236:239], v[36:39], v[80:95]
    s_mov_b32 s50, 0x28000000
    v_subrev_u32 v14, 0x2b800000, v104
    s_nop 9
    v_subrev_u32 v15, 0x2b800000, v88
    v_max_u32 v14, v14, v15
    v_cmp_le_u32 vcc, s50, v14
    s_nop 0
    s_cbranch_vccnz L_fb
L_fbd:
    s_sub_u32 s50, s101, s60
    s_sub_u32 s50, s50, 0x1ec000
    s_lshl_b32 s51, s6, 12
    s_add_u32 s50, s50, s51
    s_lshl_b32 s51, s50, 3
    s_add_u32 s51, s51, s60
    s_add_u32 s8, s51, 0x80000
    s_add_u32 s9, s51, 0x88000
    s_add_u32 s50, s50, s60
    s_add_u32 s10, s50, 0x1e0000
    s_nop 0
    v_rcp_f32 v14, v104
    v_bfe_u32 v10, v251, 2, 7
    v_lshl_add_u32 v10, v12, 12, v10
    v_mul_f32 v96, v14, v96
    v_mul_f32 v97, v14, v97
    v_mul_f32 v98, v14, v98
    v_mul_f32 v99, v14, v99
    v_mul_f32 v100, v14, v100
    v_mul_f32 v101, v14, v101
    v_mul_f32 v102, v14, v102
    v_mul_f32 v103, v14, v103
    v_cvt_pk_bf16_f32 v36, v96, v97
    v_cvt_pk_bf16_f32 v37, v98, v99
    v_cvt_pk_bf16_f32 v38, v100, v101
    v_cvt_pk_bf16_f32 v39, v102, v103
    buffer_store_dwordx4 v[36:39], v251, s[44:47], s9 offen sc1
    v_dot2_f32_bf16 v41, v36, v252, 0
    v_dot2_f32_bf16 v41, v37, v253, v41
    v_dot2_f32_bf16 v41, v38, v254, v41
    v_dot2_f32_bf16 v41, v39, v255, v41
    v_rcp_f32 v14, v88
    s_nop 0
    v_mul_f32 v80, v14, v80
    v_mul_f32 v81, v14, v81
    v_mul_f32 v82, v14, v82
    v_mul_f32 v83, v14, v83
    v_mul_f32 v84, v14, v84
    v_mul_f32 v85, v14, v85
    v_mul_f32 v86, v14, v86
    v_mul_f32 v87, v14, v87
    v_cvt_pk_bf16_f32 v32, v80, v81
    v_cvt_pk_bf16_f32 v33, v82, v83
    v_cvt_pk_bf16_f32 v34, v84, v85
    v_cvt_pk_bf16_f32 v35, v86, v87
    buffer_store_dwordx4 v[32:35], v251, s[44:47], s8 offen sc1
    v_dot2_f32_bf16 v40, v32, v252, 0
    v_dot2_f32_bf16 v40, v33, v253, v40
    v_dot2_f32_bf16 v40, v34, v254, v40
    v_dot2_f32_bf16 v40, v35, v255, v40
    s_nop 2
    v_permlane32_swap_b32 v40, v41
    v_add_f32 v40, v40, v41
    buffer_store_dword v40, v10, s[44:47], s10 offen sc1
    s_lshr_b32 s55, s5, 4
    s_mul_i32 s55, s55, 896
    s_bfe_u32 s56, s5, 0x30001
    s_lshl_b32 s56, s56, 6
    s_add_u32 s55, s55, s56
    s_and_b32 s56, s5, 1
    s_lshl_b32 s56, s56, 2
    s_add_u32 s56, s56, s3
    s_lshl_b32 s56, s56, 2
    s_add_u32 s55, s55, s56
    s_lshl_b32 s13, s55, 10
    v_lshlrev_b32 v14, 7, v0
    s_mov_b32 exec_hi, 0
    buffer_load_dword v250, v14, s[36:39], s13 offen
    s_mov_b64 exec, -1
    s_add_u32 s50, s60, 0x1f0400
    s_lshl_b32 s51, s5, 2
    s_add_u32 s51, s51, s3
    s_lshl_b32 s51, s51, 3
    s_add_u32 s51, s51, s50
    v_mov_b32 v4, s51
    v_mov_b32 v8, s48
    v_mov_b32 v9, s49
    s_lshl_b32 s51, s6, 1
    s_add_u32 s51, s51, s95
    s_lshl_b32 s51, s51, 4
    s_lshl_b32 s51, s51, 3
    s_add_u32 s51, s51, s50
    v_lshl_add_u32 v5, v0, 3, s51
    ds_read_b64_tr_b16 a[168:169], v6 offset:16384
    ds_read_b64_tr_b16 a[170:171], v6 offset:17408
    ds_read_b64_tr_b16 a[172:173], v7 offset:16384
    ds_read_b64_tr_b16 a[174:175], v7 offset:17408
    ds_read_b64_tr_b16 a[176:177], v6 offset:18432
    ds_read_b64_tr_b16 a[178:179], v6 offset:19456
    ds_read_b64_tr_b16 a[180:181], v7 offset:18432
    ds_read_b64_tr_b16 a[182:183], v7 offset:19456
    ds_read_b64_tr_b16 a[184:185], v6 offset:20480
    ds_read_b64_tr_b16 a[186:187], v6 offset:21504
    ds_read_b64_tr_b16 a[188:189], v7 offset:20480
    ds_read_b64_tr_b16 a[190:191], v7 offset:21504
    ds_read_b64_tr_b16 a[192:193], v6 offset:22528
    ds_read_b64_tr_b16 a[194:195], v6 offset:23552
    ds_read_b64_tr_b16 a[196:197], v7 offset:22528
    ds_read_b64_tr_b16 a[198:199], v7 offset:23552
    ds_read_b64_tr_b16 a[200:201], v6 offset:24576
    ds_read_b64_tr_b16 a[202:203], v6 offset:25600
    ds_read_b64_tr_b16 a[204:205], v7 offset:24576
    ds_read_b64_tr_b16 a[206:207], v7 offset:25600
    ds_read_b64_tr_b16 a[208:209], v6 offset:26624
    ds_read_b64_tr_b16 a[210:211], v6 offset:27648
    ds_read_b64_tr_b16 a[212:213], v7 offset:26624
    ds_read_b64_tr_b16 a[214:215], v7 offset:27648
    ds_read_b64_tr_b16 a[216:217], v6 offset:28672
    ds_read_b64_tr_b16 a[218:219], v6 offset:29696
    ds_read_b64_tr_b16 a[220:221], v7 offset:28672
    ds_read_b64_tr_b16 a[222:223], v7 offset:29696
    ds_read_b64_tr_b16 a[224:225], v6 offset:30720
    ds_read_b64_tr_b16 a[226:227], v6 offset:31744
    ds_read_b64_tr_b16 a[228:229], v7 offset:30720
    ds_read_b64_tr_b16 a[230:231], v7 offset:31744
    s_mov_b32 s62, s60
    v_and_b32 v20, 7, v0
    v_lshrrev_b32 v7, 4, v0
    v_lshlrev_b32 v21, 1, v7
    v_xor_b32 v20, v20, v21
    v_lshlrev_b32 v20, 4, v20
    v_lshrrev_b32 v21, 3, v0
    v_lshl_add_u32 v20, v21, 10, v20
    s_lshl_b32 s55, s7, 7
    s_mul_i32 s56, s95, 917504
    s_add_u32 s55, s55, s56
    v_add_u32 v244, s55, v20
    s_lshl_b32 s56, s95, 14
    v_lshl_add_u32 v20, v12, 10, v18
    v_add_u32 v20, s56, v20
    v_xor_b32 v252, 0, v20
    v_xor_b32 v253, 32, v20
    v_xor_b32 v254, 64, v20
    v_xor_b32 v255, 96, v20
    s_lshl_b32 s55, s61, 1
    s_add_u32 s55, s55, s95
    s_lshl_b32 s56, s55, 11
    s_lshl_b32 s55, s55, 14
    s_add_u32 s55, s55, s60
    s_add_u32 s56, s56, s60
    s_add_u32 s55, s55, 0x80000
    s_add_u32 s56, s56, 0x1e0000
    v_lshlrev_b32 v3, 2, v0
    s_mul_i32 s96, s3, 4352
    s_add_u32 s96, s96, 32768
    s_xor_b32 s97, s3, 2
    s_mul_i32 s97, s97, 4352
    s_add_u32 s97, s97, 32768
    v_add_u32 v14, s96, v1
    v_add_u32 v15, s97, v1
    v_add_u32 v16, s96, v3
    v_add_u32 v17, s97, v3
    v_bfe_u32 v7, v0, 4, 1
    v_lshlrev_b32 v6, 4, v13
    v_lshl_add_u32 v6, v12, 8, v6
    v_lshl_add_u32 v6, v7, 14, v6
    s_lshl_b32 s11, s7, 1
    s_add_u32 s11, s11, s95
    s_lshl_b32 s12, s61, 4
    s_add_u32 s12, s12, s11
    s_lshl_b32 s12, s12, 7
    s_add_u32 s12, s12, s60
    s_add_u32 s12, s12, 0x1e8000
    s_lshl_b32 s11, s11, 10
    s_lshl_b32 s100, s61, 15
    s_add_u32 s11, s11, s100
    s_add_u32 s11, s11, s60
    s_add_u32 s11, s11, 0xc0000
    v_accvgpr_read_b32 v177, a128
    v_lshlrev_b32 v176, 16, v177
    v_and_b32 v177, 0xffff0000, v177
    v_accvgpr_read_b32 v179, a129
    v_lshlrev_b32 v178, 16, v179
    v_and_b32 v179, 0xffff0000, v179
    v_accvgpr_read_b32 v181, a130
    v_lshlrev_b32 v180, 16, v181
    v_and_b32 v181, 0xffff0000, v181
    v_accvgpr_read_b32 v183, a131
    v_lshlrev_b32 v182, 16, v183
    v_and_b32 v183, 0xffff0000, v183
    v_accvgpr_read_b32 v185, a132
    v_lshlrev_b32 v184, 16, v185
    v_and_b32 v185, 0xffff0000, v185
    v_accvgpr_read_b32 v187, a133
    v_lshlrev_b32 v186, 16, v187
    v_and_b32 v187, 0xffff0000, v187
    v_accvgpr_read_b32 v189, a134
    v_lshlrev_b32 v188, 16, v189
    v_and_b32 v189, 0xffff0000, v189
    v_accvgpr_read_b32 v191, a135
    v_lshlrev_b32 v190, 16, v191
    v_and_b32 v191, 0xffff0000, v191
    s_cmp_lg_u32 s93, 0
    s_cbranch_scc1 L_sys_s2
    s_waitcnt vmcnt(1)
    s_mov_b64 exec, 1
    buffer_store_dwordx2 v[8:9], v4, s[44:47], 0 offen
L_syp_s2:
    s_mov_b64 exec, -1
    s_mov_b64 exec, 0xffff
    buffer_load_dwordx2 v[8:9], v5, s[44:47], 0 offen sc1
    s_mov_b64 exec, -1
    s_waitcnt lgkmcnt(0)
    s_barrier
    s_mul_i32 s101, s94, 131072
    s_add_u32 m0, s58, 0
    s_add_u32 s101, s101, 0
    buffer_load_dwordx4 v244, s[36:39], s101 offen lds
    v_and_b32 v20, 7, v0
    v_xor_b32 v21, v20, v12
    v_lshlrev_b32 v21, 4, v21
    v_lshl_add_u32 v21, v11, 7, v21
    v_add_u32 v26, s97, v21
    v_lshrrev_b32 v7, 4, v0
    v_xor_b32 v21, v20, v7
    v_lshlrev_b32 v21, 4, v21
    s_addk_i32 m0, 0x400
    s_addk_i32 s101, 0x2000
    buffer_load_dwordx4 v244, s[36:39], s101 offen lds
    v_lshl_add_u32 v21, v13, 7, v21
    s_mul_i32 s22, s94, 4352
    s_lshl_b32 s23, s95, 11
    s_add_u32 s22, s22, s23
    s_add_u32 s22, s22, 32768
    v_add_u32 v24, s22, v21
    v_xor_b32 v25, 64, v24
    s_lshl_b32 s96, s3, 16
    s_addk_i32 m0, 0x400
    s_addk_i32 s101, 0x2000
    buffer_load_dwordx4 v244, s[36:39], s101 offen lds
    s_add_u32 s96, s96, s62
    s_add_u32 s96, s96, 0xc0000
    s_and_b32 s22, s2, 2
    s_lshl_b32 s22, s22, 10
    s_add_u32 s96, s96, s22
    s_add_u32 s97, s96, 16384
    s_add_u32 s98, s96, 32768
    s_add_u32 s99, s96, 49152
    s_addk_i32 m0, 0x400
    s_addk_i32 s101, 0x2000
    buffer_load_dwordx4 v244, s[36:39], s101 offen lds
    s_xor_b32 s8, s96, 2048
    s_xor_b32 s9, s97, 2048
    s_xor_b32 s10, s98, 2048
    s_xor_b32 s52, s99, 2048
    s_cmp_ge_u32 s92, 14
    s_cselect_b32 s22, 14, 0
    s_add_u32 s22, s22, s92
    s_lshl_b32 s22, s22, 10
    s_addk_i32 m0, 0x400
    s_add_u32 s101, s101, 40960
    buffer_load_dwordx4 v244, s[36:39], s101 offen lds
    s_mul_i32 s100, s3, 229376
    s_add_u32 s100, s100, s62
    s_add_u32 s100, s100, s22
    s_add_u32 s100, s100, 0x100000
    s_cmp_lt_u32 s92, 28
    s_cselect_b32 s100, s100, 0x40000000
    v_lshrrev_b32 v21, 3, v0
    v_mul_u32_u24 v245, 57344, v21
    s_addk_i32 m0, 0x400
    s_addk_i32 s101, 0x2000
    buffer_load_dwordx4 v244, s[36:39], s101 offen lds
    v_and_b32 v21, 7, v0
    v_lshl_add_u32 v245, v21, 7, v245
    v_add_u32 v245, s100, v245
    s_lshl_b32 s14, s61, 1
    s_add_u32 s14, s14, s95
    s_xor_b32 s15, s14, 1
    s_mul_i32 s23, s95, 28672
    s_add_u32 s23, s23, s60
    s_addk_i32 m0, 0x400
    s_addk_i32 s101, 0x2000
    buffer_load_dwordx4 v244, s[36:39], s101 offen lds
    s_add_u32 s23, s23, 0x100000
    s_mul_i32 s14, s14, 57344
    s_mul_i32 s15, s15, 57344
    s_add_u32 s14, s14, s23
    s_add_u32 s15, s15, s23
    s_lshl_b32 s16, s61, 11
    s_lshl_b32 s23, s95, 6
    s_add_u32 s16, s16, s23
    s_addk_i32 m0, 0x400
    s_addk_i32 s101, 0x2000
    buffer_load_dwordx4 v244, s[36:39], s101 offen lds
    s_add_u32 s16, s16, s60
    s_add_u32 s16, s16, 0x1e8000
    s_lshl_b32 s23, s3, 12
    s_add_u32 s23, s23, 65536
    s_xor_b32 s57, s23, 8192
    v_add_u32 v10, s23, v1
    v_add_u32 v19, s57, v1
    s_lshl_b32 s23, s95, 14
    s_add_u32 s17, s59, s23
    s_add_u32 s18, s17, 8192
    s_lshl_b32 s19, s3, 5
    s_add_u32 s19, s19, s92
    s_lshl_b32 s19, s19, 3
    s_add_u32 s19, s19, s62
    s_add_u32 s19, s19, 0x1f0000
    s_mul_i32 s20, s95, 14
    s_lshl_b32 s23, s6, 5
    s_add_u32 s20, s20, s23
    s_lshl_b32 s20, s20, 3
    s_add_u32 s20, s20, s60
    s_add_u32 s20, s20, 0x1f0000
    v_mov_b32 v246, s48
    v_mov_b32 v247, s49
    s_movk_i32 s21, 14336
    s_mov_b64 exec, 0xffff
    s_waitcnt vmcnt(8)
    v_cmp_ne_u64 vcc, s[48:49], v[8:9]
    s_nop 0
    s_cbranch_vccz L_polld_s2
    s_mov_b32 s50, 0
L_poll_s2:
    buffer_load_dwordx2 v[8:9], v5, s[44:47], 0 offen sc1
    s_add_u32 s50, s50, 1
    s_cmp_gt_u32 s50, 65536
    s_waitcnt vmcnt(0)
    s_cbranch_scc1 L_polld_s2
    v_cmp_ne_u64 vcc, s[48:49], v[8:9]
    s_nop 0
    s_cbranch_vccnz L_poll_s2
L_polld_s2:
    s_mov_b64 exec, -1
    buffer_load_dwordx4 v[64:67], v1, s[44:47], s55 offen offset:0 sc1
    buffer_load_dwordx4 v[68:71], v1, s[44:47], s55 offen offset:1024 sc1
    buffer_load_dwordx4 v[72:75], v1, s[44:47], s55 offen offset:2048 sc1
    buffer_load_dwordx4 v[76:79], v1, s[44:47], s55 offen offset:3072 sc1
    s_addk_i32 s55, 0x1000
    buffer_load_dwordx4 v[80:83], v1, s[44:47], s55 offen offset:0 sc1
    buffer_load_dwordx4 v[84:87], v1, s[44:47], s55 offen offset:1024 sc1
    buffer_load_dwordx4 v[88:91], v1, s[44:47], s55 offen offset:2048 sc1
    buffer_load_dwordx4 v[92:95], v1, s[44:47], s55 offen offset:3072 sc1
    s_addk_i32 s55, 0x1000
    buffer_load_dwordx4 v[96:99], v1, s[44:47], s55 offen offset:0 sc1
    buffer_load_dwordx4 v[100:103], v1, s[44:47], s55 offen offset:1024 sc1
    buffer_load_dwordx4 v[104:107], v1, s[44:47], s55 offen offset:2048 sc1
    buffer_load_dwordx4 v[108:111], v1, s[44:47], s55 offen offset:3072 sc1
    s_addk_i32 s55, 0x1000
    s_waitcnt vmcnt(11)
    v_mfma_f32_32x32x16_bf16 v[144:159], a[0:3], v[64:67], 0
    s_barrier
    ds_read_b64_tr_b16 a[64:65], v252 offset:0
    ds_read_b64_tr_b16 a[66:67], v252 offset:2048
    ds_read_b64_tr_b16 a[68:69], v253 offset:0
    buffer_load_dwordx4 v[112:115], v1, s[44:47], s55 offen offset:0 sc1
    v_mfma_f32_32x32x16_bf16 v[160:175], a[4:7], v[64:67], v[176:191]
    ds_read_b64_tr_b16 a[70:71], v253 offset:2048
    ds_read_b64_tr_b16 a[72:73], v254 offset:0
    ds_read_b64_tr_b16 a[74:75], v254 offset:2048
    buffer_load_dwordx4 v[116:119], v1, s[44:47], s55 offen offset:1024 sc1
    s_waitcnt vmcnt(12)
    v_mfma_f32_32x32x16_bf16 v[144:159], a[8:11], v[68:71], v[144:159]
    ds_read_b64_tr_b16 a[76:77], v255 offset:0
    ds_read_b64_tr_b16 a[78:79], v255 offset:2048
    ds_read_b64_tr_b16 a[80:81], v252 offset:4096
    buffer_load_dwordx4 v[120:123], v1, s[44:47], s55 offen offset:2048 sc1
    v_mfma_f32_32x32x16_bf16 v[160:175], a[12:15], v[68:71], v[160:175]
    ds_read_b64_tr_b16 a[82:83], v252 offset:6144
    ds_read_b64_tr_b16 a[84:85], v253 offset:4096
    ds_read_b64_tr_b16 a[86:87], v253 offset:6144
    buffer_load_dwordx4 v[124:127], v1, s[44:47], s55 offen offset:3072 sc1
    s_waitcnt vmcnt(13)
    v_mfma_f32_32x32x16_bf16 v[144:159], a[16:19], v[72:75], v[144:159]
    ds_read_b64_tr_b16 a[88:89], v254 offset:4096
    ds_read_b64_tr_b16 a[90:91], v254 offset:6144
    ds_read_b64_tr_b16 a[92:93], v255 offset:4096
    buffer_load_dword v128, v3, s[44:47], s56 offen offset:0 sc1
    v_mfma_f32_32x32x16_bf16 v[160:175], a[20:23], v[72:75], v[160:175]
    ds_read_b64_tr_b16 a[94:95], v255 offset:6144
    ds_read_b64_tr_b16 a[96:97], v252 offset:8192
    ds_read_b64_tr_b16 a[98:99], v252 offset:10240
    buffer_load_dword v129, v3, s[44:47], s56 offen offset:256 sc1
    s_waitcnt vmcnt(14)
    v_mfma_f32_32x32x16_bf16 v[144:159], a[24:27], v[76:79], v[144:159]
    ds_read_b64_tr_b16 a[100:101], v253 offset:8192
    ds_read_b64_tr_b16 a[102:103], v253 offset:10240
    ds_read_b64_tr_b16 a[104:105], v254 offset:8192
    buffer_load_dword v130, v3, s[44:47], s56 offen offset:512 sc1
    v_mfma_f32_32x32x16_bf16 v[160:175], a[28:31], v[76:79], v[160:175]
    ds_read_b64_tr_b16 a[106:107], v254 offset:10240
    ds_read_b64_tr_b16 a[108:109], v255 offset:8192
    ds_read_b64_tr_b16 a[110:111], v255 offset:10240
    buffer_load_dword v131, v3, s[44:47], s56 offen offset:768 sc1
    s_waitcnt vmcnt(15)
    v_mfma_f32_32x32x16_bf16 v[144:159], a[32:35], v[80:83], v[144:159]
    ds_read_b64_tr_b16 a[112:113], v252 offset:12288
    ds_read_b64_tr_b16 a[114:115], v252 offset:14336
    ds_read_b64_tr_b16 a[116:117], v253 offset:12288
    buffer_load_dword v132, v3, s[44:47], s56 offen offset:1024 sc1
    v_mfma_f32_32x32x16_bf16 v[160:175], a[36:39], v[80:83], v[160:175]
    ds_read_b64_tr_b16 a[118:119], v253 offset:14336
    ds_read_b64_tr_b16 a[120:121], v254 offset:12288
    ds_read_b64_tr_b16 a[122:123], v254 offset:14336
    buffer_load_dword v133, v3, s[44:47], s56 offen offset:1280 sc1
    s_waitcnt vmcnt(16)
    v_mfma_f32_32x32x16_bf16 v[144:159], a[40:43], v[84:87], v[144:159]
    ds_read_b64_tr_b16 a[124:125], v255 offset:12288
    ds_read_b64_tr_b16 a[126:127], v255 offset:14336
    buffer_load_dword v134, v3, s[44:47], s56 offen offset:1536 sc1
    v_mfma_f32_32x32x16_bf16 v[160:175], a[44:47], v[84:87], v[160:175]
    buffer_load_dword v135, v3, s[44:47], s56 offen offset:1792 sc1
    s_waitcnt vmcnt(17)
    v_mfma_f32_32x32x16_bf16 v[144:159], a[48:51], v[88:91], v[144:159]
    s_add_u32 m0, s53, 131072
    s_xor_b32 s63, s2, 8
    s_mul_i32 s63, s63, 114688
    buffer_load_dwordx4 v248, s[28:31], s63 offen lds
    v_mfma_f32_32x32x16_bf16 v[160:175], a[52:55], v[88:91], v[160:175]
    s_add_u32 m0, s53, 132096
    s_nop 0
    buffer_load_dwordx4 v248, s[32:35], s63 offen lds
    s_waitcnt vmcnt(18)
    v_mfma_f32_32x32x16_bf16 v[144:159], a[56:59], v[92:95], v[144:159]
    s_add_u32 m0, s53, 139264
    s_xor_b32 s63, s2, 9
    s_mul_i32 s63, s63, 114688
    buffer_load_dwordx4 v248, s[28:31], s63 offen lds
    v_mfma_f32_32x32x16_bf16 v[160:175], a[60:63], v[92:95], v[160:175]
    s_add_u32 m0, s53, 140288
    s_nop 0
    buffer_load_dwordx4 v248, s[32:35], s63 offen lds
    s_waitcnt vmcnt(19)
    v_mfma_f32_32x32x16_bf16 v[144:159], a[168:171], v[96:99], v[144:159]
    s_add_u32 m0, s53, 147456
    s_xor_b32 s63, s2, 10
    s_mul_i32 s63, s63, 114688
    buffer_load_dwordx4 v248, s[28:31], s63 offen lds
    v_mfma_f32_32x32x16_bf16 v[160:175], a[172:175], v[96:99], v[160:175]
    s_add_u32 m0, s53, 148480
    s_nop 0
    buffer_load_dwordx4 v248, s[32:35], s63 offen lds
    s_waitcnt vmcnt(20)
    v_mfma_f32_32x32x16_bf16 v[144:159], a[176:179], v[100:103], v[144:159]
    v_mfma_f32_32x32x16_bf16 v[160:175], a[180:183], v[100:103], v[160:175]
    s_waitcnt vmcnt(19)
    v_mfma_f32_32x32x16_bf16 v[144:159], a[184:187], v[104:107], v[144:159]
    v_mfma_f32_32x32x16_bf16 v[160:175], a[188:191], v[104:107], v[160:175]
    s_waitcnt vmcnt(18)
    v_mfma_f32_32x32x16_bf16 v[144:159], a[192:195], v[108:111], v[144:159]
    v_mfma_f32_32x32x16_bf16 v[160:175], a[196:199], v[108:111], v[160:175]
    s_waitcnt vmcnt(17)
    v_mfma_f32_32x32x16_bf16 v[144:159], a[200:203], v[112:115], v[144:159]
    v_mfma_f32_32x32x16_bf16 v[160:175], a[204:207], v[112:115], v[160:175]
    s_waitcnt vmcnt(16)
    v_mfma_f32_32x32x16_bf16 v[144:159], a[208:211], v[116:119], v[144:159]
    s_waitcnt vmcnt(15)
    v_mfma_f32_32x32x16_bf16 v[144:159], a[216:219], v[120:123], v[144:159]
    s_waitcnt vmcnt(6)
    v_add_f32 v128, v128, v129
    v_add_f32 v128, v128, v130
    v_add_f32 v128, v128, v131
    v_add_f32 v128, v128, v132
    v_add_f32 v128, v128, v133
    v_add_f32 v128, v128, v134
    v_add_f32 v128, v128, v135
    v_mov_b32 v129, v128
    s_nop 1
    v_permlane32_swap_b32 v129, v128
    v_add_f32 v128, v128, v129
    ds_write_b32 v16, v128 offset:4096
    v_mfma_f32_32x32x16_bf16 v[144:159], a[224:227], v[124:127], v[144:159]
    v_mfma_f32_32x32x16_bf16 v[160:175], a[212:215], v[116:119], v[160:175]
    v_mfma_f32_32x32x16_bf16 v[160:175], a[220:223], v[120:123], v[160:175]
    s_nop 9
    ds_write_b128 v14, v[144:147] offset:0
    ds_write_b128 v14, v[148:151] offset:1024
    v_mfma_f32_32x32x16_bf16 v[160:175], a[228:231], v[124:127], v[160:175]
    ds_write_b128 v14, v[152:155] offset:2048
    ds_write_b128 v14, v[156:159] offset:3072
    s_waitcnt lgkmcnt(0)
    s_barrier
    ds_read_b32 v129, v17 offset:4096
    ds_read_b128 v[144:147], v15 offset:0
    ds_read_b128 v[148:151], v15 offset:1024
    ds_read_b128 v[152:155], v15 offset:2048
    ds_read_b128 v[156:159], v15 offset:3072
    v_sub_f32 v128, v128, v2
    s_waitcnt lgkmcnt(4)
    v_add_f32 v128, v128, v129
    s_waitcnt lgkmcnt(2)
    v_add_f32 v32, v160, v144
    v_add_f32 v33, v161, v145
    v_add_f32 v34, v162, v146
    v_add_f32 v35, v163, v147
    v_add_f32 v36, v164, v148
    v_add_f32 v37, v165, v149
    v_add_f32 v38, v166, v150
    v_add_f32 v39, v167, v151
    v_sub_f32 v48, v32, v128
    v_sub_f32 v49, v33, v128
    v_sub_f32 v50, v34, v128
    v_sub_f32 v51, v35, v128
    v_sub_f32 v52, v36, v128
    v_sub_f32 v53, v37, v128
    v_sub_f32 v54, v38, v128
    v_sub_f32 v55, v39, v128
    v_cvt_pk_bf16_f32 v64, v48, v49
    v_cvt_pk_bf16_f32 v65, v50, v51
    v_cvt_pk_bf16_f32 v66, v52, v53
    v_cvt_pk_bf16_f32 v67, v54, v55
    buffer_store_dwordx4 v[64:67], v6, s[44:47], s11 offen offset:0 sc1
    s_waitcnt lgkmcnt(0)
    v_add_f32 v40, v168, v152
    v_add_f32 v41, v169, v153
    v_add_f32 v42, v170, v154
    v_add_f32 v43, v171, v155
    v_add_f32 v44, v172, v156
    v_add_f32 v45, v173, v157
    v_add_f32 v46, v174, v158
    v_add_f32 v47, v175, v159
    v_sub_f32 v56, v40, v128
    v_sub_f32 v57, v41, v128
    v_sub_f32 v58, v42, v128
    v_sub_f32 v59, v43, v128
    v_sub_f32 v60, v44, v128
    v_sub_f32 v61, v45, v128
    v_sub_f32 v62, v46, v128
    v_sub_f32 v63, v47, v128
    v_cvt_pk_bf16_f32 v68, v56, v57
    v_cvt_pk_bf16_f32 v69, v58, v59
    v_cvt_pk_bf16_f32 v70, v60, v61
    v_cvt_pk_bf16_f32 v71, v62, v63
    buffer_store_dwordx4 v[68:71], v6, s[44:47], s11 offen offset:512 sc1
    v_mul_f32 v20, v48, v48
    v_mul_f32 v21, v49, v49
    v_mul_f32 v22, v50, v50
    v_mul_f32 v23, v51, v51
    v_fmac_f32 v20, v52, v52
    v_fmac_f32 v21, v53, v53
    v_fmac_f32 v22, v54, v54
    v_fmac_f32 v23, v55, v55
    v_fmac_f32 v20, v56, v56
    v_fmac_f32 v21, v57, v57
    v_fmac_f32 v22, v58, v58
    v_fmac_f32 v23, v59, v59
    v_fmac_f32 v20, v60, v60
    v_fmac_f32 v21, v61, v61
    v_fmac_f32 v22, v62, v62
    v_fmac_f32 v23, v63, v63
    v_add_f32 v20, v20, v22
    v_add_f32 v21, v21, v23
    v_add_f32 v20, v20, v21
    v_mov_b32 v21, v20
    s_nop 1
    v_permlane32_swap_b32 v21, v20
    v_add_f32 v20, v20, v21
    s_mov_b32 exec_hi, 0
    buffer_store_dword v20, v3, s[44:47], s12 offen sc1
    s_mov_b64 exec, -1
    s_add_u32 s50, s60, 0x1f0800
    s_lshl_b32 s51, s5, 2
    s_add_u32 s51, s51, s3
    s_lshl_b32 s51, s51, 3
    s_add_u32 s51, s51, s50
    v_mov_b32 v4, s51
    v_mov_b32 v8, s48
    v_mov_b32 v9, s49
    s_lshl_b32 s51, s3, 5
    s_lshl_b32 s51, s51, 3
    s_add_u32 s51, s51, s50
    v_lshl_add_u32 v5, v0, 3, s51
    s_mul_i32 s55, s94, 131072
    s_add_u32 m0, s58, 0
    s_add_u32 s55, s55, 262144
    buffer_load_dwordx4 v244, s[36:39], s55 offen lds
    ds_write_b128 v26, v[32:35]
    v_xor_b32 v22, 32, v26
    ds_write_b128 v22, v[36:39]
    s_addk_i32 m0, 0x400
    s_addk_i32 s55, 0x2000
    buffer_load_dwordx4 v244, s[36:39], s55 offen lds
    v_xor_b32 v22, 64, v26
    ds_write_b128 v22, v[40:43]
    v_xor_b32 v22, 96, v26
    s_addk_i32 m0, 0x400
    s_addk_i32 s55, 0x2000
    buffer_load_dwordx4 v244, s[36:39], s55 offen lds
    ds_write_b128 v22, v[44:47]
    s_waitcnt lgkmcnt(0)
    s_barrier
    s_addk_i32 m0, 0x400
    s_addk_i32 s55, 0x2000
    buffer_load_dwordx4 v244, s[36:39], s55 offen lds
    ds_read_b128 v[228:231], v24 offset:8704
    ds_read_b128 v[232:235], v25 offset:8704
    ds_read_b128 v[236:239], v24 offset:0
    s_addk_i32 m0, 0x400
    s_add_u32 s55, s55, 40960
    buffer_load_dwordx4 v244, s[36:39], s55 offen lds
    ds_read_b128 v[240:243], v25 offset:0
    s_addk_i32 m0, 0x400
    s_addk_i32 s55, 0x2000
    buffer_load_dwordx4 v244, s[36:39], s55 offen lds
    v_lshl_add_u32 v20, v12, 11, v18
    v_add_u32 v20, 65536, v20
    v_xor_b32 v14, 0, v20
    s_addk_i32 m0, 0x400
    s_addk_i32 s55, 0x2000
    buffer_load_dwordx4 v244, s[36:39], s55 offen lds
    v_xor_b32 v15, 32, v20
    v_xor_b32 v16, 64, v20
    v_xor_b32 v17, 96, v20
    s_addk_i32 m0, 0x400
    s_addk_i32 s55, 0x2000
    buffer_load_dwordx4 v244, s[36:39], s55 offen lds
    v_lshlrev_b32 v3, 2, v13
    v_lshl_add_u32 v3, v7, 7, v3
    v_and_b32 v6, 7, v0
    v_lshlrev_b32 v6, 10, v6
    v_bfe_u32 v2, v0, 3, 1
    v_lshl_add_u32 v6, v2, 6, v6
    v_and_b32 v2, 1, v7
    v_lshl_add_u32 v6, v2, 5, v6
    v_lshl_add_u32 v6, v12, 4, v6
    v_lshlrev_b32 v2, 3, v0
    s_and_b32 s22, s2, 12
    s_lshl_b32 s22, s22, 10
    v_add_u32 v13, s22, v1
    v_xor_b32 v18, 4096, v13
    v_xor_b32 v251, 8192, v13
    v_xor_b32 v7, 12288, v13
    s_waitcnt lgkmcnt(0)
    s_barrier
    s_cmp_lg_u32 s93, 0
    s_cbranch_scc1 L_sys_s3
    s_waitcnt vmcnt(8)
    s_mov_b64 exec, 1
    buffer_store_dwordx2 v[8:9], v4, s[44:47], 0 offen
L_syp_s3:
    s_mov_b64 exec, -1
    s_cmp_ge_u32 s92, 28
    s_cbranch_scc1 L_spare
    s_mov_b32 exec_hi, 0
    s_mov_b32 s50, 0
L_poll_s3:
    buffer_load_dwordx2 v[8:9], v5, s[44:47], 0 offen sc1
    s_add_u32 s50, s50, 1
    s_cmp_gt_u32 s50, 65536
    s_waitcnt vmcnt(0)
    s_cbranch_scc1 L_polld_s3
    v_cmp_ne_u64 vcc, s[48:49], v[8:9]
    s_nop 0
    s_cbranch_vccnz L_poll_s3
L_polld_s3:
    s_mov_b64 exec, -1
    buffer_load_dwordx4 a[0:3], v13, s[44:47], s96 offen offset:0 sc1
    buffer_load_dwordx4 a[4:7], v13, s[44:47], s97 offen offset:0 sc1
    buffer_load_dwordx4 a[8:11], v13, s[44:47], s98 offen offset:0 sc1
    buffer_load_dwordx4 a[12:15], v13, s[44:47], s99 offen offset:0 sc1
    buffer_load_dwordx4 a[16:19], v13, s[44:47], s96 offen offset:1024 sc1
    buffer_load_dwordx4 a[20:23], v13, s[44:47], s97 offen offset:1024 sc1
    buffer_load_dwordx4 a[24:27], v13, s[44:47], s98 offen offset:1024 sc1
    buffer_load_dwordx4 a[28:31], v13, s[44:47], s99 offen offset:1024 sc1
    buffer_load_dwordx4 a[32:35], v13, s[44:47], s8 offen offset:0 sc1
    buffer_load_dwordx4 a[36:39], v13, s[44:47], s9 offen offset:0 sc1
    buffer_load_dwordx4 a[40:43], v13, s[44:47], s10 offen offset:0 sc1
    buffer_load_dwordx4 a[44:47], v13, s[44:47], s52 offen offset:0 sc1
    buffer_load_dwordx4 a[48:51], v13, s[44:47], s8 offen offset:1024 sc1
    buffer_load_dwordx4 a[52:55], v13, s[44:47], s9 offen offset:1024 sc1
    buffer_load_dwordx4 a[56:59], v13, s[44:47], s10 offen offset:1024 sc1
    buffer_load_dwordx4 a[60:63], v13, s[44:47], s52 offen offset:1024 sc1
    ds_read_b64_tr_b16 v[148:149], v14 offset:0
    ds_read_b64_tr_b16 v[150:151], v14 offset:4096
    ds_read_b64_tr_b16 v[152:153], v14 offset:1024
    ds_read_b64_tr_b16 v[154:155], v14 offset:5120
    ds_read_b64_tr_b16 v[156:157], v15 offset:0
    ds_read_b64_tr_b16 v[158:159], v15 offset:4096
    ds_read_b64_tr_b16 v[160:161], v15 offset:1024
    ds_read_b64_tr_b16 v[162:163], v15 offset:5120
    ds_read_b64_tr_b16 v[164:165], v16 offset:0
    ds_read_b64_tr_b16 v[166:167], v16 offset:4096
    ds_read_b64_tr_b16 v[168:169], v16 offset:1024
    ds_read_b64_tr_b16 v[170:171], v16 offset:5120
    ds_read_b64_tr_b16 v[172:173], v17 offset:0
    ds_read_b64_tr_b16 v[174:175], v17 offset:4096
    s_waitcnt lgkmcnt(12)
    s_waitcnt vmcnt(15)
    v_mfma_f32_16x16x32_bf16 v[20:23], v[148:151], a[0:3], 0
    s_add_u32 m0, s53, 155648
    s_xor_b32 s63, s2, 11
    s_mul_i32 s63, s63, 114688
    buffer_load_dwordx4 v248, s[28:31], s63 offen lds
    s_waitcnt vmcnt(15)
    v_mfma_f32_16x16x32_bf16 v[52:55], v[148:151], a[4:7], 0
    s_waitcnt vmcnt(14)
    v_mfma_f32_16x16x32_bf16 v[84:87], v[148:151], a[8:11], 0
    s_waitcnt vmcnt(13)
    v_mfma_f32_16x16x32_bf16 v[116:119], v[148:151], a[12:15], 0
    s_add_u32 m0, s53, 156672
    s_nop 0
    buffer_load_dwordx4 v248, s[32:35], s63 offen lds
    s_waitcnt lgkmcnt(10)
    v_mfma_f32_16x16x32_bf16 v[24:27], v[152:155], a[0:3], 0
    ds_read_b64_tr_b16 v[176:177], v17 offset:1024
    ds_read_b64_tr_b16 v[178:179], v17 offset:5120
    v_mfma_f32_16x16x32_bf16 v[56:59], v[152:155], a[4:7], 0
    v_mfma_f32_16x16x32_bf16 v[88:91], v[152:155], a[8:11], 0
    s_add_u32 m0, s53, 32768
    s_xor_b32 s63, s2, 12
    s_mul_i32 s63, s63, 114688
    buffer_load_dwordx4 v248, s[28:31], s63 offen lds
    v_mfma_f32_16x16x32_bf16 v[120:123], v[152:155], a[12:15], 0
    s_waitcnt lgkmcnt(10)
    v_mfma_f32_16x16x32_bf16 v[28:31], v[156:159], a[0:3], 0
    ds_read_b64_tr_b16 v[180:181], v14 offset:8192
    ds_read_b64_tr_b16 v[182:183], v14 offset:12288
    v_mfma_f32_16x16x32_bf16 v[60:63], v[156:159], a[4:7], 0
    s_add_u32 m0, s53, 33792
    s_nop 0
    buffer_load_dwordx4 v248, s[32:35], s63 offen lds
    v_mfma_f32_16x16x32_bf16 v[92:95], v[156:159], a[8:11], 0
    v_mfma_f32_16x16x32_bf16 v[124:127], v[156:159], a[12:15], 0
    s_waitcnt lgkmcnt(10)
    v_mfma_f32_16x16x32_bf16 v[32:35], v[160:163], a[0:3], 0
    s_add_u32 m0, s53, 40960
    s_xor_b32 s63, s2, 13
    s_mul_i32 s63, s63, 114688
    buffer_load_dwordx4 v248, s[28:31], s63 offen lds
    v_mfma_f32_16x16x32_bf16 v[64:67], v[160:163], a[4:7], 0
    ds_read_b64_tr_b16 v[184:185], v14 offset:9216
    ds_read_b64_tr_b16 v[186:187], v14 offset:13312
    v_mfma_f32_16x16x32_bf16 v[96:99], v[160:163], a[8:11], 0
    v_mfma_f32_16x16x32_bf16 v[128:131], v[160:163], a[12:15], 0
    s_add_u32 m0, s53, 41984
    s_nop 0
    buffer_load_dwordx4 v248, s[32:35], s63 offen lds
    s_waitcnt lgkmcnt(10)
    v_mfma_f32_16x16x32_bf16 v[36:39], v[164:167], a[0:3], 0
    ds_read_b64_tr_b16 v[188:189], v15 offset:8192
    ds_read_b64_tr_b16 v[190:191], v15 offset:12288
    v_mfma_f32_16x16x32_bf16 v[68:71], v[164:167], a[4:7], 0
    v_mfma_f32_16x16x32_bf16 v[100:103], v[164:167], a[8:11], 0
    s_add_u32 m0, s53, 49152
    s_xor_b32 s63, s2, 14
    s_mul_i32 s63, s63, 114688
    buffer_load_dwordx4 v248, s[28:31], s63 offen lds
    v_mfma_f32_16x16x32_bf16 v[132:135], v[164:167], a[12:15], 0
    s_waitcnt lgkmcnt(10)
    v_mfma_f32_16x16x32_bf16 v[40:43], v[168:171], a[0:3], 0
    ds_read_b64_tr_b16 v[192:193], v15 offset:9216
    ds_read_b64_tr_b16 v[194:195], v15 offset:13312
    v_mfma_f32_16x16x32_bf16 v[72:75], v[168:171], a[4:7], 0
    s_add_u32 m0, s53, 50176
    s_nop 0
    buffer_load_dwordx4 v248, s[32:35], s63 offen lds
    v_mfma_f32_16x16x32_bf16 v[104:107], v[168:171], a[8:11], 0
    v_mfma_f32_16x16x32_bf16 v[136:139], v[168:171], a[12:15], 0
    s_waitcnt lgkmcnt(10)
    v_mfma_f32_16x16x32_bf16 v[44:47], v[172:175], a[0:3], 0
    s_add_u32 m0, s53, 57344
    s_xor_b32 s63, s2, 15
    s_mul_i32 s63, s63, 114688
    buffer_load_dwordx4 v248, s[28:31], s63 offen lds
    v_mfma_f32_16x16x32_bf16 v[76:79], v[172:175], a[4:7], 0
    ds_read_b64_tr_b16 v[196:197], v16 offset:8192
    ds_read_b64_tr_b16 v[198:199], v16 offset:12288
    v_mfma_f32_16x16x32_bf16 v[108:111], v[172:175], a[8:11], 0
    v_mfma_f32_16x16x32_bf16 v[140:143], v[172:175], a[12:15], 0
    s_add_u32 m0, s53, 58368
    s_nop 0
    buffer_load_dwordx4 v248, s[32:35], s63 offen lds
    s_waitcnt lgkmcnt(10)
    v_mfma_f32_16x16x32_bf16 v[48:51], v[176:179], a[0:3], 0
    ds_read_b64_tr_b16 v[200:201], v16 offset:9216
    ds_read_b64_tr_b16 v[202:203], v16 offset:13312
    v_mfma_f32_16x16x32_bf16 v[80:83], v[176:179], a[4:7], 0
    v_mfma_f32_16x16x32_bf16 v[112:115], v[176:179], a[8:11], 0
    buffer_load_dwordx4 a[0:3], v18, s[44:47], s96 offen offset:0 sc1
    v_mfma_f32_16x16x32_bf16 v[144:147], v[176:179], a[12:15], 0
    s_waitcnt lgkmcnt(10)
    s_waitcnt vmcnt(22)
    v_mfma_f32_16x16x32_bf16 v[20:23], v[180:183], a[16:19], v[20:23]
    ds_read_b64_tr_b16 v[204:205], v17 offset:8192
    ds_read_b64_tr_b16 v[206:207], v17 offset:12288
    s_waitcnt vmcnt(21)
    v_mfma_f32_16x16x32_bf16 v[52:55], v[180:183], a[20:23], v[52:55]
    s_waitcnt vmcnt(20)
    v_mfma_f32_16x16x32_bf16 v[84:87], v[180:183], a[24:27], v[84:87]
    s_waitcnt vmcnt(19)
    v_mfma_f32_16x16x32_bf16 v[116:119], v[180:183], a[28:31], v[116:119]
    s_waitcnt lgkmcnt(10)
    v_mfma_f32_16x16x32_bf16 v[24:27], v[184:187], a[16:19], v[24:27]
    ds_read_b64_tr_b16 v[208:209], v17 offset:9216
    ds_read_b64_tr_b16 v[210:211], v17 offset:13312
    v_mfma_f32_16x16x32_bf16 v[56:59], v[184:187], a[20:23], v[56:59]
    v_mfma_f32_16x16x32_bf16 v[88:91], v[184:187], a[24:27], v[88:91]
    v_mfma_f32_16x16x32_bf16 v[120:123], v[184:187], a[28:31], v[120:123]
    s_waitcnt lgkmcnt(10)
    v_mfma_f32_16x16x32_bf16 v[28:31], v[188:191], a[16:19], v[28:31]
    ds_read_b64_tr_b16 v[212:213], v14 offset:16384
    ds_read_b64_tr_b16 v[214:215], v14 offset:20480
    v_mfma_f32_16x16x32_bf16 v[60:63], v[188:191], a[20:23], v[60:63]
    v_mfma_f32_16x16x32_bf16 v[92:95], v[188:191], a[24:27], v[92:95]
    v_mfma_f32_16x16x32_bf16 v[124:127], v[188:191], a[28:31], v[124:127]
    s_waitcnt lgkmcnt(10)
    v_mfma_f32_16x16x32_bf16 v[32:35], v[192:195], a[16:19], v[32:35]
    ds_read_b64_tr_b16 v[216:217], v14 offset:17408
    ds_read_b64_tr_b16 v[218:219], v14 offset:21504
    v_mfma_f32_16x16x32_bf16 v[64:67], v[192:195], a[20:23], v[64:67]
    v_mfma_f32_16x16x32_bf16 v[96:99], v[192:195], a[24:27], v[96:99]
    v_mfma_f32_16x16x32_bf16 v[128:131], v[192:195], a[28:31], v[128:131]
    s_waitcnt lgkmcnt(10)
    v_mfma_f32_16x16x32_bf16 v[36:39], v[196:199], a[16:19], v[36:39]
    ds_read_b64_tr_b16 v[220:221], v15 offset:16384
    ds_read_b64_tr_b16 v[222:223], v15 offset:20480
    v_mfma_f32_16x16x32_bf16 v[68:71], v[196:199], a[20:23], v[68:71]
    v_mfma_f32_16x16x32_bf16 v[100:103], v[196:199], a[24:27], v[100:103]
    v_mfma_f32_16x16x32_bf16 v[132:135], v[196:199], a[28:31], v[132:135]
    s_waitcnt lgkmcnt(10)
    v_mfma_f32_16x16x32_bf16 v[40:43], v[200:203], a[16:19], v[40:43]
    ds_read_b64_tr_b16 v[224:225], v15 offset:17408
    ds_read_b64_tr_b16 v[226:227], v15 offset:21504
    v_mfma_f32_16x16x32_bf16 v[72:75], v[200:203], a[20:23], v[72:75]
    v_mfma_f32_16x16x32_bf16 v[104:107], v[200:203], a[24:27], v[104:107]
    v_mfma_f32_16x16x32_bf16 v[136:139], v[200:203], a[28:31], v[136:139]
    s_waitcnt lgkmcnt(10)
    v_mfma_f32_16x16x32_bf16 v[44:47], v[204:207], a[16:19], v[44:47]
    ds_read_b64_tr_b16 v[148:149], v16 offset:16384
    ds_read_b64_tr_b16 v[150:151], v16 offset:20480
    v_mfma_f32_16x16x32_bf16 v[76:79], v[204:207], a[20:23], v[76:79]
    v_mfma_f32_16x16x32_bf16 v[108:111], v[204:207], a[24:27], v[108:111]
    v_mfma_f32_16x16x32_bf16 v[140:143], v[204:207], a[28:31], v[140:143]
    s_waitcnt lgkmcnt(10)
    v_mfma_f32_16x16x32_bf16 v[48:51], v[208:211], a[16:19], v[48:51]
    ds_read_b64_tr_b16 v[152:153], v16 offset:17408
    ds_read_b64_tr_b16 v[154:155], v16 offset:21504
    v_mfma_f32_16x16x32_bf16 v[80:83], v[208:211], a[20:23], v[80:83]
    v_mfma_f32_16x16x32_bf16 v[112:115], v[208:211], a[24:27], v[112:115]
    v_mfma_f32_16x16x32_bf16 v[144:147], v[208:211], a[28:31], v[144:147]
    s_waitcnt lgkmcnt(10)
    s_waitcnt vmcnt(18)
    v_mfma_f32_16x16x32_bf16 v[20:23], v[212:215], a[32:35], v[20:23]
    ds_read_b64_tr_b16 v[156:157], v17 offset:16384
    ds_read_b64_tr_b16 v[158:159], v17 offset:20480
    s_waitcnt vmcnt(17)
    v_mfma_f32_16x16x32_bf16 v[52:55], v[212:215], a[36:39], v[52:55]
    s_waitcnt vmcnt(16)
    v_mfma_f32_16x16x32_bf16 v[84:87], v[212:215], a[40:43], v[84:87]
    s_waitcnt vmcnt(15)
    v_mfma_f32_16x16x32_bf16 v[116:119], v[212:215], a[44:47], v[116:119]
    s_waitcnt lgkmcnt(10)
    v_mfma_f32_16x16x32_bf16 v[24:27], v[216:219], a[32:35], v[24:27]
    ds_read_b64_tr_b16 v[160:161], v17 offset:17408
    ds_read_b64_tr_b16 v[162:163], v17 offset:21504
    v_mfma_f32_16x16x32_bf16 v[56:59], v[216:219], a[36:39], v[56:59]
    v_mfma_f32_16x16x32_bf16 v[88:91], v[216:219], a[40:43], v[88:91]
    v_mfma_f32_16x16x32_bf16 v[120:123], v[216:219], a[44:47], v[120:123]
    s_waitcnt lgkmcnt(10)
    v_mfma_f32_16x16x32_bf16 v[28:31], v[220:223], a[32:35], v[28:31]
    ds_read_b64_tr_b16 v[164:165], v14 offset:24576
    ds_read_b64_tr_b16 v[166:167], v14 offset:28672
    v_mfma_f32_16x16x32_bf16 v[60:63], v[220:223], a[36:39], v[60:63]
    v_mfma_f32_16x16x32_bf16 v[92:95], v[220:223], a[40:43], v[92:95]
    v_mfma_f32_16x16x32_bf16 v[124:127], v[220:223], a[44:47], v[124:127]
    s_waitcnt lgkmcnt(10)
    v_mfma_f32_16x16x32_bf16 v[32:35], v[224:227], a[32:35], v[32:35]
    ds_read_b64_tr_b16 v[168:169], v14 offset:25600
    ds_read_b64_tr_b16 v[170:171], v14 offset:29696
    v_mfma_f32_16x16x32_bf16 v[64:67], v[224:227], a[36:39], v[64:67]
    v_mfma_f32_16x16x32_bf16 v[96:99], v[224:227], a[40:43], v[96:99]
    v_mfma_f32_16x16x32_bf16 v[128:131], v[224:227], a[44:47], v[128:131]
    s_waitcnt lgkmcnt(10)
    v_mfma_f32_16x16x32_bf16 v[36:39], v[148:151], a[32:35], v[36:39]
    ds_read_b64_tr_b16 v[172:173], v15 offset:24576
    ds_read_b64_tr_b16 v[174:175], v15 offset:28672
    v_mfma_f32_16x16x32_bf16 v[68:71], v[148:151], a[36:39], v[68:71]
    v_mfma_f32_16x16x32_bf16 v[100:103], v[148:151], a[40:43], v[100:103]
    v_mfma_f32_16x16x32_bf16 v[132:135], v[148:151], a[44:47], v[132:135]
    s_waitcnt lgkmcnt(10)
    v_mfma_f32_16x16x32_bf16 v[40:43], v[152:155], a[32:35], v[40:43]
    ds_read_b64_tr_b16 v[176:177], v15 offset:25600
    ds_read_b64_tr_b16 v[178:179], v15 offset:29696
    v_mfma_f32_16x16x32_bf16 v[72:75], v[152:155], a[36:39], v[72:75]
    v_mfma_f32_16x16x32_bf16 v[104:107], v[152:155], a[40:43], v[104:107]
    v_mfma_f32_16x16x32_bf16 v[136:139], v[152:155], a[44:47], v[136:139]
    s_waitcnt lgkmcnt(10)
    v_mfma_f32_16x16x32_bf16 v[44:47], v[156:159], a[32:35], v[44:47]
    ds_read_b64_tr_b16 v[180:181], v16 offset:24576
    ds_read_b64_tr_b16 v[182:183], v16 offset:28672
    v_mfma_f32_16x16x32_bf16 v[76:79], v[156:159], a[36:39], v[76:79]
    v_mfma_f32_16x16x32_bf16 v[108:111], v[156:159], a[40:43], v[108:111]
    v_mfma_f32_16x16x32_bf16 v[140:143], v[156:159], a[44:47], v[140:143]
    s_waitcnt lgkmcnt(10)
    v_mfma_f32_16x16x32_bf16 v[48:51], v[160:163], a[32:35], v[48:51]
    ds_read_b64_tr_b16 v[184:185], v16 offset:25600
    ds_read_b64_tr_b16 v[186:187], v16 offset:29696
    v_mfma_f32_16x16x32_bf16 v[80:83], v[160:163], a[36:39], v[80:83]
    v_mfma_f32_16x16x32_bf16 v[112:115], v[160:163], a[40:43], v[112:115]
    buffer_load_dwordx4 a[4:7], v18, s[44:47], s97 offen offset:0 sc1
    v_mfma_f32_16x16x32_bf16 v[144:147], v[160:163], a[44:47], v[144:147]
    s_waitcnt lgkmcnt(10)
    s_waitcnt vmcnt(15)
    v_mfma_f32_16x16x32_bf16 v[20:23], v[164:167], a[48:51], v[20:23]
    ds_read_b64_tr_b16 v[188:189], v17 offset:24576
    ds_read_b64_tr_b16 v[190:191], v17 offset:28672
    s_waitcnt vmcnt(14)
    v_mfma_f32_16x16x32_bf16 v[52:55], v[164:167], a[52:55], v[52:55]
    s_waitcnt vmcnt(13)
    v_mfma_f32_16x16x32_bf16 v[84:87], v[164:167], a[56:59], v[84:87]
    buffer_load_dwordx4 a[8:11], v18, s[44:47], s98 offen offset:0 sc1
    s_waitcnt vmcnt(13)
    v_mfma_f32_16x16x32_bf16 v[116:119], v[164:167], a[60:63], v[116:119]
    s_waitcnt lgkmcnt(10)
    v_mfma_f32_16x16x32_bf16 v[24:27], v[168:171], a[48:51], v[24:27]
    ds_read_b64_tr_b16 v[192:193], v17 offset:25600
    ds_read_b64_tr_b16 v[194:195], v17 offset:29696
    v_mfma_f32_16x16x32_bf16 v[56:59], v[168:171], a[52:55], v[56:59]
    v_mfma_f32_16x16x32_bf16 v[88:91], v[168:171], a[56:59], v[88:91]
    buffer_load_dwordx4 a[12:15], v18, s[44:47], s99 offen offset:0 sc1
    v_mfma_f32_16x16x32_bf16 v[120:123], v[168:171], a[60:63], v[120:123]
    s_waitcnt lgkmcnt(10)
    v_mfma_f32_16x16x32_bf16 v[28:31], v[172:175], a[48:51], v[28:31]
    ds_read_b64_tr_b16 v[196:197], v14 offset:32768
    ds_read_b64_tr_b16 v[198:199], v14 offset:36864
    v_mfma_f32_16x16x32_bf16 v[60:63], v[172:175], a[52:55], v[60:63]
    v_mfma_f32_16x16x32_bf16 v[92:95], v[172:175], a[56:59], v[92:95]
    buffer_load_dwordx4 a[16:19], v18, s[44:47], s96 offen offset:1024 sc1
    v_mfma_f32_16x16x32_bf16 v[124:127], v[172:175], a[60:63], v[124:127]
    s_waitcnt lgkmcnt(10)
    v_mfma_f32_16x16x32_bf16 v[32:35], v[176:179], a[48:51], v[32:35]
    ds_read_b64_tr_b16 v[200:201], v14 offset:33792
    ds_read_b64_tr_b16 v[202:203], v14 offset:37888
    v_mfma_f32_16x16x32_bf16 v[64:67], v[176:179], a[52:55], v[64:67]
    v_mfma_f32_16x16x32_bf16 v[96:99], v[176:179], a[56:59], v[96:99]
    buffer_load_dwordx4 a[20:23], v18, s[44:47], s97 offen offset:1024 sc1
    v_mfma_f32_16x16x32_bf16 v[128:131], v[176:179], a[60:63], v[128:131]
    s_waitcnt lgkmcnt(10)
    v_mfma_f32_16x16x32_bf16 v[36:39], v[180:183], a[48:51], v[36:39]
    ds_read_b64_tr_b16 v[204:205], v15 offset:32768
    ds_read_b64_tr_b16 v[206:207], v15 offset:36864
    v_mfma_f32_16x16x32_bf16 v[68:71], v[180:183], a[52:55], v[68:71]
    v_mfma_f32_16x16x32_bf16 v[100:103], v[180:183], a[56:59], v[100:103]
    buffer_load_dwordx4 a[24:27], v18, s[44:47], s98 offen offset:1024 sc1
    v_mfma_f32_16x16x32_bf16 v[132:135], v[180:183], a[60:63], v[132:135]
    s_waitcnt lgkmcnt(10)
    v_mfma_f32_16x16x32_bf16 v[40:43], v[184:187], a[48:51], v[40:43]
    ds_read_b64_tr_b16 v[208:209], v15 offset:33792
    ds_read_b64_tr_b16 v[210:211], v15 offset:37888
    v_mfma_f32_16x16x32_bf16 v[72:75], v[184:187], a[52:55], v[72:75]
    v_mfma_f32_16x16x32_bf16 v[104:107], v[184:187], a[56:59], v[104:107]
    buffer_load_dwordx4 a[28:31], v18, s[44:47], s99 offen offset:1024 sc1
    v_mfma_f32_16x16x32_bf16 v[136:139], v[184:187], a[60:63], v[136:139]
    s_waitcnt lgkmcnt(10)
    v_mfma_f32_16x16x32_bf16 v[44:47], v[188:191], a[48:51], v[44:47]
    ds_read_b64_tr_b16 v[212:213], v16 offset:32768
    ds_read_b64_tr_b16 v[214:215], v16 offset:36864
    v_mfma_f32_16x16x32_bf16 v[76:79], v[188:191], a[52:55], v[76:79]
    v_mfma_f32_16x16x32_bf16 v[108:111], v[188:191], a[56:59], v[108:111]
    buffer_load_dwordx4 a[32:35], v18, s[44:47], s8 offen offset:0 sc1
    v_mfma_f32_16x16x32_bf16 v[140:143], v[188:191], a[60:63], v[140:143]
    s_waitcnt lgkmcnt(10)
    v_mfma_f32_16x16x32_bf16 v[48:51], v[192:195], a[48:51], v[48:51]
    s_waitcnt vmcnt(17)
    s_barrier
    ds_read_b64_tr_b16 v[216:217], v16 offset:33792
    ds_read_b64_tr_b16 v[218:219], v16 offset:37888
    v_mfma_f32_16x16x32_bf16 v[80:83], v[192:195], a[52:55], v[80:83]
    v_mfma_f32_16x16x32_bf16 v[112:115], v[192:195], a[56:59], v[112:115]
    buffer_load_dwordx4 a[36:39], v18, s[44:47], s9 offen offset:0 sc1
    v_mfma_f32_16x16x32_bf16 v[144:147], v[192:195], a[60:63], v[144:147]
    s_waitcnt lgkmcnt(10)
    s_waitcnt vmcnt(9)
    v_mfma_f32_16x16x32_bf16 v[20:23], v[196:199], a[0:3], v[20:23]
    ds_read_b64_tr_b16 v[220:221], v17 offset:32768
    ds_read_b64_tr_b16 v[222:223], v17 offset:36864
    s_waitcnt vmcnt(8)
    v_mfma_f32_16x16x32_bf16 v[52:55], v[196:199], a[4:7], v[52:55]
    s_waitcnt vmcnt(7)
    v_mfma_f32_16x16x32_bf16 v[84:87], v[196:199], a[8:11], v[84:87]
    buffer_load_dwordx4 a[40:43], v18, s[44:47], s10 offen offset:0 sc1
    s_waitcnt vmcnt(7)
    v_mfma_f32_16x16x32_bf16 v[116:119], v[196:199], a[12:15], v[116:119]
    s_waitcnt lgkmcnt(10)
    v_mfma_f32_16x16x32_bf16 v[24:27], v[200:203], a[0:3], v[24:27]
    ds_read_b64_tr_b16 v[224:225], v17 offset:33792
    ds_read_b64_tr_b16 v[226:227], v17 offset:37888
    v_mfma_f32_16x16x32_bf16 v[56:59], v[200:203], a[4:7], v[56:59]
    v_mfma_f32_16x16x32_bf16 v[88:91], v[200:203], a[8:11], v[88:91]
    buffer_load_dwordx4 a[44:47], v18, s[44:47], s52 offen offset:0 sc1
    v_mfma_f32_16x16x32_bf16 v[120:123], v[200:203], a[12:15], v[120:123]
    s_waitcnt lgkmcnt(10)
    v_mfma_f32_16x16x32_bf16 v[28:31], v[204:207], a[0:3], v[28:31]
    ds_read_b64_tr_b16 v[148:149], v14 offset:40960
    ds_read_b64_tr_b16 v[150:151], v14 offset:45056
    v_mfma_f32_16x16x32_bf16 v[60:63], v[204:207], a[4:7], v[60:63]
    v_mfma_f32_16x16x32_bf16 v[92:95], v[204:207], a[8:11], v[92:95]
    buffer_load_dwordx4 a[48:51], v18, s[44:47], s8 offen offset:1024 sc1
    v_mfma_f32_16x16x32_bf16 v[124:127], v[204:207], a[12:15], v[124:127]
    s_waitcnt lgkmcnt(10)
    v_mfma_f32_16x16x32_bf16 v[32:35], v[208:211], a[0:3], v[32:35]
    ds_read_b64_tr_b16 v[152:153], v14 offset:41984
    ds_read_b64_tr_b16 v[154:155], v14 offset:46080
    v_mfma_f32_16x16x32_bf16 v[64:67], v[208:211], a[4:7], v[64:67]
    v_mfma_f32_16x16x32_bf16 v[96:99], v[208:211], a[8:11], v[96:99]
    buffer_load_dwordx4 a[52:55], v18, s[44:47], s9 offen offset:1024 sc1
    v_mfma_f32_16x16x32_bf16 v[128:131], v[208:211], a[12:15], v[128:131]
    s_waitcnt lgkmcnt(10)
    v_mfma_f32_16x16x32_bf16 v[36:39], v[212:215], a[0:3], v[36:39]
    ds_read_b64_tr_b16 v[156:157], v15 offset:40960
    ds_read_b64_tr_b16 v[158:159], v15 offset:45056
    v_mfma_f32_16x16x32_bf16 v[68:71], v[212:215], a[4:7], v[68:71]
    v_mfma_f32_16x16x32_bf16 v[100:103], v[212:215], a[8:11], v[100:103]
    buffer_load_dwordx4 a[56:59], v18, s[44:47], s10 offen offset:1024 sc1
    v_mfma_f32_16x16x32_bf16 v[132:135], v[212:215], a[12:15], v[132:135]
    s_waitcnt lgkmcnt(10)
    v_mfma_f32_16x16x32_bf16 v[40:43], v[216:219], a[0:3], v[40:43]
    ds_read_b64_tr_b16 v[160:161], v15 offset:41984
    ds_read_b64_tr_b16 v[162:163], v15 offset:46080
    v_mfma_f32_16x16x32_bf16 v[72:75], v[216:219], a[4:7], v[72:75]
    v_mfma_f32_16x16x32_bf16 v[104:107], v[216:219], a[8:11], v[104:107]
    buffer_load_dwordx4 a[60:63], v18, s[44:47], s52 offen offset:1024 sc1
    v_mfma_f32_16x16x32_bf16 v[136:139], v[216:219], a[12:15], v[136:139]
    s_waitcnt lgkmcnt(10)
    v_mfma_f32_16x16x32_bf16 v[44:47], v[220:223], a[0:3], v[44:47]
    ds_read_b64_tr_b16 v[164:165], v16 offset:40960
    ds_read_b64_tr_b16 v[166:167], v16 offset:45056
    v_mfma_f32_16x16x32_bf16 v[76:79], v[220:223], a[4:7], v[76:79]
    v_mfma_f32_16x16x32_bf16 v[108:111], v[220:223], a[8:11], v[108:111]
    buffer_load_dwordx4 a[128:131], v251, s[44:47], s96 offen offset:0 sc1
    v_mfma_f32_16x16x32_bf16 v[140:143], v[220:223], a[12:15], v[140:143]
    s_waitcnt lgkmcnt(10)
    v_mfma_f32_16x16x32_bf16 v[48:51], v[224:227], a[0:3], v[48:51]
    ds_read_b64_tr_b16 v[168:169], v16 offset:41984
    ds_read_b64_tr_b16 v[170:171], v16 offset:46080
    v_mfma_f32_16x16x32_bf16 v[80:83], v[224:227], a[4:7], v[80:83]
    ds_read_b64_tr_b16 a[0:1], v252 offset:0
    ds_read_b64_tr_b16 a[2:3], v252 offset:2048
    v_mfma_f32_16x16x32_bf16 v[112:115], v[224:227], a[8:11], v[112:115]
    buffer_load_dwordx4 a[132:135], v251, s[44:47], s97 offen offset:0 sc1
    ds_read_b64_tr_b16 a[4:5], v253 offset:0
    v_mfma_f32_16x16x32_bf16 v[144:147], v[224:227], a[12:15], v[144:147]
    ds_read_b64_tr_b16 a[6:7], v253 offset:2048
    ds_read_b64_tr_b16 a[8:9], v254 offset:0
    s_waitcnt lgkmcnt(15)
    s_waitcnt vmcnt(13)
    v_mfma_f32_16x16x32_bf16 v[20:23], v[148:151], a[16:19], v[20:23]
    ds_read_b64_tr_b16 v[172:173], v17 offset:40960
    ds_read_b64_tr_b16 v[174:175], v17 offset:45056
    s_waitcnt vmcnt(12)
    v_mfma_f32_16x16x32_bf16 v[52:55], v[148:151], a[20:23], v[52:55]
    ds_read_b64_tr_b16 a[10:11], v254 offset:2048
    ds_read_b64_tr_b16 a[12:13], v255 offset:0
    s_waitcnt vmcnt(11)
    v_mfma_f32_16x16x32_bf16 v[84:87], v[148:151], a[24:27], v[84:87]
    buffer_load_dwordx4 a[136:139], v251, s[44:47], s98 offen offset:0 sc1
    ds_read_b64_tr_b16 a[14:15], v255 offset:2048
    s_waitcnt vmcnt(11)
    v_mfma_f32_16x16x32_bf16 v[116:119], v[148:151], a[28:31], v[116:119]
    s_waitcnt lgkmcnt(15)
    v_mfma_f32_16x16x32_bf16 v[24:27], v[152:155], a[16:19], v[24:27]
    ds_read_b64_tr_b16 v[176:177], v17 offset:41984
    ds_read_b64_tr_b16 v[178:179], v17 offset:46080
    v_mfma_f32_16x16x32_bf16 v[56:59], v[152:155], a[20:23], v[56:59]
    v_mfma_f32_16x16x32_bf16 v[88:91], v[152:155], a[24:27], v[88:91]
    buffer_load_dwordx4 a[140:143], v251, s[44:47], s99 offen offset:0 sc1
    v_mfma_f32_16x16x32_bf16 v[120:123], v[152:155], a[28:31], v[120:123]
    v_mfma_f32_16x16x32_bf16 v[28:31], v[156:159], a[16:19], v[28:31]
    ds_read_b64_tr_b16 v[180:181], v14 offset:49152
    ds_read_b64_tr_b16 v[182:183], v14 offset:53248
    v_mfma_f32_16x16x32_bf16 v[60:63], v[156:159], a[20:23], v[60:63]
    v_mfma_f32_16x16x32_bf16 v[92:95], v[156:159], a[24:27], v[92:95]
    buffer_load_dwordx4 a[144:147], v251, s[44:47], s96 offen offset:1024 sc1
    v_mfma_f32_16x16x32_bf16 v[124:127], v[156:159], a[28:31], v[124:127]
    s_waitcnt lgkmcnt(15)
    v_mfma_f32_16x16x32_bf16 v[32:35], v[160:163], a[16:19], v[32:35]
    ds_read_b64_tr_b16 v[184:185], v14 offset:50176
    ds_read_b64_tr_b16 v[186:187], v14 offset:54272
    v_mfma_f32_16x16x32_bf16 v[64:67], v[160:163], a[20:23], v[64:67]
    v_mfma_f32_16x16x32_bf16 v[96:99], v[160:163], a[24:27], v[96:99]
    buffer_load_dwordx4 a[148:151], v251, s[44:47], s97 offen offset:1024 sc1
    v_mfma_f32_16x16x32_bf16 v[128:131], v[160:163], a[28:31], v[128:131]
    v_mfma_f32_16x16x32_bf16 v[36:39], v[164:167], a[16:19], v[36:39]
    ds_read_b64_tr_b16 v[188:189], v15 offset:49152
    ds_read_b64_tr_b16 v[190:191], v15 offset:53248
    v_mfma_f32_16x16x32_bf16 v[68:71], v[164:167], a[20:23], v[68:71]
    v_mfma_f32_16x16x32_bf16 v[100:103], v[164:167], a[24:27], v[100:103]
    buffer_load_dwordx4 a[152:155], v251, s[44:47], s98 offen offset:1024 sc1
    v_mfma_f32_16x16x32_bf16 v[132:135], v[164:167], a[28:31], v[132:135]
    s_waitcnt lgkmcnt(15)
    v_mfma_f32_16x16x32_bf16 v[40:43], v[168:171], a[16:19], v[40:43]
    ds_read_b64_tr_b16 v[192:193], v15 offset:50176
    ds_read_b64_tr_b16 v[194:195], v15 offset:54272
    v_mfma_f32_16x16x32_bf16 v[72:75], v[168:171], a[20:23], v[72:75]
    v_mfma_f32_16x16x32_bf16 v[104:107], v[168:171], a[24:27], v[104:107]
    buffer_load_dwordx4 a[156:159], v251, s[44:47], s99 offen offset:1024 sc1
    v_mfma_f32_16x16x32_bf16 v[136:139], v[168:171], a[28:31], v[136:139]
    s_waitcnt lgkmcnt(13)
    v_mfma_f32_16x16x32_bf16 v[44:47], v[172:175], a[16:19], v[44:47]
    ds_read_b64_tr_b16 v[196:197], v16 offset:49152
    ds_read_b64_tr_b16 v[198:199], v16 offset:53248
    v_mfma_f32_16x16x32_bf16 v[76:79], v[172:175], a[20:23], v[76:79]
    v_mfma_f32_16x16x32_bf16 v[108:111], v[172:175], a[24:27], v[108:111]
    buffer_load_dwordx4 a[160:163], v251, s[44:47], s8 offen offset:0 sc1
    v_mfma_f32_16x16x32_bf16 v[140:143], v[172:175], a[28:31], v[140:143]
    s_waitcnt lgkmcnt(10)
    v_mfma_f32_16x16x32_bf16 v[48:51], v[176:179], a[16:19], v[48:51]
    ds_read_b64_tr_b16 v[200:201], v16 offset:50176
    ds_read_b64_tr_b16 v[202:203], v16 offset:54272
    v_mfma_f32_16x16x32_bf16 v[80:83], v[176:179], a[20:23], v[80:83]
    ds_read_b64_tr_b16 a[16:17], v252 offset:4096
    ds_read_b64_tr_b16 a[18:19], v252 offset:6144
    v_mfma_f32_16x16x32_bf16 v[112:115], v[176:179], a[24:27], v[112:115]
    buffer_load_dwordx4 a[164:167], v251, s[44:47], s9 offen offset:0 sc1
    ds_read_b64_tr_b16 a[20:21], v253 offset:4096
    v_mfma_f32_16x16x32_bf16 v[144:147], v[176:179], a[28:31], v[144:147]
    ds_read_b64_tr_b16 a[22:23], v253 offset:6144
    ds_read_b64_tr_b16 a[24:25], v254 offset:4096
    s_waitcnt lgkmcnt(15)
    s_waitcnt vmcnt(17)
    v_mfma_f32_16x16x32_bf16 v[20:23], v[180:183], a[32:35], v[20:23]
    ds_read_b64_tr_b16 v[204:205], v17 offset:49152
    ds_read_b64_tr_b16 v[206:207], v17 offset:53248
    s_waitcnt vmcnt(16)
    v_mfma_f32_16x16x32_bf16 v[52:55], v[180:183], a[36:39], v[52:55]
    ds_read_b64_tr_b16 a[26:27], v254 offset:6144
    ds_read_b64_tr_b16 a[28:29], v255 offset:4096
    s_waitcnt vmcnt(15)
    v_mfma_f32_16x16x32_bf16 v[84:87], v[180:183], a[40:43], v[84:87]
    buffer_load_dwordx4 a[168:171], v251, s[44:47], s10 offen offset:0 sc1
    ds_read_b64_tr_b16 a[30:31], v255 offset:6144
    s_waitcnt vmcnt(15)
    v_mfma_f32_16x16x32_bf16 v[116:119], v[180:183], a[44:47], v[116:119]
    s_waitcnt lgkmcnt(15)
    v_mfma_f32_16x16x32_bf16 v[24:27], v[184:187], a[32:35], v[24:27]
    ds_read_b64_tr_b16 v[208:209], v17 offset:50176
    ds_read_b64_tr_b16 v[210:211], v17 offset:54272
    v_mfma_f32_16x16x32_bf16 v[56:59], v[184:187], a[36:39], v[56:59]
    v_mfma_f32_16x16x32_bf16 v[88:91], v[184:187], a[40:43], v[88:91]
    buffer_load_dwordx4 a[172:175], v251, s[44:47], s52 offen offset:0 sc1
    v_mfma_f32_16x16x32_bf16 v[120:123], v[184:187], a[44:47], v[120:123]
    v_mfma_f32_16x16x32_bf16 v[28:31], v[188:191], a[32:35], v[28:31]
    ds_read_b64_tr_b16 v[212:213], v14 offset:57344
    ds_read_b64_tr_b16 v[214:215], v14 offset:61440
    v_mfma_f32_16x16x32_bf16 v[60:63], v[188:191], a[36:39], v[60:63]
    v_mfma_f32_16x16x32_bf16 v[92:95], v[188:191], a[40:43], v[92:95]
    buffer_load_dwordx4 a[176:179], v251, s[44:47], s8 offen offset:1024 sc1
    v_mfma_f32_16x16x32_bf16 v[124:127], v[188:191], a[44:47], v[124:127]
    s_waitcnt lgkmcnt(15)
    v_mfma_f32_16x16x32_bf16 v[32:35], v[192:195], a[32:35], v[32:35]
    ds_read_b64_tr_b16 v[216:217], v14 offset:58368
    ds_read_b64_tr_b16 v[218:219], v14 offset:62464
    v_mfma_f32_16x16x32_bf16 v[64:67], v[192:195], a[36:39], v[64:67]
    v_mfma_f32_16x16x32_bf16 v[96:99], v[192:195], a[40:43], v[96:99]
    buffer_load_dwordx4 a[180:183], v251, s[44:47], s9 offen offset:1024 sc1
    v_mfma_f32_16x16x32_bf16 v[128:131], v[192:195], a[44:47], v[128:131]
    v_mfma_f32_16x16x32_bf16 v[36:39], v[196:199], a[32:35], v[36:39]
    ds_read_b64_tr_b16 v[220:221], v15 offset:57344
    ds_read_b64_tr_b16 v[222:223], v15 offset:61440
    v_mfma_f32_16x16x32_bf16 v[68:71], v[196:199], a[36:39], v[68:71]
    v_mfma_f32_16x16x32_bf16 v[100:103], v[196:199], a[40:43], v[100:103]
    buffer_load_dwordx4 a[184:187], v251, s[44:47], s10 offen offset:1024 sc1
    v_mfma_f32_16x16x32_bf16 v[132:135], v[196:199], a[44:47], v[132:135]
    s_waitcnt lgkmcnt(15)
    v_mfma_f32_16x16x32_bf16 v[40:43], v[200:203], a[32:35], v[40:43]
    ds_read_b64_tr_b16 v[224:225], v15 offset:58368
    ds_read_b64_tr_b16 v[226:227], v15 offset:62464
    v_mfma_f32_16x16x32_bf16 v[72:75], v[200:203], a[36:39], v[72:75]
    v_mfma_f32_16x16x32_bf16 v[104:107], v[200:203], a[40:43], v[104:107]
    buffer_load_dwordx4 a[188:191], v251, s[44:47], s52 offen offset:1024 sc1
    v_mfma_f32_16x16x32_bf16 v[136:139], v[200:203], a[44:47], v[136:139]
    s_waitcnt lgkmcnt(13)
    v_mfma_f32_16x16x32_bf16 v[44:47], v[204:207], a[32:35], v[44:47]
    ds_read_b64_tr_b16 v[148:149], v16 offset:57344
    ds_read_b64_tr_b16 v[150:151], v16 offset:61440
    v_mfma_f32_16x16x32_bf16 v[76:79], v[204:207], a[36:39], v[76:79]
    v_mfma_f32_16x16x32_bf16 v[108:111], v[204:207], a[40:43], v[108:111]
    buffer_load_dwordx4 a[192:195], v7, s[44:47], s96 offen offset:0 sc1
    v_mfma_f32_16x16x32_bf16 v[140:143], v[204:207], a[44:47], v[140:143]
    s_waitcnt lgkmcnt(10)
    v_mfma_f32_16x16x32_bf16 v[48:51], v[208:211], a[32:35], v[48:51]
    ds_read_b64_tr_b16 v[152:153], v16 offset:58368
    ds_read_b64_tr_b16 v[154:155], v16 offset:62464
    v_mfma_f32_16x16x32_bf16 v[80:83], v[208:211], a[36:39], v[80:83]
    ds_read_b64_tr_b16 a[32:33], v252 offset:8192
    ds_read_b64_tr_b16 a[34:35], v252 offset:10240
    v_mfma_f32_16x16x32_bf16 v[112:115], v[208:211], a[40:43], v[112:115]
    buffer_load_dwordx4 a[196:199], v7, s[44:47], s97 offen offset:0 sc1
    ds_read_b64_tr_b16 a[36:37], v253 offset:8192
    v_mfma_f32_16x16x32_bf16 v[144:147], v[208:211], a[44:47], v[144:147]
    ds_read_b64_tr_b16 a[38:39], v253 offset:10240
    ds_read_b64_tr_b16 a[40:41], v254 offset:8192
    s_waitcnt lgkmcnt(15)
    s_waitcnt vmcnt(21)
    v_mfma_f32_16x16x32_bf16 v[20:23], v[212:215], a[48:51], v[20:23]
    ds_read_b64_tr_b16 v[156:157], v17 offset:57344
    ds_read_b64_tr_b16 v[158:159], v17 offset:61440
    s_waitcnt vmcnt(20)
    v_mfma_f32_16x16x32_bf16 v[52:55], v[212:215], a[52:55], v[52:55]
    ds_read_b64_tr_b16 a[42:43], v254 offset:10240
    ds_read_b64_tr_b16 a[44:45], v255 offset:8192
    s_waitcnt vmcnt(19)
    v_mfma_f32_16x16x32_bf16 v[84:87], v[212:215], a[56:59], v[84:87]
    buffer_load_dwordx4 a[200:203], v7, s[44:47], s98 offen offset:0 sc1
    ds_read_b64_tr_b16 a[46:47], v255 offset:10240
    s_waitcnt vmcnt(19)
    v_mfma_f32_16x16x32_bf16 v[116:119], v[212:215], a[60:63], v[116:119]
    s_waitcnt lgkmcnt(15)
    v_mfma_f32_16x16x32_bf16 v[24:27], v[216:219], a[48:51], v[24:27]
    ds_read_b64_tr_b16 v[160:161], v17 offset:58368
    ds_read_b64_tr_b16 v[162:163], v17 offset:62464
    v_mfma_f32_16x16x32_bf16 v[56:59], v[216:219], a[52:55], v[56:59]
    v_mfma_f32_16x16x32_bf16 v[88:91], v[216:219], a[56:59], v[88:91]
    buffer_load_dwordx4 a[204:207], v7, s[44:47], s99 offen offset:0 sc1
    v_mfma_f32_16x16x32_bf16 v[120:123], v[216:219], a[60:63], v[120:123]
    v_mfma_f32_16x16x32_bf16 v[28:31], v[220:223], a[48:51], v[28:31]
    v_add_u32 v14, 65536, v14
    ds_read_b64_tr_b16 v[164:165], v14 offset:0
    ds_read_b64_tr_b16 v[166:167], v14 offset:4096
    v_mfma_f32_16x16x32_bf16 v[60:63], v[220:223], a[52:55], v[60:63]
    v_mfma_f32_16x16x32_bf16 v[92:95], v[220:223], a[56:59], v[92:95]
    buffer_load_dwordx4 a[208:211], v7, s[44:47], s96 offen offset:1024 sc1
    v_mfma_f32_16x16x32_bf16 v[124:127], v[220:223], a[60:63], v[124:127]
    s_waitcnt lgkmcnt(15)
    v_mfma_f32_16x16x32_bf16 v[32:35], v[224:227], a[48:51], v[32:35]
    ds_read_b64_tr_b16 v[168:169], v14 offset:1024
    ds_read_b64_tr_b16 v[170:171], v14 offset:5120
    v_mfma_f32_16x16x32_bf16 v[64:67], v[224:227], a[52:55], v[64:67]
    v_mfma_f32_16x16x32_bf16 v[96:99], v[224:227], a[56:59], v[96:99]
    buffer_load_dwordx4 a[212:215], v7, s[44:47], s97 offen offset:1024 sc1
    v_mfma_f32_16x16x32_bf16 v[128:131], v[224:227], a[60:63], v[128:131]
    v_mfma_f32_16x16x32_bf16 v[36:39], v[148:151], a[48:51], v[36:39]
    v_add_u32 v15, 65536, v15
    ds_read_b64_tr_b16 v[172:173], v15 offset:0
    ds_read_b64_tr_b16 v[174:175], v15 offset:4096
    v_mfma_f32_16x16x32_bf16 v[68:71], v[148:151], a[52:55], v[68:71]
    v_mfma_f32_16x16x32_bf16 v[100:103], v[148:151], a[56:59], v[100:103]
    buffer_load_dwordx4 a[216:219], v7, s[44:47], s98 offen offset:1024 sc1
    v_mfma_f32_16x16x32_bf16 v[132:135], v[148:151], a[60:63], v[132:135]
    s_waitcnt lgkmcnt(15)
    v_mfma_f32_16x16x32_bf16 v[40:43], v[152:155], a[48:51], v[40:43]
    ds_read_b64_tr_b16 v[176:177], v15 offset:1024
    ds_read_b64_tr_b16 v[178:179], v15 offset:5120
    v_mfma_f32_16x16x32_bf16 v[72:75], v[152:155], a[52:55], v[72:75]
    v_mfma_f32_16x16x32_bf16 v[104:107], v[152:155], a[56:59], v[104:107]
    buffer_load_dwordx4 a[220:223], v7, s[44:47], s99 offen offset:1024 sc1
    v_mfma_f32_16x16x32_bf16 v[136:139], v[152:155], a[60:63], v[136:139]
    s_waitcnt lgkmcnt(13)
    v_mfma_f32_16x16x32_bf16 v[44:47], v[156:159], a[48:51], v[44:47]
    ds_read_b64_tr_b16 v[180:181], v14 offset:8192
    ds_read_b64_tr_b16 v[182:183], v14 offset:12288
    v_mfma_f32_16x16x32_bf16 v[76:79], v[156:159], a[52:55], v[76:79]
    v_mfma_f32_16x16x32_bf16 v[108:111], v[156:159], a[56:59], v[108:111]
    buffer_load_dwordx4 a[224:227], v7, s[44:47], s8 offen offset:0 sc1
    v_mfma_f32_16x16x32_bf16 v[140:143], v[156:159], a[60:63], v[140:143]
    s_waitcnt lgkmcnt(10)
    v_mfma_f32_16x16x32_bf16 v[48:51], v[160:163], a[48:51], v[48:51]
    ds_read_b64_tr_b16 v[184:185], v14 offset:9216
    ds_read_b64_tr_b16 v[186:187], v14 offset:13312
    v_mfma_f32_16x16x32_bf16 v[80:83], v[160:163], a[52:55], v[80:83]
    ds_read_b64_tr_b16 a[48:49], v252 offset:12288
    ds_read_b64_tr_b16 a[50:51], v252 offset:14336
    v_mfma_f32_16x16x32_bf16 v[112:115], v[160:163], a[56:59], v[112:115]
    buffer_load_dwordx4 a[228:231], v7, s[44:47], s9 offen offset:0 sc1
    ds_read_b64_tr_b16 a[52:53], v253 offset:12288
    v_mfma_f32_16x16x32_bf16 v[144:147], v[160:163], a[60:63], v[144:147]
    ds_read_b64_tr_b16 a[54:55], v253 offset:14336
    ds_read_b64_tr_b16 a[56:57], v254 offset:12288
    s_waitcnt lgkmcnt(15)
    s_waitcnt vmcnt(25)
    v_mfma_f32_16x16x32_bf16 v[20:23], v[164:167], a[128:131], v[20:23]
    ds_read_b64_tr_b16 v[188:189], v15 offset:8192
    ds_read_b64_tr_b16 v[190:191], v15 offset:12288
    s_waitcnt vmcnt(24)
    v_mfma_f32_16x16x32_bf16 v[52:55], v[164:167], a[132:135], v[52:55]
    ds_read_b64_tr_b16 a[58:59], v254 offset:14336
    ds_read_b64_tr_b16 a[60:61], v255 offset:12288
    s_waitcnt vmcnt(23)
    v_mfma_f32_16x16x32_bf16 v[84:87], v[164:167], a[136:139], v[84:87]
    buffer_load_dwordx4 a[232:235], v7, s[44:47], s10 offen offset:0 sc1
    ds_read_b64_tr_b16 a[62:63], v255 offset:14336
    s_waitcnt vmcnt(23)
    v_mfma_f32_16x16x32_bf16 v[116:119], v[164:167], a[140:143], v[116:119]
    s_waitcnt lgkmcnt(15)
    v_mfma_f32_16x16x32_bf16 v[24:27], v[168:171], a[128:131], v[24:27]
    ds_read_b64_tr_b16 v[192:193], v15 offset:9216
    ds_read_b64_tr_b16 v[194:195], v15 offset:13312
    v_mfma_f32_16x16x32_bf16 v[56:59], v[168:171], a[132:135], v[56:59]
    v_mfma_f32_16x16x32_bf16 v[88:91], v[168:171], a[136:139], v[88:91]
    buffer_load_dwordx4 a[236:239], v7, s[44:47], s52 offen offset:0 sc1
    v_mfma_f32_16x16x32_bf16 v[120:123], v[168:171], a[140:143], v[120:123]
    v_mfma_f32_16x16x32_bf16 v[28:31], v[172:175], a[128:131], v[28:31]
    s_waitcnt lgkmcnt(2)
    s_barrier
    ds_read_b64_tr_b16 v[196:197], v14 offset:16384
    ds_read_b64_tr_b16 v[198:199], v14 offset:20480
    v_mfma_f32_16x16x32_bf16 v[60:63], v[172:175], a[132:135], v[60:63]
    v_mfma_f32_16x16x32_bf16 v[92:95], v[172:175], a[136:139], v[92:95]
    buffer_load_dwordx4 a[240:243], v7, s[44:47], s8 offen offset:1024 sc1
    v_mfma_f32_16x16x32_bf16 v[124:127], v[172:175], a[140:143], v[124:127]
    v_mfma_f32_16x16x32_bf16 v[32:35], v[176:179], a[128:131], v[32:35]
    ds_read_b64_tr_b16 v[200:201], v14 offset:17408
    ds_read_b64_tr_b16 v[202:203], v14 offset:21504
    v_mfma_f32_16x16x32_bf16 v[64:67], v[176:179], a[132:135], v[64:67]
    v_mfma_f32_16x16x32_bf16 v[96:99], v[176:179], a[136:139], v[96:99]
    buffer_load_dwordx4 a[244:247], v7, s[44:47], s9 offen offset:1024 sc1
    v_mfma_f32_16x16x32_bf16 v[128:131], v[176:179], a[140:143], v[128:131]
    s_waitcnt vmcnt(25)
    v_mfma_f32_16x16x32_bf16 v[20:23], v[180:183], a[144:147], v[20:23]
    ds_read_b64_tr_b16 v[204:205], v15 offset:16384
    ds_read_b64_tr_b16 v[206:207], v15 offset:20480
    s_waitcnt vmcnt(24)
    v_mfma_f32_16x16x32_bf16 v[52:55], v[180:183], a[148:151], v[52:55]
    s_waitcnt vmcnt(23)
    v_mfma_f32_16x16x32_bf16 v[84:87], v[180:183], a[152:155], v[84:87]
    buffer_load_dwordx4 a[248:251], v7, s[44:47], s10 offen offset:1024 sc1
    s_waitcnt vmcnt(23)
    v_mfma_f32_16x16x32_bf16 v[116:119], v[180:183], a[156:159], v[116:119]
    v_mfma_f32_16x16x32_bf16 v[24:27], v[184:187], a[144:147], v[24:27]
    ds_read_b64_tr_b16 v[208:209], v15 offset:17408
    ds_read_b64_tr_b16 v[210:211], v15 offset:21504
    v_mfma_f32_16x16x32_bf16 v[56:59], v[184:187], a[148:151], v[56:59]
    v_mfma_f32_16x16x32_bf16 v[88:91], v[184:187], a[152:155], v[88:91]
    buffer_load_dwordx4 a[252:255], v7, s[44:47], s52 offen offset:1024 sc1
    v_mfma_f32_16x16x32_bf16 v[120:123], v[184:187], a[156:159], v[120:123]
    v_mfma_f32_16x16x32_bf16 v[28:31], v[188:191], a[144:147], v[28:31]
    ds_read_b64_tr_b16 v[212:213], v14 offset:24576
    ds_read_b64_tr_b16 v[214:215], v14 offset:28672
    v_mfma_f32_16x16x32_bf16 v[60:63], v[188:191], a[148:151], v[60:63]
    v_mfma_f32_16x16x32_bf16 v[92:95], v[188:191], a[152:155], v[92:95]
    s_mul_i32 s55, s94, 131072
    s_add_u32 m0, s58, 65536
    s_add_u32 s55, s55, 524288
    buffer_load_dwordx4 v244, s[36:39], s55 offen lds
    v_mfma_f32_16x16x32_bf16 v[124:127], v[188:191], a[156:159], v[124:127]
    s_waitcnt lgkmcnt(10)
    v_mfma_f32_16x16x32_bf16 v[32:35], v[192:195], a[144:147], v[32:35]
    ds_read_b64_tr_b16 v[216:217], v14 offset:25600
    ds_read_b64_tr_b16 v[218:219], v14 offset:29696
    v_mfma_f32_16x16x32_bf16 v[64:67], v[192:195], a[148:151], v[64:67]
    v_mfma_f32_16x16x32_bf16 v[96:99], v[192:195], a[152:155], v[96:99]
    s_addk_i32 m0, 0x400
    s_addk_i32 s55, 0x2000
    buffer_load_dwordx4 v244, s[36:39], s55 offen lds
    v_mfma_f32_16x16x32_bf16 v[128:131], v[192:195], a[156:159], v[128:131]
    s_waitcnt lgkmcnt(10)
    s_waitcnt vmcnt(25)
    v_mfma_f32_16x16x32_bf16 v[20:23], v[196:199], a[160:163], v[20:23]
    ds_read_b64_tr_b16 v[220:221], v15 offset:24576
    ds_read_b64_tr_b16 v[222:223], v15 offset:28672
    s_waitcnt vmcnt(24)
    v_mfma_f32_16x16x32_bf16 v[52:55], v[196:199], a[164:167], v[52:55]
    s_waitcnt vmcnt(23)
    v_mfma_f32_16x16x32_bf16 v[84:87], v[196:199], a[168:171], v[84:87]
    s_addk_i32 m0, 0x400
    s_addk_i32 s55, 0x2000
    buffer_load_dwordx4 v244, s[36:39], s55 offen lds
    s_waitcnt vmcnt(23)
    v_mfma_f32_16x16x32_bf16 v[116:119], v[196:199], a[172:175], v[116:119]
    s_waitcnt lgkmcnt(10)
    v_mfma_f32_16x16x32_bf16 v[24:27], v[200:203], a[160:163], v[24:27]
    ds_read_b64_tr_b16 v[224:225], v15 offset:25600
    ds_read_b64_tr_b16 v[226:227], v15 offset:29696
    v_mfma_f32_16x16x32_bf16 v[56:59], v[200:203], a[164:167], v[56:59]
    v_mfma_f32_16x16x32_bf16 v[88:91], v[200:203], a[168:171], v[88:91]
    s_addk_i32 m0, 0x400
    s_addk_i32 s55, 0x2000
    buffer_load_dwordx4 v244, s[36:39], s55 offen lds
    v_mfma_f32_16x16x32_bf16 v[120:123], v[200:203], a[172:175], v[120:123]
    s_waitcnt lgkmcnt(10)
    v_mfma_f32_16x16x32_bf16 v[28:31], v[204:207], a[160:163], v[28:31]
    v_add_u32 v14, 4294868992, v14
    ds_read_b64_tr_b16 v[148:149], v14 offset:0
    ds_read_b64_tr_b16 v[150:151], v14 offset:4096
    v_mfma_f32_16x16x32_bf16 v[60:63], v[204:207], a[164:167], v[60:63]
    ds_read_b64_tr_b16 v[152:153], v14 offset:1024
    ds_read_b64_tr_b16 v[154:155], v14 offset:5120
    v_mfma_f32_16x16x32_bf16 v[92:95], v[204:207], a[168:171], v[92:95]
    s_addk_i32 m0, 0x400
    s_add_u32 s55, s55, 40960
    buffer_load_dwordx4 v244, s[36:39], s55 offen lds
    v_mfma_f32_16x16x32_bf16 v[124:127], v[204:207], a[172:175], v[124:127]
    v_add_u32 v15, 4294868992, v15
    ds_read_b64_tr_b16 v[156:157], v15 offset:0
    ds_read_b64_tr_b16 v[158:159], v15 offset:4096
    s_waitcnt lgkmcnt(14)
    v_mfma_f32_16x16x32_bf16 v[32:35], v[208:211], a[160:163], v[32:35]
    ds_read_b64_tr_b16 v[160:161], v15 offset:1024
    ds_read_b64_tr_b16 v[162:163], v15 offset:5120
    v_mfma_f32_16x16x32_bf16 v[64:67], v[208:211], a[164:167], v[64:67]
    ds_read_b64_tr_b16 v[164:165], v14 offset:8192
    ds_read_b64_tr_b16 v[166:167], v14 offset:12288
    v_mfma_f32_16x16x32_bf16 v[96:99], v[208:211], a[168:171], v[96:99]
    s_addk_i32 m0, 0x400
    s_addk_i32 s55, 0x2000
    buffer_load_dwordx4 v244, s[36:39], s55 offen lds
    v_mfma_f32_16x16x32_bf16 v[128:131], v[208:211], a[172:175], v[128:131]
    ds_read_b64_tr_b16 v[168:169], v14 offset:9216
    ds_read_b64_tr_b16 v[170:171], v14 offset:13312
    s_waitcnt lgkmcnt(15)
    s_waitcnt vmcnt(25)
    v_mfma_f32_16x16x32_bf16 v[20:23], v[212:215], a[176:179], v[20:23]
    ds_read_b64_tr_b16 v[172:173], v15 offset:8192
    ds_read_b64_tr_b16 v[174:175], v15 offset:12288
    s_waitcnt vmcnt(24)
    v_mfma_f32_16x16x32_bf16 v[52:55], v[212:215], a[180:183], v[52:55]
    ds_read_b64_tr_b16 v[176:177], v15 offset:9216
    ds_read_b64_tr_b16 v[178:179], v15 offset:13312
    s_waitcnt vmcnt(23)
    v_mfma_f32_16x16x32_bf16 v[84:87], v[212:215], a[184:187], v[84:87]
    s_addk_i32 m0, 0x400
    s_addk_i32 s55, 0x2000
    buffer_load_dwordx4 v244, s[36:39], s55 offen lds
    s_waitcnt vmcnt(23)
    v_mfma_f32_16x16x32_bf16 v[116:119], v[212:215], a[188:191], v[116:119]
    ds_read_b64_tr_b16 v[180:181], v14 offset:16384
    ds_read_b64_tr_b16 v[182:183], v14 offset:20480
    v_mfma_f32_16x16x32_bf16 v[24:27], v[216:219], a[176:179], v[24:27]
    ds_read_b64_tr_b16 v[184:185], v14 offset:17408
    ds_read_b64_tr_b16 v[186:187], v14 offset:21504
    v_mfma_f32_16x16x32_bf16 v[56:59], v[216:219], a[180:183], v[56:59]
    ds_read_b64_tr_b16 v[188:189], v15 offset:16384
    ds_read_b64_tr_b16 v[190:191], v15 offset:20480
    v_mfma_f32_16x16x32_bf16 v[88:91], v[216:219], a[184:187], v[88:91]
    s_addk_i32 m0, 0x400
    s_addk_i32 s55, 0x2000
    buffer_load_dwordx4 v244, s[36:39], s55 offen lds
    v_mfma_f32_16x16x32_bf16 v[120:123], v[216:219], a[188:191], v[120:123]
    ds_read_b64_tr_b16 v[192:193], v15 offset:17408
    ds_read_b64_tr_b16 v[194:195], v15 offset:21504
    s_waitcnt lgkmcnt(15)
    v_mfma_f32_16x16x32_bf16 v[28:31], v[220:223], a[176:179], v[28:31]
    ds_read_b64_tr_b16 v[196:197], v14 offset:24576
    ds_read_b64_tr_b16 v[198:199], v14 offset:28672
    v_mfma_f32_16x16x32_bf16 v[60:63], v[220:223], a[180:183], v[60:63]
    ds_read_b64_tr_b16 v[200:201], v14 offset:25600
    ds_read_b64_tr_b16 v[202:203], v14 offset:29696
    v_mfma_f32_16x16x32_bf16 v[92:95], v[220:223], a[184:187], v[92:95]
    s_mul_i32 s55, s94, -753664
    s_add_u32 m0, s58, 98304
    s_add_u32 s55, s55, 786432
    buffer_load_dwordx4 v244, s[36:39], s55 offen lds
    v_mfma_f32_16x16x32_bf16 v[124:127], v[220:223], a[188:191], v[124:127]
    ds_read_b64_tr_b16 v[204:205], v15 offset:24576
    ds_read_b64_tr_b16 v[206:207], v15 offset:28672
    v_mfma_f32_16x16x32_bf16 v[32:35], v[224:227], a[176:179], v[32:35]
    ds_read_b64_tr_b16 v[208:209], v15 offset:25600
    ds_read_b64_tr_b16 v[210:211], v15 offset:29696
    v_mfma_f32_16x16x32_bf16 v[64:67], v[224:227], a[180:183], v[64:67]
    v_mfma_f32_16x16x32_bf16 v[96:99], v[224:227], a[184:187], v[96:99]
    s_addk_i32 m0, 0x400
    s_addk_i32 s55, 0x2000
    buffer_load_dwordx4 v244, s[36:39], s55 offen lds
    v_mfma_f32_16x16x32_bf16 v[128:131], v[224:227], a[188:191], v[128:131]
    s_waitcnt vmcnt(25)
    v_mfma_f32_16x16x32_bf16 v[20:23], v[148:151], a[192:195], v[20:23]
    v_mfma_f32_16x16x32_bf16 v[24:27], v[152:155], a[192:195], v[24:27]
    v_mfma_f32_16x16x32_bf16 v[28:31], v[156:159], a[192:195], v[28:31]
    s_addk_i32 m0, 0x400
    s_addk_i32 s55, 0x2000
    buffer_load_dwordx4 v244, s[36:39], s55 offen lds
    v_mfma_f32_16x16x32_bf16 v[32:35], v[160:163], a[192:195], v[32:35]
    s_waitcnt lgkmcnt(15)
    s_waitcnt vmcnt(22)
    v_mfma_f32_16x16x32_bf16 v[20:23], v[164:167], a[208:211], v[20:23]
    v_mfma_f32_16x16x32_bf16 v[24:27], v[168:171], a[208:211], v[24:27]
    v_mfma_f32_16x16x32_bf16 v[28:31], v[172:175], a[208:211], v[28:31]
    s_addk_i32 m0, 0x400
    s_addk_i32 s55, 0x2000
    buffer_load_dwordx4 v244, s[36:39], s55 offen lds
    v_mfma_f32_16x16x32_bf16 v[32:35], v[176:179], a[208:211], v[32:35]
    s_waitcnt lgkmcnt(14)
    s_waitcnt vmcnt(19)
    v_mfma_f32_16x16x32_bf16 v[20:23], v[180:183], a[224:227], v[20:23]
    s_waitcnt lgkmcnt(12)
    v_mfma_f32_16x16x32_bf16 v[24:27], v[184:187], a[224:227], v[24:27]
    s_waitcnt lgkmcnt(10)
    v_mfma_f32_16x16x32_bf16 v[28:31], v[188:191], a[224:227], v[28:31]
    s_addk_i32 m0, 0x400
    s_add_u32 s55, s55, 40960
    buffer_load_dwordx4 v244, s[36:39], s55 offen lds
    s_waitcnt lgkmcnt(8)
    v_mfma_f32_16x16x32_bf16 v[32:35], v[192:195], a[224:227], v[32:35]
    s_waitcnt lgkmcnt(6)
    s_waitcnt vmcnt(16)
    v_mfma_f32_16x16x32_bf16 v[20:23], v[196:199], a[240:243], v[20:23]
    s_waitcnt lgkmcnt(4)
    v_mfma_f32_16x16x32_bf16 v[24:27], v[200:203], a[240:243], v[24:27]
    s_waitcnt lgkmcnt(2)
    v_mfma_f32_16x16x32_bf16 v[28:31], v[204:207], a[240:243], v[28:31]
    s_addk_i32 m0, 0x400
    s_addk_i32 s55, 0x2000
    buffer_load_dwordx4 v244, s[36:39], s55 offen lds
    s_waitcnt lgkmcnt(0)
    v_mfma_f32_16x16x32_bf16 v[32:35], v[208:211], a[240:243], v[32:35]
    v_mfma_f32_16x16x32_bf16 v[52:55], v[148:151], a[196:199], v[52:55]
    v_mfma_f32_16x16x32_bf16 v[56:59], v[152:155], a[196:199], v[56:59]
    v_mfma_f32_16x16x32_bf16 v[60:63], v[156:159], a[196:199], v[60:63]
    s_addk_i32 m0, 0x400
    s_addk_i32 s55, 0x2000
    buffer_load_dwordx4 v244, s[36:39], s55 offen lds
    v_mfma_f32_16x16x32_bf16 v[64:67], v[160:163], a[196:199], v[64:67]
    v_max_f32 v20, 0, v20
    v_max_f32 v21, 0, v21
    v_mfma_f32_16x16x32_bf16 v[52:55], v[164:167], a[212:215], v[52:55]
    v_max_f32 v22, 0, v22
    v_max_f32 v23, 0, v23
    v_mfma_f32_16x16x32_bf16 v[56:59], v[168:171], a[212:215], v[56:59]
    v_mul_f32 v20, v20, v24
    v_mul_f32 v21, v21, v25
    v_mfma_f32_16x16x32_bf16 v[60:63], v[172:175], a[212:215], v[60:63]
    s_addk_i32 m0, 0x400
    s_addk_i32 s55, 0x2000
    buffer_load_dwordx4 v244, s[36:39], s55 offen lds
    v_mfma_f32_16x16x32_bf16 v[64:67], v[176:179], a[212:215], v[64:67]
    v_mul_f32 v22, v22, v26
    v_mul_f32 v23, v23, v27
    v_mfma_f32_16x16x32_bf16 v[52:55], v[180:183], a[228:231], v[52:55]
    v_max_f32 v28, 0, v28
    v_max_f32 v29, 0, v29
    v_mfma_f32_16x16x32_bf16 v[56:59], v[184:187], a[228:231], v[56:59]
    v_max_f32 v30, 0, v30
    v_max_f32 v31, 0, v31
    v_mfma_f32_16x16x32_bf16 v[60:63], v[188:191], a[228:231], v[60:63]
    s_mul_i32 s55, s94, 131072
    s_add_u32 m0, s58, 0
    s_add_u32 s55, s55, 163840
    buffer_load_dwordx4 v244, s[36:39], s55 offen lds
    v_mfma_f32_16x16x32_bf16 v[64:67], v[192:195], a[228:231], v[64:67]
    v_mul_f32 v28, v28, v32
    v_mul_f32 v29, v29, v33
    s_waitcnt vmcnt(19)
    v_mfma_f32_16x16x32_bf16 v[52:55], v[196:199], a[244:247], v[52:55]
    v_mul_f32 v30, v30, v34
    v_mul_f32 v31, v31, v35
    v_mfma_f32_16x16x32_bf16 v[56:59], v[200:203], a[244:247], v[56:59]
    v_cvt_pk_bf16_f32 v24, v20, v21
    v_cvt_pk_bf16_f32 v25, v22, v23
    v_mfma_f32_16x16x32_bf16 v[60:63], v[204:207], a[244:247], v[60:63]
    s_addk_i32 m0, 0x400
    s_addk_i32 s55, 0x2000
    buffer_load_dwordx4 v244, s[36:39], s55 offen lds
    v_mfma_f32_16x16x32_bf16 v[64:67], v[208:211], a[244:247], v[64:67]
    v_cvt_pk_bf16_f32 v26, v28, v29
    v_cvt_pk_bf16_f32 v27, v30, v31
    v_mfma_f32_16x16x32_bf16 v[84:87], v[148:151], a[200:203], v[84:87]
    s_add_u32 s101, s100, 0
    buffer_store_dwordx4 v[24:27], v1, s[44:47], s101 offen sc1
    v_mfma_f32_16x16x32_bf16 v[88:91], v[152:155], a[200:203], v[88:91]
    v_mfma_f32_16x16x32_bf16 v[92:95], v[156:159], a[200:203], v[92:95]
    v_max_f32 v52, 0, v52
    v_max_f32 v53, 0, v53
    v_mfma_f32_16x16x32_bf16 v[96:99], v[160:163], a[200:203], v[96:99]
    v_max_f32 v54, 0, v54
    v_max_f32 v55, 0, v55
    v_mfma_f32_16x16x32_bf16 v[84:87], v[164:167], a[216:219], v[84:87]
    s_addk_i32 m0, 0x400
    s_addk_i32 s55, 0x2000
    buffer_load_dwordx4 v244, s[36:39], s55 offen lds
    v_mfma_f32_16x16x32_bf16 v[88:91], v[168:171], a[216:219], v[88:91]
    v_mul_f32 v52, v52, v56
    v_mul_f32 v53, v53, v57
    v_mfma_f32_16x16x32_bf16 v[92:95], v[172:175], a[216:219], v[92:95]
    v_mul_f32 v54, v54, v58
    v_mul_f32 v55, v55, v59
    v_mfma_f32_16x16x32_bf16 v[96:99], v[176:179], a[216:219], v[96:99]
    v_max_f32 v60, 0, v60
    v_max_f32 v61, 0, v61
    v_mfma_f32_16x16x32_bf16 v[84:87], v[180:183], a[232:235], v[84:87]
    s_addk_i32 m0, 0x400
    s_addk_i32 s55, 0x2000
    buffer_load_dwordx4 v244, s[36:39], s55 offen lds
    v_mfma_f32_16x16x32_bf16 v[88:91], v[184:187], a[232:235], v[88:91]
    v_add_u32 v16, 65536, v16
    ds_read_b64_tr_b16 v[212:213], v16 offset:0
    ds_read_b64_tr_b16 v[214:215], v16 offset:4096
    v_mfma_f32_16x16x32_bf16 v[92:95], v[188:191], a[232:235], v[92:95]
    v_max_f32 v62, 0, v62
    v_max_f32 v63, 0, v63
    v_mfma_f32_16x16x32_bf16 v[96:99], v[192:195], a[232:235], v[96:99]
    v_mul_f32 v60, v60, v64
    v_mul_f32 v61, v61, v65
    s_waitcnt vmcnt(22)
    v_mfma_f32_16x16x32_bf16 v[84:87], v[196:199], a[248:251], v[84:87]
    s_addk_i32 m0, 0x400
    s_add_u32 s55, s55, 40960
    buffer_load_dwordx4 v244, s[36:39], s55 offen lds
    v_mfma_f32_16x16x32_bf16 v[88:91], v[200:203], a[248:251], v[88:91]
    ds_read_b64_tr_b16 v[216:217], v16 offset:1024
    ds_read_b64_tr_b16 v[218:219], v16 offset:5120
    v_mfma_f32_16x16x32_bf16 v[92:95], v[204:207], a[248:251], v[92:95]
    v_mul_f32 v62, v62, v66
    v_mul_f32 v63, v63, v67
    v_mfma_f32_16x16x32_bf16 v[96:99], v[208:211], a[248:251], v[96:99]
    v_cvt_pk_bf16_f32 v56, v52, v53
    v_cvt_pk_bf16_f32 v57, v54, v55
    v_mfma_f32_16x16x32_bf16 v[116:119], v[148:151], a[204:207], v[116:119]
    s_addk_i32 m0, 0x400
    s_addk_i32 s55, 0x2000
    buffer_load_dwordx4 v244, s[36:39], s55 offen lds
    v_mfma_f32_16x16x32_bf16 v[120:123], v[152:155], a[204:207], v[120:123]
    v_add_u32 v17, 65536, v17
    ds_read_b64_tr_b16 v[220:221], v17 offset:0
    ds_read_b64_tr_b16 v[222:223], v17 offset:4096
    v_mfma_f32_16x16x32_bf16 v[124:127], v[156:159], a[204:207], v[124:127]
    v_cvt_pk_bf16_f32 v58, v60, v61
    v_cvt_pk_bf16_f32 v59, v62, v63
    v_mfma_f32_16x16x32_bf16 v[128:131], v[160:163], a[204:207], v[128:131]
    s_add_u32 s101, s100, 57344
    buffer_store_dwordx4 v[56:59], v1, s[44:47], s101 offen sc1
    v_mfma_f32_16x16x32_bf16 v[116:119], v[164:167], a[220:223], v[116:119]
    ds_read_b64_tr_b16 v[224:225], v17 offset:1024
    ds_read_b64_tr_b16 v[226:227], v17 offset:5120
    v_mfma_f32_16x16x32_bf16 v[120:123], v[168:171], a[220:223], v[120:123]
    v_max_f32 v84, 0, v84
    v_max_f32 v85, 0, v85
    v_mfma_f32_16x16x32_bf16 v[124:127], v[172:175], a[220:223], v[124:127]
    v_max_f32 v86, 0, v86
    v_max_f32 v87, 0, v87
    v_mfma_f32_16x16x32_bf16 v[128:131], v[176:179], a[220:223], v[128:131]
    s_addk_i32 m0, 0x400
    s_addk_i32 s55, 0x2000
    buffer_load_dwordx4 v244, s[36:39], s55 offen lds
    v_mfma_f32_16x16x32_bf16 v[116:119], v[180:183], a[236:239], v[116:119]
    ds_read_b64_tr_b16 v[148:149], v16 offset:8192
    ds_read_b64_tr_b16 v[150:151], v16 offset:12288
    v_mfma_f32_16x16x32_bf16 v[120:123], v[184:187], a[236:239], v[120:123]
    v_mul_f32 v84, v84, v88
    v_mul_f32 v85, v85, v89
    v_mfma_f32_16x16x32_bf16 v[124:127], v[188:191], a[236:239], v[124:127]
    v_mul_f32 v86, v86, v90
    v_mul_f32 v87, v87, v91
    v_mfma_f32_16x16x32_bf16 v[128:131], v[192:195], a[236:239], v[128:131]
    s_addk_i32 m0, 0x400
    s_addk_i32 s55, 0x2000
    buffer_load_dwordx4 v244, s[36:39], s55 offen lds
    s_waitcnt vmcnt(26)
    v_mfma_f32_16x16x32_bf16 v[116:119], v[196:199], a[252:255], v[116:119]
    ds_read_b64_tr_b16 v[152:153], v16 offset:9216
    ds_read_b64_tr_b16 v[154:155], v16 offset:13312
    v_mfma_f32_16x16x32_bf16 v[120:123], v[200:203], a[252:255], v[120:123]
    v_max_f32 v92, 0, v92
    v_max_f32 v93, 0, v93
    v_mfma_f32_16x16x32_bf16 v[124:127], v[204:207], a[252:255], v[124:127]
    v_max_f32 v94, 0, v94
    v_max_f32 v95, 0, v95
    v_mfma_f32_16x16x32_bf16 v[128:131], v[208:211], a[252:255], v[128:131]
    v_mul_f32 v92, v92, v96
    v_mul_f32 v93, v93, v97
    s_waitcnt lgkmcnt(10)
    v_mfma_f32_16x16x32_bf16 v[36:39], v[212:215], a[128:131], v[36:39]
    ds_read_b64_tr_b16 v[156:157], v17 offset:8192
    ds_read_b64_tr_b16 v[158:159], v17 offset:12288
    v_mfma_f32_16x16x32_bf16 v[68:71], v[212:215], a[132:135], v[68:71]
    v_mul_f32 v94, v94, v98
    v_mul_f32 v95, v95, v99
    v_mfma_f32_16x16x32_bf16 v[100:103], v[212:215], a[136:139], v[100:103]
    v_cvt_pk_bf16_f32 v88, v84, v85
    v_cvt_pk_bf16_f32 v89, v86, v87
    v_mfma_f32_16x16x32_bf16 v[132:135], v[212:215], a[140:143], v[132:135]
    v_cvt_pk_bf16_f32 v90, v92, v93
    v_cvt_pk_bf16_f32 v91, v94, v95
    s_waitcnt lgkmcnt(10)
    v_mfma_f32_16x16x32_bf16 v[40:43], v[216:219], a[128:131], v[40:43]
    ds_read_b64_tr_b16 v[160:161], v17 offset:9216
    ds_read_b64_tr_b16 v[162:163], v17 offset:13312
    v_mfma_f32_16x16x32_bf16 v[72:75], v[216:219], a[132:135], v[72:75]
    s_add_u32 s101, s100, 114688
    buffer_store_dwordx4 v[88:91], v1, s[44:47], s101 offen sc1
    v_mfma_f32_16x16x32_bf16 v[104:107], v[216:219], a[136:139], v[104:107]
    v_max_f32 v116, 0, v116
    v_max_f32 v117, 0, v117
    v_mfma_f32_16x16x32_bf16 v[136:139], v[216:219], a[140:143], v[136:139]
    v_max_f32 v118, 0, v118
    v_max_f32 v119, 0, v119
    s_waitcnt lgkmcnt(10)
    v_mfma_f32_16x16x32_bf16 v[44:47], v[220:223], a[128:131], v[44:47]
    ds_read_b64_tr_b16 v[164:165], v16 offset:16384
    ds_read_b64_tr_b16 v[166:167], v16 offset:20480
    v_mfma_f32_16x16x32_bf16 v[76:79], v[220:223], a[132:135], v[76:79]
    v_mul_f32 v116, v116, v120
    v_mul_f32 v117, v117, v121
    v_mfma_f32_16x16x32_bf16 v[108:111], v[220:223], a[136:139], v[108:111]
    v_mul_f32 v118, v118, v122
    v_mul_f32 v119, v119, v123
    v_mfma_f32_16x16x32_bf16 v[140:143], v[220:223], a[140:143], v[140:143]
    v_max_f32 v124, 0, v124
    v_max_f32 v125, 0, v125
    s_waitcnt lgkmcnt(10)
    v_mfma_f32_16x16x32_bf16 v[48:51], v[224:227], a[128:131], v[48:51]
    ds_read_b64_tr_b16 v[168:169], v16 offset:17408
    ds_read_b64_tr_b16 v[170:171], v16 offset:21504
    v_mfma_f32_16x16x32_bf16 v[80:83], v[224:227], a[132:135], v[80:83]
    v_max_f32 v126, 0, v126
    v_max_f32 v127, 0, v127
    v_mfma_f32_16x16x32_bf16 v[112:115], v[224:227], a[136:139], v[112:115]
    v_mul_f32 v124, v124, v128
    v_mul_f32 v125, v125, v129
    v_mfma_f32_16x16x32_bf16 v[144:147], v[224:227], a[140:143], v[144:147]
    v_mul_f32 v126, v126, v130
    v_mul_f32 v127, v127, v131
    s_waitcnt lgkmcnt(10)
    v_mfma_f32_16x16x32_bf16 v[36:39], v[148:151], a[144:147], v[36:39]
    ds_read_b64_tr_b16 v[172:173], v17 offset:16384
    ds_read_b64_tr_b16 v[174:175], v17 offset:20480
    v_mfma_f32_16x16x32_bf16 v[68:71], v[148:151], a[148:151], v[68:71]
    v_cvt_pk_bf16_f32 v120, v116, v117
    v_cvt_pk_bf16_f32 v121, v118, v119
    v_mfma_f32_16x16x32_bf16 v[100:103], v[148:151], a[152:155], v[100:103]
    v_cvt_pk_bf16_f32 v122, v124, v125
    v_cvt_pk_bf16_f32 v123, v126, v127
    v_mfma_f32_16x16x32_bf16 v[132:135], v[148:151], a[156:159], v[132:135]
    s_add_u32 s101, s100, 172032
    buffer_store_dwordx4 v[120:123], v1, s[44:47], s101 offen sc1
    s_waitcnt lgkmcnt(10)
    v_mfma_f32_16x16x32_bf16 v[40:43], v[152:155], a[144:147], v[40:43]
    ds_read_b64_tr_b16 v[176:177], v17 offset:17408
    ds_read_b64_tr_b16 v[178:179], v17 offset:21504
    v_mfma_f32_16x16x32_bf16 v[72:75], v[152:155], a[148:151], v[72:75]
    v_mfma_f32_16x16x32_bf16 v[104:107], v[152:155], a[152:155], v[104:107]
    v_mfma_f32_16x16x32_bf16 v[136:139], v[152:155], a[156:159], v[136:139]
    s_waitcnt lgkmcnt(10)
    v_mfma_f32_16x16x32_bf16 v[44:47], v[156:159], a[144:147], v[44:47]
    ds_read_b64_tr_b16 v[180:181], v16 offset:24576
    ds_read_b64_tr_b16 v[182:183], v16 offset:28672
    v_mfma_f32_16x16x32_bf16 v[76:79], v[156:159], a[148:151], v[76:79]
    v_mfma_f32_16x16x32_bf16 v[108:111], v[156:159], a[152:155], v[108:111]
    v_mfma_f32_16x16x32_bf16 v[140:143], v[156:159], a[156:159], v[140:143]
    s_waitcnt lgkmcnt(10)
    v_mfma_f32_16x16x32_bf16 v[48:51], v[160:163], a[144:147], v[48:51]
    ds_read_b64_tr_b16 v[184:185], v16 offset:25600
    ds_read_b64_tr_b16 v[186:187], v16 offset:29696
    v_mfma_f32_16x16x32_bf16 v[80:83], v[160:163], a[148:151], v[80:83]
    v_mfma_f32_16x16x32_bf16 v[112:115], v[160:163], a[152:155], v[112:115]
    v_mfma_f32_16x16x32_bf16 v[144:147], v[160:163], a[156:159], v[144:147]
    s_waitcnt lgkmcnt(10)
    v_mfma_f32_16x16x32_bf16 v[36:39], v[164:167], a[160:163], v[36:39]
    ds_read_b64_tr_b16 v[188:189], v17 offset:24576
    ds_read_b64_tr_b16 v[190:191], v17 offset:28672
    v_mfma_f32_16x16x32_bf16 v[68:71], v[164:167], a[164:167], v[68:71]
    v_mfma_f32_16x16x32_bf16 v[100:103], v[164:167], a[168:171], v[100:103]
    v_mfma_f32_16x16x32_bf16 v[132:135], v[164:167], a[172:175], v[132:135]
    s_waitcnt lgkmcnt(10)
    v_mfma_f32_16x16x32_bf16 v[40:43], v[168:171], a[160:163], v[40:43]
    ds_read_b64_tr_b16 v[192:193], v17 offset:25600
    ds_read_b64_tr_b16 v[194:195], v17 offset:29696
    v_mfma_f32_16x16x32_bf16 v[72:75], v[168:171], a[164:167], v[72:75]
    v_mfma_f32_16x16x32_bf16 v[104:107], v[168:171], a[168:171], v[104:107]
    v_mfma_f32_16x16x32_bf16 v[136:139], v[168:171], a[172:175], v[136:139]
    s_waitcnt lgkmcnt(10)
    v_mfma_f32_16x16x32_bf16 v[44:47], v[172:175], a[160:163], v[44:47]
    v_add_u32 v16, 4294868992, v16
    ds_read_b64_tr_b16 v[196:197], v16 offset:0
    ds_read_b64_tr_b16 v[198:199], v16 offset:4096
    v_mfma_f32_16x16x32_bf16 v[76:79], v[172:175], a[164:167], v[76:79]
    ds_read_b64_tr_b16 v[200:201], v16 offset:1024
    ds_read_b64_tr_b16 v[202:203], v16 offset:5120
    v_mfma_f32_16x16x32_bf16 v[108:111], v[172:175], a[168:171], v[108:111]
    v_add_u32 v17, 4294868992, v17
    ds_read_b64_tr_b16 v[204:205], v17 offset:0
    ds_read_b64_tr_b16 v[206:207], v17 offset:4096
    v_mfma_f32_16x16x32_bf16 v[140:143], v[172:175], a[172:175], v[140:143]
    ds_read_b64_tr_b16 v[208:209], v17 offset:1024
    ds_read_b64_tr_b16 v[210:211], v17 offset:5120
    s_waitcnt lgkmcnt(15)
    v_mfma_f32_16x16x32_bf16 v[48:51], v[176:179], a[160:163], v[48:51]
    ds_read_b64_tr_b16 v[212:213], v16 offset:8192
    ds_read_b64_tr_b16 v[214:215], v16 offset:12288
    v_mfma_f32_16x16x32_bf16 v[80:83], v[176:179], a[164:167], v[80:83]
    ds_read_b64_tr_b16 v[216:217], v16 offset:9216
    ds_read_b64_tr_b16 v[218:219], v16 offset:13312
    v_mfma_f32_16x16x32_bf16 v[112:115], v[176:179], a[168:171], v[112:115]
    ds_read_b64_tr_b16 v[220:221], v17 offset:8192
    ds_read_b64_tr_b16 v[222:223], v17 offset:12288
    v_mfma_f32_16x16x32_bf16 v[144:147], v[176:179], a[172:175], v[144:147]
    ds_read_b64_tr_b16 v[224:225], v17 offset:9216
    ds_read_b64_tr_b16 v[226:227], v17 offset:13312
    s_waitcnt lgkmcnt(15)
    v_mfma_f32_16x16x32_bf16 v[36:39], v[180:183], a[176:179], v[36:39]
    s_barrier
    s_mul_i32 s55, s94, 131072
    s_add_u32 m0, s58, 131072
    s_add_u32 s55, s55, 425984
    buffer_load_dwordx4 v244, s[36:39], s55 offen lds
    v_mfma_f32_16x16x32_bf16 v[68:71], v[180:183], a[180:183], v[68:71]
    ds_read_b64_tr_b16 v[148:149], v16 offset:16384
    ds_read_b64_tr_b16 v[150:151], v16 offset:20480
    v_mfma_f32_16x16x32_bf16 v[100:103], v[180:183], a[184:187], v[100:103]
    ds_read_b64_tr_b16 v[152:153], v16 offset:17408
    ds_read_b64_tr_b16 v[154:155], v16 offset:21504
    v_mfma_f32_16x16x32_bf16 v[132:135], v[180:183], a[188:191], v[132:135]
    ds_read_b64_tr_b16 v[156:157], v17 offset:16384
    ds_read_b64_tr_b16 v[158:159], v17 offset:20480
    v_mfma_f32_16x16x32_bf16 v[40:43], v[184:187], a[176:179], v[40:43]
    s_cmp_lg_u32 s93, 0
    s_cbranch_scc1 L_af0
    s_waitcnt vmcnt(1)
    s_mov_b64 exec, 1
    buffer_store_dwordx2 v[246:247], off, s[44:47], s19 offset:3072
L_ag0:
    s_mov_b64 exec, -1
    v_mfma_f32_16x16x32_bf16 v[72:75], v[184:187], a[180:183], v[72:75]
    ds_read_b64_tr_b16 v[160:161], v17 offset:17408
    ds_read_b64_tr_b16 v[162:163], v17 offset:21504
    v_mfma_f32_16x16x32_bf16 v[104:107], v[184:187], a[184:187], v[104:107]
    ds_read_b64_tr_b16 v[164:165], v16 offset:24576
    ds_read_b64_tr_b16 v[166:167], v16 offset:28672
    v_mfma_f32_16x16x32_bf16 v[136:139], v[184:187], a[188:191], v[136:139]
    ds_read_b64_tr_b16 v[168:169], v16 offset:25600
    ds_read_b64_tr_b16 v[170:171], v16 offset:29696
    v_mfma_f32_16x16x32_bf16 v[44:47], v[188:191], a[176:179], v[44:47]
    s_addk_i32 m0, 0x400
    s_addk_i32 s55, 0x2000
    buffer_load_dwordx4 v244, s[36:39], s55 offen lds
    v_mfma_f32_16x16x32_bf16 v[76:79], v[188:191], a[180:183], v[76:79]
    ds_read_b64_tr_b16 v[172:173], v17 offset:24576
    ds_read_b64_tr_b16 v[174:175], v17 offset:28672
    v_mfma_f32_16x16x32_bf16 v[108:111], v[188:191], a[184:187], v[108:111]
    ds_read_b64_tr_b16 v[176:177], v17 offset:25600
    ds_read_b64_tr_b16 v[178:179], v17 offset:29696
    v_mfma_f32_16x16x32_bf16 v[140:143], v[188:191], a[188:191], v[140:143]
    v_mfma_f32_16x16x32_bf16 v[48:51], v[192:195], a[176:179], v[48:51]
    s_addk_i32 m0, 0x400
    s_addk_i32 s55, 0x2000
    buffer_load_dwordx4 v244, s[36:39], s55 offen lds
    v_mfma_f32_16x16x32_bf16 v[80:83], v[192:195], a[180:183], v[80:83]
    v_mfma_f32_16x16x32_bf16 v[112:115], v[192:195], a[184:187], v[112:115]
    v_mfma_f32_16x16x32_bf16 v[144:147], v[192:195], a[188:191], v[144:147]
    s_waitcnt lgkmcnt(15)
    v_mfma_f32_16x16x32_bf16 v[36:39], v[196:199], a[192:195], v[36:39]
    s_addk_i32 m0, 0x400
    s_addk_i32 s55, 0x2000
    buffer_load_dwordx4 v244, s[36:39], s55 offen lds
    v_mfma_f32_16x16x32_bf16 v[40:43], v[200:203], a[192:195], v[40:43]
    v_mfma_f32_16x16x32_bf16 v[44:47], v[204:207], a[192:195], v[44:47]
    v_mfma_f32_16x16x32_bf16 v[48:51], v[208:211], a[192:195], v[48:51]
    v_mfma_f32_16x16x32_bf16 v[36:39], v[212:215], a[208:211], v[36:39]
    s_addk_i32 m0, 0x400
    s_add_u32 s55, s55, 40960
    buffer_load_dwordx4 v244, s[36:39], s55 offen lds
    v_mfma_f32_16x16x32_bf16 v[40:43], v[216:219], a[208:211], v[40:43]
    v_mfma_f32_16x16x32_bf16 v[44:47], v[220:223], a[208:211], v[44:47]
    v_mfma_f32_16x16x32_bf16 v[48:51], v[224:227], a[208:211], v[48:51]
    s_waitcnt lgkmcnt(14)
    v_mfma_f32_16x16x32_bf16 v[36:39], v[148:151], a[224:227], v[36:39]
    s_addk_i32 m0, 0x400
    s_addk_i32 s55, 0x2000
    buffer_load_dwordx4 v244, s[36:39], s55 offen lds
    s_waitcnt lgkmcnt(12)
    v_mfma_f32_16x16x32_bf16 v[40:43], v[152:155], a[224:227], v[40:43]
    s_waitcnt lgkmcnt(10)
    v_mfma_f32_16x16x32_bf16 v[44:47], v[156:159], a[224:227], v[44:47]
    s_waitcnt lgkmcnt(8)
    v_mfma_f32_16x16x32_bf16 v[48:51], v[160:163], a[224:227], v[48:51]
    s_waitcnt lgkmcnt(6)
    v_mfma_f32_16x16x32_bf16 v[36:39], v[164:167], a[240:243], v[36:39]
    s_addk_i32 m0, 0x400
    s_addk_i32 s55, 0x2000
    buffer_load_dwordx4 v244, s[36:39], s55 offen lds
    s_waitcnt lgkmcnt(4)
    v_mfma_f32_16x16x32_bf16 v[40:43], v[168:171], a[240:243], v[40:43]
    s_waitcnt lgkmcnt(2)
    v_mfma_f32_16x16x32_bf16 v[44:47], v[172:175], a[240:243], v[44:47]
    s_waitcnt lgkmcnt(0)
    v_mfma_f32_16x16x32_bf16 v[48:51], v[176:179], a[240:243], v[48:51]
    s_barrier
    v_mfma_f32_16x16x32_bf16 v[68:71], v[196:199], a[196:199], v[68:71]
    s_addk_i32 m0, 0x400
    s_addk_i32 s55, 0x2000
    buffer_load_dwordx4 v244, s[36:39], s55 offen lds
    v_mfma_f32_16x16x32_bf16 v[72:75], v[200:203], a[196:199], v[72:75]
    v_mfma_f32_16x16x32_bf16 v[76:79], v[204:207], a[196:199], v[76:79]
    v_max_f32 v36, 0, v36
    v_max_f32 v37, 0, v37
    v_mfma_f32_16x16x32_bf16 v[80:83], v[208:211], a[196:199], v[80:83]
    v_max_f32 v38, 0, v38
    v_max_f32 v39, 0, v39
    v_mfma_f32_16x16x32_bf16 v[68:71], v[212:215], a[212:215], v[68:71]
    s_mul_i32 s55, s94, 131072
    s_add_u32 m0, s58, 32768
    s_add_u32 s55, s55, 688128
    buffer_load_dwordx4 v244, s[36:39], s55 offen lds
    v_mfma_f32_16x16x32_bf16 v[72:75], v[216:219], a[212:215], v[72:75]
    v_mul_f32 v36, v36, v40
    v_mul_f32 v37, v37, v41
    v_mfma_f32_16x16x32_bf16 v[76:79], v[220:223], a[212:215], v[76:79]
    v_mul_f32 v38, v38, v42
    v_mul_f32 v39, v39, v43
    v_mfma_f32_16x16x32_bf16 v[80:83], v[224:227], a[212:215], v[80:83]
    v_max_f32 v44, 0, v44
    v_max_f32 v45, 0, v45
    v_mfma_f32_16x16x32_bf16 v[68:71], v[148:151], a[228:231], v[68:71]
    s_addk_i32 m0, 0x400
    s_addk_i32 s55, 0x2000
    buffer_load_dwordx4 v244, s[36:39], s55 offen lds
    v_mfma_f32_16x16x32_bf16 v[72:75], v[152:155], a[228:231], v[72:75]
    v_max_f32 v46, 0, v46
    v_max_f32 v47, 0, v47
    v_mfma_f32_16x16x32_bf16 v[76:79], v[156:159], a[228:231], v[76:79]
    v_mul_f32 v44, v44, v48
    v_mul_f32 v45, v45, v49
    v_mfma_f32_16x16x32_bf16 v[80:83], v[160:163], a[228:231], v[80:83]
    v_mul_f32 v46, v46, v50
    v_mul_f32 v47, v47, v51
    v_mfma_f32_16x16x32_bf16 v[68:71], v[164:167], a[244:247], v[68:71]
    s_mov_b64 exec, 0x3fff
    buffer_load_dwordx2 v[8:9], v2, s[44:47], s20 offen offset:3072 sc1
    s_mov_b64 exec, -1
    v_mfma_f32_16x16x32_bf16 v[72:75], v[168:171], a[244:247], v[72:75]
    v_cvt_pk_bf16_f32 v40, v36, v37
    v_cvt_pk_bf16_f32 v41, v38, v39
    v_mfma_f32_16x16x32_bf16 v[76:79], v[172:175], a[244:247], v[76:79]
    v_cvt_pk_bf16_f32 v42, v44, v45
    v_cvt_pk_bf16_f32 v43, v46, v47
    v_mfma_f32_16x16x32_bf16 v[80:83], v[176:179], a[244:247], v[80:83]
    s_add_u32 s101, s100, 14336
    buffer_store_dwordx4 v[40:43], v1, s[44:47], s101 offen sc1
    v_mfma_f32_16x16x32_bf16 v[100:103], v[196:199], a[200:203], v[100:103]
    v_mfma_f32_16x16x32_bf16 v[104:107], v[200:203], a[200:203], v[104:107]
    v_mfma_f32_16x16x32_bf16 v[108:111], v[204:207], a[200:203], v[108:111]
    v_max_f32 v68, 0, v68
    v_max_f32 v69, 0, v69
    v_mfma_f32_16x16x32_bf16 v[112:115], v[208:211], a[200:203], v[112:115]
    s_addk_i32 m0, 0x400
    s_addk_i32 s55, 0x2000
    buffer_load_dwordx4 v244, s[36:39], s55 offen lds
    v_mfma_f32_16x16x32_bf16 v[100:103], v[212:215], a[216:219], v[100:103]
    v_max_f32 v70, 0, v70
    v_max_f32 v71, 0, v71
    v_mfma_f32_16x16x32_bf16 v[104:107], v[216:219], a[216:219], v[104:107]
    v_mul_f32 v68, v68, v72
    v_mul_f32 v69, v69, v73
    v_mfma_f32_16x16x32_bf16 v[108:111], v[220:223], a[216:219], v[108:111]
    v_mul_f32 v70, v70, v74
    v_mul_f32 v71, v71, v75
    v_mfma_f32_16x16x32_bf16 v[112:115], v[224:227], a[216:219], v[112:115]
    s_addk_i32 m0, 0x400
    s_addk_i32 s55, 0x2000
    buffer_load_dwordx4 v244, s[36:39], s55 offen lds
    v_mfma_f32_16x16x32_bf16 v[100:103], v[148:151], a[232:235], v[100:103]
    v_max_f32 v76, 0, v76
    v_max_f32 v77, 0, v77
    v_mfma_f32_16x16x32_bf16 v[104:107], v[152:155], a[232:235], v[104:107]
    v_max_f32 v78, 0, v78
    v_max_f32 v79, 0, v79
    v_mfma_f32_16x16x32_bf16 v[108:111], v[156:159], a[232:235], v[108:111]
    v_mul_f32 v76, v76, v80
    v_mul_f32 v77, v77, v81
    v_mfma_f32_16x16x32_bf16 v[112:115], v[160:163], a[232:235], v[112:115]
    s_addk_i32 m0, 0x400
    s_add_u32 s55, s55, 40960
    buffer_load_dwordx4 v244, s[36:39], s55 offen lds
    v_mfma_f32_16x16x32_bf16 v[100:103], v[164:167], a[248:251], v[100:103]
    v_mul_f32 v78, v78, v82
    v_mul_f32 v79, v79, v83
    v_mfma_f32_16x16x32_bf16 v[104:107], v[168:171], a[248:251], v[104:107]
    v_cvt_pk_bf16_f32 v72, v68, v69
    v_cvt_pk_bf16_f32 v73, v70, v71
    v_mfma_f32_16x16x32_bf16 v[108:111], v[172:175], a[248:251], v[108:111]
    v_cvt_pk_bf16_f32 v74, v76, v77
    v_cvt_pk_bf16_f32 v75, v78, v79
    v_mfma_f32_16x16x32_bf16 v[112:115], v[176:179], a[248:251], v[112:115]
    s_addk_i32 m0, 0x400
    s_addk_i32 s55, 0x2000
    buffer_load_dwordx4 v244, s[36:39], s55 offen lds
    v_mfma_f32_16x16x32_bf16 v[132:135], v[196:199], a[204:207], v[132:135]
    s_add_u32 s101, s100, 71680
    buffer_store_dwordx4 v[72:75], v1, s[44:47], s101 offen sc1
    v_mfma_f32_16x16x32_bf16 v[136:139], v[200:203], a[204:207], v[136:139]
    v_mfma_f32_16x16x32_bf16 v[140:143], v[204:207], a[204:207], v[140:143]
    v_max_f32 v100, 0, v100
    v_max_f32 v101, 0, v101
    v_mfma_f32_16x16x32_bf16 v[144:147], v[208:211], a[204:207], v[144:147]
    v_max_f32 v102, 0, v102
    v_max_f32 v103, 0, v103
    v_mfma_f32_16x16x32_bf16 v[132:135], v[212:215], a[220:223], v[132:135]
    s_addk_i32 m0, 0x400
    s_addk_i32 s55, 0x2000
    buffer_load_dwordx4 v244, s[36:39], s55 offen lds
    v_mfma_f32_16x16x32_bf16 v[136:139], v[216:219], a[220:223], v[136:139]
    v_mul_f32 v100, v100, v104
    v_mul_f32 v101, v101, v105
    v_mfma_f32_16x16x32_bf16 v[140:143], v[220:223], a[220:223], v[140:143]
    v_mul_f32 v102, v102, v106
    v_mul_f32 v103, v103, v107
    v_mfma_f32_16x16x32_bf16 v[144:147], v[224:227], a[220:223], v[144:147]
    v_max_f32 v108, 0, v108
    v_max_f32 v109, 0, v109
    v_mfma_f32_16x16x32_bf16 v[132:135], v[148:151], a[236:239], v[132:135]
    s_waitcnt vmcnt(7)
    v_cmp_ne_u64 vcc, s[48:49], v[8:9]
    s_nop 0
    s_and_b32 vcc_lo, vcc_lo, 0x3fff
    s_cbranch_scc1 L_ca_s
L_ca:
    v_mfma_f32_16x16x32_bf16 v[136:139], v[152:155], a[236:239], v[136:139]
    buffer_load_dwordx4 a[128:131], v1, s[44:47], s15 offen offset:0 sc1
    v_max_f32 v110, 0, v110
    v_mfma_f32_16x16x32_bf16 v[140:143], v[156:159], a[236:239], v[140:143]
    v_max_f32 v111, 0, v111
    v_mul_f32 v108, v108, v112
    v_mfma_f32_16x16x32_bf16 v[144:147], v[160:163], a[236:239], v[144:147]
    buffer_load_dwordx4 a[132:135], v1, s[44:47], s14 offen offset:0 sc1
    v_mul_f32 v109, v109, v113
    v_mfma_f32_16x16x32_bf16 v[132:135], v[164:167], a[252:255], v[132:135]
    v_mul_f32 v110, v110, v114
    v_mul_f32 v111, v111, v115
    v_mfma_f32_16x16x32_bf16 v[136:139], v[168:171], a[252:255], v[136:139]
    buffer_load_dwordx4 a[136:139], v1, s[44:47], s15 offen offset:1024 sc1
    v_cvt_pk_bf16_f32 v104, v100, v101
    v_mfma_f32_16x16x32_bf16 v[140:143], v[172:175], a[252:255], v[140:143]
    v_cvt_pk_bf16_f32 v105, v102, v103
    v_cvt_pk_bf16_f32 v106, v108, v109
    v_mfma_f32_16x16x32_bf16 v[144:147], v[176:179], a[252:255], v[144:147]
    buffer_load_dwordx4 a[140:143], v1, s[44:47], s14 offen offset:1024 sc1
    v_cvt_pk_bf16_f32 v107, v110, v111
    s_add_u32 s101, s100, 129024
    buffer_store_dwordx4 v[104:107], v1, s[44:47], s101 offen sc1
    v_max_f32 v132, 0, v132
    v_max_f32 v133, 0, v133
    v_max_f32 v134, 0, v134
    v_max_f32 v135, 0, v135
    v_mul_f32 v132, v132, v136
    v_mul_f32 v133, v133, v137
    v_mul_f32 v134, v134, v138
    v_mul_f32 v135, v135, v139
    v_max_f32 v140, 0, v140
    v_max_f32 v141, 0, v141
    v_max_f32 v142, 0, v142
    v_max_f32 v143, 0, v143
    v_mul_f32 v140, v140, v144
    v_mul_f32 v141, v141, v145
    v_mul_f32 v142, v142, v146
    v_mul_f32 v143, v143, v147
    v_cvt_pk_bf16_f32 v136, v132, v133
    v_cvt_pk_bf16_f32 v137, v134, v135
    v_cvt_pk_bf16_f32 v138, v140, v141
    v_cvt_pk_bf16_f32 v139, v142, v143
    s_add_u32 s101, s100, 186368
    buffer_store_dwordx4 v[136:139], v1, s[44:47], s101 offen sc1
    buffer_load_dwordx4 a[144:147], v1, s[44:47], s15 offen offset:2048 sc1
    buffer_load_dwordx4 a[148:151], v1, s[44:47], s14 offen offset:2048 sc1
    buffer_load_dwordx4 a[152:155], v1, s[44:47], s15 offen offset:3072 sc1
    s_addk_i32 s15, 0x1000
    buffer_load_dwordx4 a[156:159], v1, s[44:47], s14 offen offset:3072 sc1
    s_addk_i32 s14, 0x1000
    buffer_load_dwordx4 a[160:163], v1, s[44:47], s15 offen offset:0 sc1
    buffer_load_dwordx4 a[164:167], v1, s[44:47], s14 offen offset:0 sc1
    buffer_load_dwordx4 a[168:171], v1, s[44:47], s15 offen offset:1024 sc1
    buffer_load_dwordx4 a[172:175], v1, s[44:47], s14 offen offset:1024 sc1
    buffer_load_dwordx4 a[176:179], v1, s[44:47], s15 offen offset:2048 sc1
    buffer_load_dwordx4 a[180:183], v1, s[44:47], s14 offen offset:2048 sc1
L_p4e:
    v_add_u32 v252, 65536, v252
    ds_read_b64_tr_b16 v[148:149], v252 offset:0
    ds_read_b64_tr_b16 v[150:151], v252 offset:2048
    v_add_u32 v253, 65536, v253
    ds_read_b64_tr_b16 v[152:153], v253 offset:0
    ds_read_b64_tr_b16 v[154:155], v253 offset:2048
    v_add_u32 v254, 65536, v254
    ds_read_b64_tr_b16 v[156:157], v254 offset:0
    ds_read_b64_tr_b16 v[158:159], v254 offset:2048
    v_add_u32 v255, 65536, v255
    ds_read_b64_tr_b16 v[160:161], v255 offset:0
    ds_read_b64_tr_b16 v[162:163], v255 offset:2048
    ds_read_b64_tr_b16 v[164:165], v252 offset:4096
    ds_read_b64_tr_b16 v[166:167], v252 offset:6144
    ds_read_b64_tr_b16 v[168:169], v253 offset:4096
    ds_read_b64_tr_b16 v[170:171], v253 offset:6144
    ds_read_b64_tr_b16 v[172:173], v254 offset:4096
    ds_read_b64_tr_b16 v[174:175], v254 offset:6144
    ds_read_b64_tr_b16 v[176:177], v255 offset:4096
    ds_read_b64_tr_b16 v[178:179], v255 offset:6144
    ds_read_b64_tr_b16 v[180:181], v252 offset:8192
    ds_read_b64_tr_b16 v[182:183], v252 offset:10240
    ds_read_b64_tr_b16 v[184:185], v253 offset:8192
    ds_read_b64_tr_b16 v[186:187], v253 offset:10240
    s_cmp_lg_u32 s93, 0
    s_cbranch_scc1 L_af1
    s_waitcnt vmcnt(10)
    s_mov_b64 exec, 1
    buffer_store_dwordx2 v[246:247], off, s[44:47], s19 offset:0
L_ag1:
    s_mov_b64 exec, -1
    v_mfma_f32_16x16x32_bf16 v[20:23], a[64:67], a[128:131], 0
    buffer_load_dwordx4 a[184:187], v1, s[44:47], s15 offen offset:3072 sc1
    s_addk_i32 s15, 0x1000
    ds_read_b64_tr_b16 v[188:189], v254 offset:8192
    ds_read_b64_tr_b16 v[190:191], v254 offset:10240
    v_mfma_f32_16x16x32_bf16 v[36:39], a[64:67], a[132:135], 0
    ds_read_b64_tr_b16 v[192:193], v255 offset:8192
    ds_read_b64_tr_b16 v[194:195], v255 offset:10240
    v_mfma_f32_16x16x32_bf16 v[24:27], a[68:71], a[128:131], 0
    ds_read_b64_tr_b16 v[196:197], v252 offset:12288
    ds_read_b64_tr_b16 v[198:199], v252 offset:14336
    v_mfma_f32_16x16x32_bf16 v[40:43], a[68:71], a[132:135], 0
    buffer_load_dwordx4 a[188:191], v1, s[44:47], s14 offen offset:3072 sc1
    s_addk_i32 s14, 0x1000
    ds_read_b64_tr_b16 v[200:201], v253 offset:12288
    ds_read_b64_tr_b16 v[202:203], v253 offset:14336
    v_mfma_f32_16x16x32_bf16 v[28:31], a[72:75], a[128:131], 0
    ds_read_b64_tr_b16 v[204:205], v254 offset:12288
    ds_read_b64_tr_b16 v[206:207], v254 offset:14336
    v_mfma_f32_16x16x32_bf16 v[44:47], a[72:75], a[132:135], 0
    ds_read_b64_tr_b16 v[208:209], v255 offset:12288
    ds_read_b64_tr_b16 v[210:211], v255 offset:14336
    v_mfma_f32_16x16x32_bf16 v[32:35], a[76:79], a[128:131], 0
    buffer_load_dwordx4 a[192:195], v1, s[44:47], s15 offen offset:0 sc1
    ds_read_b64_tr_b16 v[212:213], v252 offset:32768
    ds_read_b64_tr_b16 v[214:215], v252 offset:34816
    v_mfma_f32_16x16x32_bf16 v[48:51], a[76:79], a[132:135], 0
    ds_read_b64_tr_b16 v[216:217], v253 offset:32768
    ds_read_b64_tr_b16 v[218:219], v253 offset:34816
    v_mfma_f32_16x16x32_bf16 v[20:23], a[80:83], a[136:139], v[20:23]
    ds_read_b64_tr_b16 v[220:221], v254 offset:32768
    ds_read_b64_tr_b16 v[222:223], v254 offset:34816
    v_mfma_f32_16x16x32_bf16 v[36:39], a[80:83], a[140:143], v[36:39]
    buffer_load_dwordx4 a[196:199], v1, s[44:47], s14 offen offset:0 sc1
    ds_read_b64_tr_b16 v[224:225], v255 offset:32768
    ds_read_b64_tr_b16 v[226:227], v255 offset:34816
    v_mfma_f32_16x16x32_bf16 v[24:27], a[84:87], a[136:139], v[24:27]
    ds_read_b64_tr_b16 v[72:73], v252 offset:36864
    ds_read_b64_tr_b16 v[74:75], v252 offset:38912
    v_mfma_f32_16x16x32_bf16 v[40:43], a[84:87], a[140:143], v[40:43]
    ds_read_b64_tr_b16 v[76:77], v253 offset:36864
    ds_read_b64_tr_b16 v[78:79], v253 offset:38912
    v_mfma_f32_16x16x32_bf16 v[28:31], a[88:91], a[136:139], v[28:31]
    buffer_load_dwordx4 a[200:203], v1, s[44:47], s15 offen offset:1024 sc1
    ds_read_b64_tr_b16 v[80:81], v254 offset:36864
    ds_read_b64_tr_b16 v[82:83], v254 offset:38912
    v_mfma_f32_16x16x32_bf16 v[44:47], a[88:91], a[140:143], v[44:47]
    ds_read_b64_tr_b16 v[84:85], v255 offset:36864
    ds_read_b64_tr_b16 v[86:87], v255 offset:38912
    v_mfma_f32_16x16x32_bf16 v[32:35], a[92:95], a[136:139], v[32:35]
    ds_read_b64_tr_b16 v[88:89], v252 offset:40960
    ds_read_b64_tr_b16 v[90:91], v252 offset:43008
    v_mfma_f32_16x16x32_bf16 v[48:51], a[92:95], a[140:143], v[48:51]
    buffer_load_dwordx4 a[204:207], v1, s[44:47], s14 offen offset:1024 sc1
    ds_read_b64_tr_b16 v[92:93], v253 offset:40960
    ds_read_b64_tr_b16 v[94:95], v253 offset:43008
    s_waitcnt vmcnt(16)
    v_mfma_f32_16x16x32_bf16 v[20:23], a[96:99], a[144:147], v[20:23]
    ds_read_b64_tr_b16 v[96:97], v254 offset:40960
    ds_read_b64_tr_b16 v[98:99], v254 offset:43008
    s_waitcnt vmcnt(15)
    v_mfma_f32_16x16x32_bf16 v[36:39], a[96:99], a[148:151], v[36:39]
    ds_read_b64_tr_b16 v[100:101], v255 offset:40960
    ds_read_b64_tr_b16 v[102:103], v255 offset:43008
    v_mfma_f32_16x16x32_bf16 v[24:27], a[100:103], a[144:147], v[24:27]
    buffer_load_dwordx4 a[208:211], v1, s[44:47], s15 offen offset:2048 sc1
    ds_read_b64_tr_b16 v[104:105], v252 offset:45056
    ds_read_b64_tr_b16 v[106:107], v252 offset:47104
    v_mfma_f32_16x16x32_bf16 v[40:43], a[100:103], a[148:151], v[40:43]
    ds_read_b64_tr_b16 v[108:109], v253 offset:45056
    ds_read_b64_tr_b16 v[110:111], v253 offset:47104
    v_mfma_f32_16x16x32_bf16 v[28:31], a[104:107], a[144:147], v[28:31]
    ds_read_b64_tr_b16 v[112:113], v254 offset:45056
    ds_read_b64_tr_b16 v[114:115], v254 offset:47104
    v_mfma_f32_16x16x32_bf16 v[44:47], a[104:107], a[148:151], v[44:47]
    buffer_load_dwordx4 a[212:215], v1, s[44:47], s14 offen offset:2048 sc1
    ds_read_b64_tr_b16 v[116:117], v255 offset:45056
    ds_read_b64_tr_b16 v[118:119], v255 offset:47104
    v_mfma_f32_16x16x32_bf16 v[32:35], a[108:111], a[144:147], v[32:35]
    v_add_u32 v252, 4294901760, v252
    ds_read_b64_tr_b16 v[120:121], v252 offset:0
    ds_read_b64_tr_b16 v[122:123], v252 offset:2048
    v_mfma_f32_16x16x32_bf16 v[48:51], a[108:111], a[148:151], v[48:51]
    v_add_u32 v253, 4294901760, v253
    ds_read_b64_tr_b16 v[124:125], v253 offset:0
    ds_read_b64_tr_b16 v[126:127], v253 offset:2048
    s_waitcnt vmcnt(16)
    v_mfma_f32_16x16x32_bf16 v[20:23], a[112:115], a[152:155], v[20:23]
    buffer_load_dwordx4 a[216:219], v1, s[44:47], s15 offen offset:3072 sc1
    s_addk_i32 s15, 0x1000
    v_add_u32 v254, 4294901760, v254
    ds_read_b64_tr_b16 v[128:129], v254 offset:0
    ds_read_b64_tr_b16 v[130:131], v254 offset:2048
    s_waitcnt vmcnt(16)
    v_mfma_f32_16x16x32_bf16 v[36:39], a[112:115], a[156:159], v[36:39]
    v_add_u32 v255, 4294901760, v255
    ds_read_b64_tr_b16 v[132:133], v255 offset:0
    ds_read_b64_tr_b16 v[134:135], v255 offset:2048
    v_mfma_f32_16x16x32_bf16 v[24:27], a[116:119], a[152:155], v[24:27]
    ds_read_b64_tr_b16 v[136:137], v252 offset:4096
    ds_read_b64_tr_b16 v[138:139], v252 offset:6144
    v_mfma_f32_16x16x32_bf16 v[40:43], a[116:119], a[156:159], v[40:43]
    buffer_load_dwordx4 a[220:223], v1, s[44:47], s14 offen offset:3072 sc1
    s_addk_i32 s14, 0x1000
    ds_read_b64_tr_b16 v[140:141], v253 offset:4096
    ds_read_b64_tr_b16 v[142:143], v253 offset:6144
    v_mfma_f32_16x16x32_bf16 v[28:31], a[120:123], a[152:155], v[28:31]
    ds_read_b64_tr_b16 v[144:145], v254 offset:4096
    ds_read_b64_tr_b16 v[146:147], v254 offset:6144
    v_mfma_f32_16x16x32_bf16 v[44:47], a[120:123], a[156:159], v[44:47]
    v_mfma_f32_16x16x32_bf16 v[32:35], a[124:127], a[152:155], v[32:35]
    buffer_load_dwordx4 a[224:227], v1, s[44:47], s15 offen offset:0 sc1
    v_mfma_f32_16x16x32_bf16 v[48:51], a[124:127], a[156:159], v[48:51]
    s_waitcnt vmcnt(17)
    v_mfma_f32_16x16x32_bf16 v[20:23], a[0:3], a[160:163], v[20:23]
    s_waitcnt vmcnt(16)
    v_mfma_f32_16x16x32_bf16 v[36:39], a[0:3], a[164:167], v[36:39]
    buffer_load_dwordx4 a[228:231], v1, s[44:47], s14 offen offset:0 sc1
    v_mfma_f32_16x16x32_bf16 v[24:27], a[4:7], a[160:163], v[24:27]
    v_mfma_f32_16x16x32_bf16 v[40:43], a[4:7], a[164:167], v[40:43]
    v_mfma_f32_16x16x32_bf16 v[28:31], a[8:11], a[160:163], v[28:31]
    buffer_load_dwordx4 a[232:235], v1, s[44:47], s15 offen offset:1024 sc1
    v_mfma_f32_16x16x32_bf16 v[44:47], a[8:11], a[164:167], v[44:47]
    v_mfma_f32_16x16x32_bf16 v[32:35], a[12:15], a[160:163], v[32:35]
    v_mfma_f32_16x16x32_bf16 v[48:51], a[12:15], a[164:167], v[48:51]
    buffer_load_dwordx4 a[236:239], v1, s[44:47], s14 offen offset:1024 sc1
    s_waitcnt vmcnt(18)
    v_mfma_f32_16x16x32_bf16 v[20:23], a[16:19], a[168:171], v[20:23]
    s_waitcnt vmcnt(17)
    v_mfma_f32_16x16x32_bf16 v[36:39], a[16:19], a[172:175], v[36:39]
    v_mfma_f32_16x16x32_bf16 v[24:27], a[20:23], a[168:171], v[24:27]
    buffer_load_dword v55, v3, s[44:47], s16 offen offset:1536 sc1
    v_mfma_f32_16x16x32_bf16 v[40:43], a[20:23], a[172:175], v[40:43]
    v_mfma_f32_16x16x32_bf16 v[28:31], a[24:27], a[168:171], v[28:31]
    v_mfma_f32_16x16x32_bf16 v[44:47], a[24:27], a[172:175], v[44:47]
    buffer_load_dword v54, v3, s[44:47], s16 offen offset:1024 sc1
    v_mfma_f32_16x16x32_bf16 v[32:35], a[28:31], a[168:171], v[32:35]
    v_mfma_f32_16x16x32_bf16 v[48:51], a[28:31], a[172:175], v[48:51]
    s_waitcnt vmcnt(18)
    v_mfma_f32_16x16x32_bf16 v[20:23], a[32:35], a[176:179], v[20:23]
    buffer_load_dword v53, v3, s[44:47], s16 offen offset:512 sc1
    s_waitcnt vmcnt(18)
    v_mfma_f32_16x16x32_bf16 v[36:39], a[32:35], a[180:183], v[36:39]
    v_mfma_f32_16x16x32_bf16 v[24:27], a[36:39], a[176:179], v[24:27]
    v_mfma_f32_16x16x32_bf16 v[40:43], a[36:39], a[180:183], v[40:43]
    buffer_load_dword v52, v3, s[44:47], s16 offen offset:0 sc1
    v_mfma_f32_16x16x32_bf16 v[28:31], a[40:43], a[176:179], v[28:31]
    v_mfma_f32_16x16x32_bf16 v[44:47], a[40:43], a[180:183], v[44:47]
    v_mfma_f32_16x16x32_bf16 v[32:35], a[44:47], a[176:179], v[32:35]
    s_addk_i32 m0, 0x400
    s_addk_i32 s55, 0x2000
    buffer_load_dwordx4 v244, s[36:39], s55 offen lds
    v_mfma_f32_16x16x32_bf16 v[48:51], a[44:47], a[180:183], v[48:51]
    s_waitcnt vmcnt(18)
    v_mfma_f32_16x16x32_bf16 v[20:23], a[48:51], a[184:187], v[20:23]
    s_waitcnt vmcnt(17)
    v_mfma_f32_16x16x32_bf16 v[36:39], a[48:51], a[188:191], v[36:39]
    v_mfma_f32_16x16x32_bf16 v[24:27], a[52:55], a[184:187], v[24:27]
    v_mfma_f32_16x16x32_bf16 v[40:43], a[52:55], a[188:191], v[40:43]
    v_mfma_f32_16x16x32_bf16 v[28:31], a[56:59], a[184:187], v[28:31]
    s_mov_b64 exec, 0x3fff
    buffer_load_dwordx2 v[8:9], v2, s[44:47], s20 offen offset:0 sc1
    s_mov_b64 exec, -1
    v_mfma_f32_16x16x32_bf16 v[44:47], a[56:59], a[188:191], v[44:47]
    v_mfma_f32_16x16x32_bf16 v[32:35], a[60:63], a[184:187], v[32:35]
    v_mfma_f32_16x16x32_bf16 v[48:51], a[60:63], a[188:191], v[48:51]
    s_waitcnt lgkmcnt(15)
    s_waitcnt vmcnt(17)
    v_mfma_f32_16x16x32_bf16 v[20:23], v[148:151], a[192:195], v[20:23]
    s_waitcnt vmcnt(16)
    v_mfma_f32_16x16x32_bf16 v[36:39], v[148:151], a[196:199], v[36:39]
    v_mfma_f32_16x16x32_bf16 v[24:27], v[152:155], a[192:195], v[24:27]
    ds_read_b64_tr_b16 v[148:149], v255 offset:4096
    ds_read_b64_tr_b16 v[150:151], v255 offset:6144
    v_mfma_f32_16x16x32_bf16 v[40:43], v[152:155], a[196:199], v[40:43]
    v_mfma_f32_16x16x32_bf16 v[28:31], v[156:159], a[192:195], v[28:31]
    ds_read_b64_tr_b16 v[152:153], v252 offset:8192
    ds_read_b64_tr_b16 v[154:155], v252 offset:10240
    v_mfma_f32_16x16x32_bf16 v[44:47], v[156:159], a[196:199], v[44:47]
    v_mfma_f32_16x16x32_bf16 v[32:35], v[160:163], a[192:195], v[32:35]
    ds_read_b64_tr_b16 v[156:157], v253 offset:8192
    ds_read_b64_tr_b16 v[158:159], v253 offset:10240
    v_mfma_f32_16x16x32_bf16 v[48:51], v[160:163], a[196:199], v[48:51]
    s_waitcnt vmcnt(15)
    v_mfma_f32_16x16x32_bf16 v[20:23], v[164:167], a[200:203], v[20:23]
    ds_read_b64_tr_b16 v[160:161], v254 offset:8192
    ds_read_b64_tr_b16 v[162:163], v254 offset:10240
    s_waitcnt vmcnt(14)
    v_mfma_f32_16x16x32_bf16 v[36:39], v[164:167], a[204:207], v[36:39]
    v_mfma_f32_16x16x32_bf16 v[24:27], v[168:171], a[200:203], v[24:27]
    ds_read_b64_tr_b16 v[164:165], v255 offset:8192
    ds_read_b64_tr_b16 v[166:167], v255 offset:10240
    v_mfma_f32_16x16x32_bf16 v[40:43], v[168:171], a[204:207], v[40:43]
    v_mfma_f32_16x16x32_bf16 v[28:31], v[172:175], a[200:203], v[28:31]
    ds_read_b64_tr_b16 v[168:169], v252 offset:12288
    ds_read_b64_tr_b16 v[170:171], v252 offset:14336
    v_mfma_f32_16x16x32_bf16 v[44:47], v[172:175], a[204:207], v[44:47]
    v_mfma_f32_16x16x32_bf16 v[32:35], v[176:179], a[200:203], v[32:35]
    ds_read_b64_tr_b16 v[172:173], v253 offset:12288
    ds_read_b64_tr_b16 v[174:175], v253 offset:14336
    v_mfma_f32_16x16x32_bf16 v[48:51], v[176:179], a[204:207], v[48:51]
    s_waitcnt vmcnt(13)
    v_mfma_f32_16x16x32_bf16 v[20:23], v[180:183], a[208:211], v[20:23]
    ds_read_b64_tr_b16 v[176:177], v254 offset:12288
    ds_read_b64_tr_b16 v[178:179], v254 offset:14336
    s_waitcnt vmcnt(12)
    v_mfma_f32_16x16x32_bf16 v[36:39], v[180:183], a[212:215], v[36:39]
    v_mfma_f32_16x16x32_bf16 v[24:27], v[184:187], a[208:211], v[24:27]
    ds_read_b64_tr_b16 v[180:181], v255 offset:12288
    ds_read_b64_tr_b16 v[182:183], v255 offset:14336
    v_mfma_f32_16x16x32_bf16 v[40:43], v[184:187], a[212:215], v[40:43]
    v_mfma_f32_16x16x32_bf16 v[28:31], v[188:191], a[208:211], v[28:31]
    s_waitcnt vmcnt(0)
    v_cmp_ne_u64 vcc, s[48:49], v[8:9]
    s_nop 0
    s_and_b32 vcc_lo, vcc_lo, 0x3fff
    s_cbranch_scc1 L_cb_s
L_cb:
    v_mfma_f32_16x16x32_bf16 v[44:47], v[188:191], a[212:215], v[44:47]
    buffer_load_dwordx4 a[240:243], v1, s[44:47], s15 offen offset:2048 sc1
    v_mfma_f32_16x16x32_bf16 v[32:35], v[192:195], a[208:211], v[32:35]
    v_mfma_f32_16x16x32_bf16 v[48:51], v[192:195], a[212:215], v[48:51]
    v_mfma_f32_16x16x32_bf16 v[20:23], v[196:199], a[216:219], v[20:23]
    buffer_load_dwordx4 a[244:247], v1, s[44:47], s14 offen offset:2048 sc1
    v_mfma_f32_16x16x32_bf16 v[36:39], v[196:199], a[220:223], v[36:39]
    v_mfma_f32_16x16x32_bf16 v[24:27], v[200:203], a[216:219], v[24:27]
    v_mfma_f32_16x16x32_bf16 v[40:43], v[200:203], a[220:223], v[40:43]
    buffer_load_dwordx4 a[248:251], v1, s[44:47], s15 offen offset:3072 sc1
    s_addk_i32 s15, 0x1000
    v_mfma_f32_16x16x32_bf16 v[28:31], v[204:207], a[216:219], v[28:31]
    v_mfma_f32_16x16x32_bf16 v[44:47], v[204:207], a[220:223], v[44:47]
    v_mfma_f32_16x16x32_bf16 v[32:35], v[208:211], a[216:219], v[32:35]
    buffer_load_dwordx4 a[252:255], v1, s[44:47], s14 offen offset:3072 sc1
    s_addk_i32 s14, 0x1000
    v_mfma_f32_16x16x32_bf16 v[48:51], v[208:211], a[220:223], v[48:51]
    v_mfma_f32_16x16x32_bf16 v[20:23], v[212:215], a[224:227], v[20:23]
    v_mfma_f32_16x16x32_bf16 v[36:39], v[212:215], a[228:231], v[36:39]
    buffer_load_dwordx4 a[64:67], v1, s[44:47], s15 offen offset:0 sc1
    v_mfma_f32_16x16x32_bf16 v[24:27], v[216:219], a[224:227], v[24:27]
    v_mfma_f32_16x16x32_bf16 v[40:43], v[216:219], a[228:231], v[40:43]
    v_mfma_f32_16x16x32_bf16 v[28:31], v[220:223], a[224:227], v[28:31]
    s_barrier
    buffer_load_dwordx4 a[68:71], v1, s[44:47], s14 offen offset:0 sc1
    v_add_u32 v252, 131072, v252
    ds_read_b64_tr_b16 v[184:185], v252 offset:0
    ds_read_b64_tr_b16 v[186:187], v252 offset:2048
    v_mfma_f32_16x16x32_bf16 v[44:47], v[220:223], a[228:231], v[44:47]
    v_add_u32 v253, 131072, v253
    ds_read_b64_tr_b16 v[188:189], v253 offset:0
    ds_read_b64_tr_b16 v[190:191], v253 offset:2048
    v_mfma_f32_16x16x32_bf16 v[32:35], v[224:227], a[224:227], v[32:35]
    v_add_u32 v254, 131072, v254
    ds_read_b64_tr_b16 v[192:193], v254 offset:0
    ds_read_b64_tr_b16 v[194:195], v254 offset:2048
    v_mfma_f32_16x16x32_bf16 v[48:51], v[224:227], a[228:231], v[48:51]
    buffer_load_dwordx4 a[72:75], v1, s[44:47], s15 offen offset:1024 sc1
    v_add_u32 v255, 131072, v255
    ds_read_b64_tr_b16 v[196:197], v255 offset:0
    ds_read_b64_tr_b16 v[198:199], v255 offset:2048
    v_mfma_f32_16x16x32_bf16 v[20:23], v[72:75], a[232:235], v[20:23]
    ds_read_b64_tr_b16 v[200:201], v252 offset:4096
    ds_read_b64_tr_b16 v[202:203], v252 offset:6144
    v_mfma_f32_16x16x32_bf16 v[36:39], v[72:75], a[236:239], v[36:39]
    ds_read_b64_tr_b16 v[204:205], v253 offset:4096
    ds_read_b64_tr_b16 v[206:207], v253 offset:6144
    v_mfma_f32_16x16x32_bf16 v[24:27], v[76:79], a[232:235], v[24:27]
    buffer_load_dwordx4 a[76:79], v1, s[44:47], s14 offen offset:1024 sc1
    ds_read_b64_tr_b16 v[208:209], v254 offset:4096
    ds_read_b64_tr_b16 v[210:211], v254 offset:6144
    v_mfma_f32_16x16x32_bf16 v[40:43], v[76:79], a[236:239], v[40:43]
    ds_read_b64_tr_b16 v[212:213], v255 offset:4096
    ds_read_b64_tr_b16 v[214:215], v255 offset:6144
    v_mfma_f32_16x16x32_bf16 v[28:31], v[80:83], a[232:235], v[28:31]
    ds_read_b64_tr_b16 v[216:217], v252 offset:8192
    ds_read_b64_tr_b16 v[218:219], v252 offset:10240
    v_mfma_f32_16x16x32_bf16 v[44:47], v[80:83], a[236:239], v[44:47]
    buffer_load_dwordx4 a[80:83], v1, s[44:47], s15 offen offset:2048 sc1
    ds_read_b64_tr_b16 v[220:221], v253 offset:8192
    ds_read_b64_tr_b16 v[222:223], v253 offset:10240
    v_mfma_f32_16x16x32_bf16 v[32:35], v[84:87], a[232:235], v[32:35]
    ds_read_b64_tr_b16 v[224:225], v254 offset:8192
    ds_read_b64_tr_b16 v[226:227], v254 offset:10240
    v_mfma_f32_16x16x32_bf16 v[48:51], v[84:87], a[236:239], v[48:51]
    ds_read_b64_tr_b16 v[72:73], v255 offset:8192
    ds_read_b64_tr_b16 v[74:75], v255 offset:10240
    s_waitcnt vmcnt(8)
    v_mfma_f32_16x16x32_bf16 v[20:23], v[88:91], a[240:243], v[20:23]
    buffer_load_dwordx4 a[84:87], v1, s[44:47], s14 offen offset:2048 sc1
    ds_read_b64_tr_b16 v[76:77], v252 offset:12288
    ds_read_b64_tr_b16 v[78:79], v252 offset:14336
    s_waitcnt vmcnt(8)
    v_mfma_f32_16x16x32_bf16 v[36:39], v[88:91], a[244:247], v[36:39]
    ds_read_b64_tr_b16 v[80:81], v253 offset:12288
    ds_read_b64_tr_b16 v[82:83], v253 offset:14336
    v_mfma_f32_16x16x32_bf16 v[24:27], v[92:95], a[240:243], v[24:27]
    ds_read_b64_tr_b16 v[84:85], v254 offset:12288
    ds_read_b64_tr_b16 v[86:87], v254 offset:14336
    v_mfma_f32_16x16x32_bf16 v[40:43], v[92:95], a[244:247], v[40:43]
    buffer_load_dwordx4 a[88:91], v1, s[44:47], s15 offen offset:3072 sc1
    s_addk_i32 s15, 0x1000
    ds_read_b64_tr_b16 v[88:89], v255 offset:12288
    ds_read_b64_tr_b16 v[90:91], v255 offset:14336
    v_mfma_f32_16x16x32_bf16 v[28:31], v[96:99], a[240:243], v[28:31]
    v_add_u32 v252, 4294868992, v252
    ds_read_b64_tr_b16 v[92:93], v252 offset:0
    ds_read_b64_tr_b16 v[94:95], v252 offset:2048
    v_mfma_f32_16x16x32_bf16 v[44:47], v[96:99], a[244:247], v[44:47]
    v_mfma_f32_16x16x32_bf16 v[32:35], v[100:103], a[240:243], v[32:35]
    buffer_load_dwordx4 a[92:95], v1, s[44:47], s14 offen offset:3072 sc1
    s_addk_i32 s14, 0x1000
    v_add_u32 v253, 4294868992, v253
    ds_read_b64_tr_b16 v[96:97], v253 offset:0
    ds_read_b64_tr_b16 v[98:99], v253 offset:2048
    v_mfma_f32_16x16x32_bf16 v[48:51], v[100:103], a[244:247], v[48:51]
    s_waitcnt vmcnt(9)
    v_mfma_f32_16x16x32_bf16 v[20:23], v[104:107], a[248:251], v[20:23]
    v_add_u32 v254, 4294868992, v254
    ds_read_b64_tr_b16 v[100:101], v254 offset:0
    ds_read_b64_tr_b16 v[102:103], v254 offset:2048
    s_waitcnt vmcnt(8)
    v_mfma_f32_16x16x32_bf16 v[36:39], v[104:107], a[252:255], v[36:39]
    buffer_load_dwordx4 a[96:99], v1, s[44:47], s15 offen offset:0 sc1
    v_mfma_f32_16x16x32_bf16 v[24:27], v[108:111], a[248:251], v[24:27]
    v_add_u32 v255, 4294868992, v255
    ds_read_b64_tr_b16 v[104:105], v255 offset:0
    ds_read_b64_tr_b16 v[106:107], v255 offset:2048
    v_mfma_f32_16x16x32_bf16 v[40:43], v[108:111], a[252:255], v[40:43]
    v_mfma_f32_16x16x32_bf16 v[28:31], v[112:115], a[248:251], v[28:31]
    buffer_load_dwordx4 a[100:103], v1, s[44:47], s14 offen offset:0 sc1
    ds_read_b64_tr_b16 v[108:109], v252 offset:4096
    ds_read_b64_tr_b16 v[110:111], v252 offset:6144
    v_mfma_f32_16x16x32_bf16 v[44:47], v[112:115], a[252:255], v[44:47]
    s_waitcnt lgkmcnt(15)
    v_mfma_f32_16x16x32_bf16 v[32:35], v[116:119], a[248:251], v[32:35]
    ds_read_b64_tr_b16 v[112:113], v253 offset:4096
    ds_read_b64_tr_b16 v[114:115], v253 offset:6144
    v_mfma_f32_16x16x32_bf16 v[48:51], v[116:119], a[252:255], v[48:51]
    buffer_load_dwordx4 a[104:107], v1, s[44:47], s15 offen offset:1024 sc1
    s_waitcnt vmcnt(10)
    v_mfma_f32_16x16x32_bf16 v[20:23], v[120:123], a[64:67], v[20:23]
    ds_read_b64_tr_b16 v[116:117], v254 offset:4096
    ds_read_b64_tr_b16 v[118:119], v254 offset:6144
    s_waitcnt vmcnt(9)
    v_mfma_f32_16x16x32_bf16 v[36:39], v[120:123], a[68:71], v[36:39]
    v_mfma_f32_16x16x32_bf16 v[24:27], v[124:127], a[64:67], v[24:27]
    buffer_load_dwordx4 a[112:115], v1, s[44:47], s15 offen offset:2048 sc1
    ds_read_b64_tr_b16 v[120:121], v255 offset:4096
    ds_read_b64_tr_b16 v[122:123], v255 offset:6144
    v_mfma_f32_16x16x32_bf16 v[40:43], v[124:127], a[68:71], v[40:43]
    v_mfma_f32_16x16x32_bf16 v[28:31], v[128:131], a[64:67], v[28:31]
    ds_read_b64_tr_b16 v[124:125], v252 offset:8192
    ds_read_b64_tr_b16 v[126:127], v252 offset:10240
    v_mfma_f32_16x16x32_bf16 v[44:47], v[128:131], a[68:71], v[44:47]
    buffer_load_dwordx4 a[120:123], v1, s[44:47], s15 offen offset:3072 sc1
    s_addk_i32 s15, 0x1000
    v_mfma_f32_16x16x32_bf16 v[32:35], v[132:135], a[64:67], v[32:35]
    ds_read_b64_tr_b16 v[128:129], v253 offset:8192
    ds_read_b64_tr_b16 v[130:131], v253 offset:10240
    v_mfma_f32_16x16x32_bf16 v[48:51], v[132:135], a[68:71], v[48:51]
    s_waitcnt vmcnt(10)
    v_mfma_f32_16x16x32_bf16 v[20:23], v[136:139], a[72:75], v[20:23]
    buffer_load_dwordx4 a[0:3], v1, s[44:47], s15 offen offset:0 sc1
    ds_read_b64_tr_b16 v[132:133], v254 offset:8192
    ds_read_b64_tr_b16 v[134:135], v254 offset:10240
    s_waitcnt vmcnt(10)
    v_mfma_f32_16x16x32_bf16 v[36:39], v[136:139], a[76:79], v[36:39]
    v_mfma_f32_16x16x32_bf16 v[24:27], v[140:143], a[72:75], v[24:27]
    ds_read_b64_tr_b16 v[136:137], v255 offset:8192
    ds_read_b64_tr_b16 v[138:139], v255 offset:10240
    v_mfma_f32_16x16x32_bf16 v[40:43], v[140:143], a[76:79], v[40:43]
    buffer_load_dwordx4 a[8:11], v1, s[44:47], s15 offen offset:1024 sc1
    v_mfma_f32_16x16x32_bf16 v[28:31], v[144:147], a[72:75], v[28:31]
    ds_read_b64_tr_b16 v[140:141], v252 offset:12288
    ds_read_b64_tr_b16 v[142:143], v252 offset:14336
    v_mfma_f32_16x16x32_bf16 v[44:47], v[144:147], a[76:79], v[44:47]
    v_mfma_f32_16x16x32_bf16 v[32:35], v[148:151], a[72:75], v[32:35]
    buffer_load_dwordx4 a[16:19], v1, s[44:47], s15 offen offset:2048 sc1
    ds_read_b64_tr_b16 v[144:145], v253 offset:12288
    ds_read_b64_tr_b16 v[146:147], v253 offset:14336
    v_mfma_f32_16x16x32_bf16 v[48:51], v[148:151], a[76:79], v[48:51]
    s_waitcnt vmcnt(11)
    v_mfma_f32_16x16x32_bf16 v[20:23], v[152:155], a[80:83], v[20:23]
    ds_read_b64_tr_b16 v[148:149], v254 offset:12288
    ds_read_b64_tr_b16 v[150:151], v254 offset:14336
    s_waitcnt vmcnt(10)
    v_mfma_f32_16x16x32_bf16 v[36:39], v[152:155], a[84:87], v[36:39]
    buffer_load_dwordx4 a[24:27], v1, s[44:47], s15 offen offset:3072 sc1
    v_mfma_f32_16x16x32_bf16 v[24:27], v[156:159], a[80:83], v[24:27]
    ds_read_b64_tr_b16 v[152:153], v255 offset:12288
    ds_read_b64_tr_b16 v[154:155], v255 offset:14336
    v_mfma_f32_16x16x32_bf16 v[40:43], v[156:159], a[84:87], v[40:43]
    v_mfma_f32_16x16x32_bf16 v[28:31], v[160:163], a[80:83], v[28:31]
    buffer_load_dwordx4 a[108:111], v1, s[44:47], s14 offen offset:1024 sc1
    v_mfma_f32_16x16x32_bf16 v[44:47], v[160:163], a[84:87], v[44:47]
    v_mfma_f32_16x16x32_bf16 v[32:35], v[164:167], a[80:83], v[32:35]
    v_mfma_f32_16x16x32_bf16 v[48:51], v[164:167], a[84:87], v[48:51]
    buffer_load_dwordx4 a[116:119], v1, s[44:47], s14 offen offset:2048 sc1
    s_waitcnt vmcnt(12)
    v_mfma_f32_16x16x32_bf16 v[20:23], v[168:171], a[88:91], v[20:23]
    s_waitcnt vmcnt(11)
    v_mfma_f32_16x16x32_bf16 v[36:39], v[168:171], a[92:95], v[36:39]
    v_mfma_f32_16x16x32_bf16 v[24:27], v[172:175], a[88:91], v[24:27]
    buffer_load_dwordx4 a[124:127], v1, s[44:47], s14 offen offset:3072 sc1
    s_addk_i32 s14, 0x1000
    v_mfma_f32_16x16x32_bf16 v[40:43], v[172:175], a[92:95], v[40:43]
    v_mfma_f32_16x16x32_bf16 v[28:31], v[176:179], a[88:91], v[28:31]
    v_mfma_f32_16x16x32_bf16 v[44:47], v[176:179], a[92:95], v[44:47]
    buffer_load_dwordx4 a[4:7], v1, s[44:47], s14 offen offset:0 sc1
    v_mfma_f32_16x16x32_bf16 v[32:35], v[180:183], a[88:91], v[32:35]
    v_mfma_f32_16x16x32_bf16 v[48:51], v[180:183], a[92:95], v[48:51]
    s_waitcnt vmcnt(12)
    v_mfma_f32_16x16x32_bf16 v[20:23], v[184:187], a[96:99], v[20:23]
    buffer_load_dwordx4 a[12:15], v1, s[44:47], s14 offen offset:1024 sc1
    s_waitcnt vmcnt(12)
    v_mfma_f32_16x16x32_bf16 v[36:39], v[184:187], a[100:103], v[36:39]
    v_mfma_f32_16x16x32_bf16 v[24:27], v[188:191], a[96:99], v[24:27]
    v_mfma_f32_16x16x32_bf16 v[40:43], v[188:191], a[100:103], v[40:43]
    buffer_load_dwordx4 a[20:23], v1, s[44:47], s14 offen offset:2048 sc1
    v_mfma_f32_16x16x32_bf16 v[28:31], v[192:195], a[96:99], v[28:31]
    v_mfma_f32_16x16x32_bf16 v[44:47], v[192:195], a[100:103], v[44:47]
    v_mfma_f32_16x16x32_bf16 v[32:35], v[196:199], a[96:99], v[32:35]
    buffer_load_dwordx4 a[28:31], v1, s[44:47], s14 offen offset:3072 sc1
    v_mfma_f32_16x16x32_bf16 v[48:51], v[196:199], a[100:103], v[48:51]
    s_waitcnt vmcnt(13)
    v_mfma_f32_16x16x32_bf16 v[20:23], v[200:203], a[104:107], v[20:23]
    v_mfma_f32_16x16x32_bf16 v[24:27], v[204:207], a[104:107], v[24:27]
    v_mfma_f32_16x16x32_bf16 v[28:31], v[208:211], a[104:107], v[28:31]
    v_mfma_f32_16x16x32_bf16 v[32:35], v[212:215], a[104:107], v[32:35]
    s_waitcnt vmcnt(12)
    v_mfma_f32_16x16x32_bf16 v[20:23], v[216:219], a[112:115], v[20:23]
    v_add_f32 v52, v52, v53
    v_mfma_f32_16x16x32_bf16 v[24:27], v[220:223], a[112:115], v[24:27]
    v_add_f32 v54, v54, v55
    v_add_f32 v52, v52, v54
    v_mfma_f32_16x16x32_bf16 v[28:31], v[224:227], a[112:115], v[28:31]
    v_mov_b32 v53, v52
    v_mov_b32 v54, 0x3727c5ac
    v_mfma_f32_16x16x32_bf16 v[32:35], v[72:75], a[112:115], v[32:35]
    s_nop 0
    v_permlane32_swap_b32 v53, v52
    s_waitcnt vmcnt(11)
    v_mfma_f32_16x16x32_bf16 v[20:23], v[76:79], a[120:123], v[20:23]
    v_add_f32 v52, v52, v53
    v_mov_b32 v53, v52
    s_waitcnt lgkmcnt(15)
    v_mfma_f32_16x16x32_bf16 v[24:27], v[80:83], a[120:123], v[24:27]
    s_nop 0
    s_nop 0
    v_mfma_f32_16x16x32_bf16 v[28:31], v[84:87], a[120:123], v[28:31]
    v_permlane16_swap_b32 v53, v52
    v_add_f32 v52, v52, v53
    v_mfma_f32_16x16x32_bf16 v[32:35], v[88:91], a[120:123], v[32:35]
    v_fmac_f32 v54, 0x3b000000, v52
    v_rcp_f32 v52, v54
    s_waitcnt vmcnt(10)
    v_mfma_f32_16x16x32_bf16 v[20:23], v[92:95], a[0:3], v[20:23]
    v_mfma_f32_16x16x32_bf16 v[24:27], v[96:99], a[0:3], v[24:27]
    v_mfma_f32_16x16x32_bf16 v[28:31], v[100:103], a[0:3], v[28:31]
    v_mfma_f32_16x16x32_bf16 v[32:35], v[104:107], a[0:3], v[32:35]
    s_waitcnt vmcnt(9)
    v_mfma_f32_16x16x32_bf16 v[20:23], v[108:111], a[8:11], v[20:23]
    v_mfma_f32_16x16x32_bf16 v[24:27], v[112:115], a[8:11], v[24:27]
    v_mfma_f32_16x16x32_bf16 v[28:31], v[116:119], a[8:11], v[28:31]
    v_mfma_f32_16x16x32_bf16 v[32:35], v[120:123], a[8:11], v[32:35]
    s_waitcnt lgkmcnt(14)
    s_waitcnt vmcnt(8)
    v_mfma_f32_16x16x32_bf16 v[20:23], v[124:127], a[16:19], v[20:23]
    s_waitcnt lgkmcnt(12)
    v_mfma_f32_16x16x32_bf16 v[24:27], v[128:131], a[16:19], v[24:27]
    s_waitcnt lgkmcnt(10)
    v_mfma_f32_16x16x32_bf16 v[28:31], v[132:135], a[16:19], v[28:31]
    s_waitcnt lgkmcnt(8)
    v_mfma_f32_16x16x32_bf16 v[32:35], v[136:139], a[16:19], v[32:35]
    s_waitcnt lgkmcnt(6)
    s_waitcnt vmcnt(7)
    v_mfma_f32_16x16x32_bf16 v[20:23], v[140:143], a[24:27], v[20:23]
    s_waitcnt lgkmcnt(4)
    v_mfma_f32_16x16x32_bf16 v[24:27], v[144:147], a[24:27], v[24:27]
    s_waitcnt lgkmcnt(2)
    v_mfma_f32_16x16x32_bf16 v[28:31], v[148:151], a[24:27], v[28:31]
    s_waitcnt lgkmcnt(0)
    v_mfma_f32_16x16x32_bf16 v[32:35], v[152:155], a[24:27], v[32:35]
    s_waitcnt vmcnt(6)
    v_mfma_f32_16x16x32_bf16 v[36:39], v[200:203], a[108:111], v[36:39]
    v_mfma_f32_16x16x32_bf16 v[40:43], v[204:207], a[108:111], v[40:43]
    ds_write_b128 v10, v[20:23] offset:0
    ds_write_b128 v10, v[24:27] offset:1024
    v_mfma_f32_16x16x32_bf16 v[44:47], v[208:211], a[108:111], v[44:47]
    ds_write_b128 v10, v[28:31] offset:2048
    s_nop 0
    ds_write_b128 v10, v[32:35] offset:3072
    v_mfma_f32_16x16x32_bf16 v[48:51], v[212:215], a[108:111], v[48:51]
    s_waitcnt vmcnt(5)
    v_mfma_f32_16x16x32_bf16 v[36:39], v[216:219], a[116:119], v[36:39]
    v_mfma_f32_16x16x32_bf16 v[40:43], v[220:223], a[116:119], v[40:43]
    v_mfma_f32_16x16x32_bf16 v[44:47], v[224:227], a[116:119], v[44:47]
    v_mfma_f32_16x16x32_bf16 v[48:51], v[72:75], a[116:119], v[48:51]
    s_waitcnt vmcnt(4)
    v_mfma_f32_16x16x32_bf16 v[36:39], v[76:79], a[124:127], v[36:39]
    s_waitcnt lgkmcnt(0)
    s_barrier
    ds_read_b128 v[56:59], v19 offset:0
    ds_read_b128 v[60:63], v19 offset:1024
    v_mfma_f32_16x16x32_bf16 v[40:43], v[80:83], a[124:127], v[40:43]
    ds_read_b128 v[64:67], v19 offset:2048
    ds_read_b128 v[68:71], v19 offset:3072
    v_mfma_f32_16x16x32_bf16 v[44:47], v[84:87], a[124:127], v[44:47]
    v_mfma_f32_16x16x32_bf16 v[48:51], v[88:91], a[124:127], v[48:51]
    s_waitcnt vmcnt(3)
    v_mfma_f32_16x16x32_bf16 v[36:39], v[92:95], a[4:7], v[36:39]
    v_mfma_f32_16x16x32_bf16 v[40:43], v[96:99], a[4:7], v[40:43]
    v_mfma_f32_16x16x32_bf16 v[44:47], v[100:103], a[4:7], v[44:47]
    s_waitcnt lgkmcnt(3)
    v_fmac_f32 v228, v56, v52
    v_fmac_f32 v229, v57, v52
    v_mfma_f32_16x16x32_bf16 v[48:51], v[104:107], a[4:7], v[48:51]
    v_fmac_f32 v230, v58, v52
    v_fmac_f32 v231, v59, v52
    s_waitcnt vmcnt(2)
    v_mfma_f32_16x16x32_bf16 v[36:39], v[108:111], a[12:15], v[36:39]
    s_waitcnt lgkmcnt(2)
    v_fmac_f32 v232, v60, v52
    v_fmac_f32 v233, v61, v52
    v_mfma_f32_16x16x32_bf16 v[40:43], v[112:115], a[12:15], v[40:43]
    v_fmac_f32 v234, v62, v52
    v_fmac_f32 v235, v63, v52
    v_mfma_f32_16x16x32_bf16 v[44:47], v[116:119], a[12:15], v[44:47]
    s_waitcnt lgkmcnt(1)
    v_fmac_f32 v236, v64, v52
    v_fmac_f32 v237, v65, v52
    v_mfma_f32_16x16x32_bf16 v[48:51], v[120:123], a[12:15], v[48:51]
    v_fmac_f32 v238, v66, v52
    v_fmac_f32 v239, v67, v52
    s_waitcnt vmcnt(1)
    v_mfma_f32_16x16x32_bf16 v[36:39], v[124:127], a[20:23], v[36:39]
    s_waitcnt lgkmcnt(0)
    v_fmac_f32 v240, v68, v52
    v_fmac_f32 v241, v69, v52
    v_mfma_f32_16x16x32_bf16 v[40:43], v[128:131], a[20:23], v[40:43]
    v_fmac_f32 v242, v70, v52
    v_fmac_f32 v243, v71, v52
    v_mfma_f32_16x16x32_bf16 v[44:47], v[132:135], a[20:23], v[44:47]
    v_mfma_f32_16x16x32_bf16 v[48:51], v[136:139], a[20:23], v[48:51]
    s_waitcnt vmcnt(0)
    v_mfma_f32_16x16x32_bf16 v[36:39], v[140:143], a[28:31], v[36:39]
    v_mfma_f32_16x16x32_bf16 v[40:43], v[144:147], a[28:31], v[40:43]
    v_mfma_f32_16x16x32_bf16 v[44:47], v[148:151], a[28:31], v[44:47]
    v_mfma_f32_16x16x32_bf16 v[48:51], v[152:155], a[28:31], v[48:51]
    s_nop 4
    v_fmac_f32 v228, v36, v52
    v_fmac_f32 v229, v37, v52
    v_fmac_f32 v230, v38, v52
    v_fmac_f32 v231, v39, v52
    v_cvt_pk_bf16_f32 v72, v228, v229
    v_cvt_pk_bf16_f32 v73, v230, v231
    v_fmac_f32 v232, v40, v52
    v_fmac_f32 v233, v41, v52
    v_fmac_f32 v234, v42, v52
    v_fmac_f32 v235, v43, v52
    v_cvt_pk_bf16_f32 v74, v232, v233
    v_cvt_pk_bf16_f32 v75, v234, v235
    v_fmac_f32 v236, v44, v52
    v_fmac_f32 v237, v45, v52
    v_fmac_f32 v238, v46, v52
    v_fmac_f32 v239, v47, v52
    v_cvt_pk_bf16_f32 v76, v236, v237
    v_cvt_pk_bf16_f32 v77, v238, v239
    v_fmac_f32 v240, v48, v52
    v_fmac_f32 v241, v49, v52
    v_fmac_f32 v242, v50, v52
    v_fmac_f32 v243, v51, v52
    v_cvt_pk_bf16_f32 v78, v240, v241
    v_cvt_pk_bf16_f32 v79, v242, v243
    v_permlane16_swap_b32 v72, v74
    v_permlane16_swap_b32 v73, v75
    v_permlane16_swap_b32 v76, v78
    v_permlane16_swap_b32 v77, v79
    v_mov_b32 v80, v72
    v_mov_b32 v81, v73
    v_mov_b32 v82, v74
    v_mov_b32 v83, v75
    v_mov_b32_dpp v72, v76 row_ror:8 row_mask:0xf bank_mask:0xc
    v_mov_b32_dpp v73, v77 row_ror:8 row_mask:0xf bank_mask:0xc
    v_mov_b32_dpp v74, v78 row_ror:8 row_mask:0xf bank_mask:0xc
    v_mov_b32_dpp v75, v79 row_ror:8 row_mask:0xf bank_mask:0xc
    buffer_store_dwordx4 v[72:75], v6, s[40:43], s17 offen sc1
    v_mov_b32_dpp v76, v80 row_ror:8 row_mask:0xf bank_mask:0x3
    v_mov_b32_dpp v77, v81 row_ror:8 row_mask:0xf bank_mask:0x3
    v_mov_b32_dpp v78, v82 row_ror:8 row_mask:0xf bank_mask:0x3
    v_mov_b32_dpp v79, v83 row_ror:8 row_mask:0xf bank_mask:0x3
    buffer_store_dwordx4 v[76:79], v6, s[40:43], s18 offen sc1
L_fin:
L_end:
    s_endpgm
L_sys_s2:
    s_waitcnt vmcnt(0)
    buffer_wbl2 sc1
    s_waitcnt vmcnt(0)
    s_mov_b64 exec, 1
    buffer_store_dwordx2 v[8:9], v4, s[44:47], 0 offen sc1
    s_branch L_syp_s2
L_sys_s3:
    s_waitcnt vmcnt(0)
    buffer_wbl2 sc1
    s_waitcnt vmcnt(0)
    s_mov_b64 exec, 1
    buffer_store_dwordx2 v[8:9], v4, s[44:47], 0 offen sc1
    s_branch L_syp_s3
L_af0:
    s_waitcnt vmcnt(0)
    buffer_wbl2 sc1
    s_waitcnt vmcnt(0)
    s_mov_b64 exec, 1
    buffer_store_dwordx2 v[246:247], off, s[44:47], s19 offset:3072 sc1
    s_branch L_ag0
L_ca_s:
    s_mov_b32 s50, 0
    s_mov_b64 exec, 0x3fff
L_ca_l:
    buffer_load_dwordx2 v[8:9], v2, s[44:47], s20 offen offset:3072 sc1
    s_add_u32 s50, s50, 1
    s_cmp_gt_u32 s50, 65536
    s_waitcnt vmcnt(0)
    s_cbranch_scc1 L_ca_x
    v_cmp_ne_u64 vcc, s[48:49], v[8:9]
    s_nop 0
    s_cbranch_vccnz L_ca_l
L_ca_x:
    s_mov_b64 exec, -1
    s_branch L_ca
L_spare:
    s_waitcnt vmcnt(0) lgkmcnt(0)
    s_barrier
    s_and_b32 s57, s92, 1
    s_mul_i32 s56, s57, 131072
    s_add_u32 s56, s56, 163840
    buffer_load_dword v250, v249, s[36:39], s56 offen
    s_mov_b64 exec, -1
    buffer_load_dword v250, v249, s[36:39], s56 offen offset:512
    ds_read_b64_tr_b16 a[0:1], v252 offset:0
    ds_read_b64_tr_b16 a[2:3], v252 offset:2048
    ds_read_b64_tr_b16 a[4:5], v253 offset:0
    ds_read_b64_tr_b16 a[6:7], v253 offset:2048
    ds_read_b64_tr_b16 a[8:9], v254 offset:0
    ds_read_b64_tr_b16 a[10:11], v254 offset:2048
    ds_read_b64_tr_b16 a[12:13], v255 offset:0
    ds_read_b64_tr_b16 a[14:15], v255 offset:2048
    ds_read_b64_tr_b16 a[16:17], v252 offset:4096
    ds_read_b64_tr_b16 a[18:19], v252 offset:6144
    ds_read_b64_tr_b16 a[20:21], v253 offset:4096
    ds_read_b64_tr_b16 a[22:23], v253 offset:6144
    ds_read_b64_tr_b16 a[24:25], v254 offset:4096
    ds_read_b64_tr_b16 a[26:27], v254 offset:6144
    ds_read_b64_tr_b16 a[28:29], v255 offset:4096
    ds_read_b64_tr_b16 a[30:31], v255 offset:6144
    ds_read_b64_tr_b16 a[32:33], v252 offset:8192
    ds_read_b64_tr_b16 a[34:35], v252 offset:10240
    ds_read_b64_tr_b16 a[36:37], v253 offset:8192
    ds_read_b64_tr_b16 a[38:39], v253 offset:10240
    ds_read_b64_tr_b16 a[40:41], v254 offset:8192
    ds_read_b64_tr_b16 a[42:43], v254 offset:10240
    ds_read_b64_tr_b16 a[44:45], v255 offset:8192
    ds_read_b64_tr_b16 a[46:47], v255 offset:10240
    ds_read_b64_tr_b16 a[48:49], v252 offset:12288
    ds_read_b64_tr_b16 a[50:51], v252 offset:14336
    ds_read_b64_tr_b16 a[52:53], v253 offset:12288
    ds_read_b64_tr_b16 a[54:55], v253 offset:14336
    ds_read_b64_tr_b16 a[56:57], v254 offset:12288
    ds_read_b64_tr_b16 a[58:59], v254 offset:14336
    ds_read_b64_tr_b16 a[60:61], v255 offset:12288
    ds_read_b64_tr_b16 a[62:63], v255 offset:14336
    s_mul_i32 s56, s57, 131072
    s_add_u32 s56, s56, 425984
    buffer_load_dword v250, v249, s[36:39], s56 offen
    s_mov_b64 exec, -1
    buffer_load_dword v250, v249, s[36:39], s56 offen offset:512
    s_mul_i32 s56, s57, 131072
    s_add_u32 s56, s56, 524288
    s_mov_b32 exec_lo, 0x88888888
    s_mov_b32 exec_hi, 0x88888888
    buffer_load_dword v250, v249, s[36:39], s56 offen
    s_mov_b64 exec, -1
    s_mul_i32 s56, s57, -753664
    s_add_u32 s56, s56, 786432
    s_mov_b32 exec_lo, 0x88888888
    s_mov_b32 exec_hi, 0x88888888
    buffer_load_dword v250, v249, s[36:39], s56 offen
    s_mov_b64 exec, -1
    s_waitcnt lgkmcnt(0)
    s_barrier
    s_mul_i32 s55, s94, 131072
    s_add_u32 m0, s58, 65536
    s_add_u32 s55, s55, 524288
    buffer_load_dwordx4 v244, s[36:39], s55 offen lds
    s_addk_i32 m0, 0x400
    s_addk_i32 s55, 0x2000
    buffer_load_dwordx4 v244, s[36:39], s55 offen lds
    s_addk_i32 m0, 0x400
    s_addk_i32 s55, 0x2000
    buffer_load_dwordx4 v244, s[36:39], s55 offen lds
    s_addk_i32 m0, 0x400
    s_addk_i32 s55, 0x2000
    buffer_load_dwordx4 v244, s[36:39], s55 offen lds
    s_addk_i32 m0, 0x400
    s_add_u32 s55, s55, 40960
    buffer_load_dwordx4 v244, s[36:39], s55 offen lds
    s_addk_i32 m0, 0x400
    s_addk_i32 s55, 0x2000
    buffer_load_dwordx4 v244, s[36:39], s55 offen lds
    s_addk_i32 m0, 0x400
    s_addk_i32 s55, 0x2000
    buffer_load_dwordx4 v244, s[36:39], s55 offen lds
    s_addk_i32 m0, 0x400
    s_addk_i32 s55, 0x2000
    buffer_load_dwordx4 v244, s[36:39], s55 offen lds
    s_mul_i32 s56, s57, 131072
    s_add_u32 s56, s56, 688128
    buffer_load_dword v250, v249, s[36:39], s56 offen
    s_mov_b64 exec, -1
    buffer_load_dword v250, v249, s[36:39], s56 offen offset:512
    s_mul_i32 s55, s94, -753664
    s_add_u32 m0, s58, 98304
    s_add_u32 s55, s55, 786432
    buffer_load_dwordx4 v244, s[36:39], s55 offen lds
    s_addk_i32 m0, 0x400
    s_addk_i32 s55, 0x2000
    buffer_load_dwordx4 v244, s[36:39], s55 offen lds
    s_addk_i32 m0, 0x400
    s_addk_i32 s55, 0x2000
    buffer_load_dwordx4 v244, s[36:39], s55 offen lds
    s_addk_i32 m0, 0x400
    s_addk_i32 s55, 0x2000
    buffer_load_dwordx4 v244, s[36:39], s55 offen lds
    s_addk_i32 m0, 0x400
    s_add_u32 s55, s55, 40960
    buffer_load_dwordx4 v244, s[36:39], s55 offen lds
    s_addk_i32 m0, 0x400
    s_addk_i32 s55, 0x2000
    buffer_load_dwordx4 v244, s[36:39], s55 offen lds
    s_addk_i32 m0, 0x400
    s_addk_i32 s55, 0x2000
    buffer_load_dwordx4 v244, s[36:39], s55 offen lds
    s_addk_i32 m0, 0x400
    s_addk_i32 s55, 0x2000
    buffer_load_dwordx4 v244, s[36:39], s55 offen lds
    s_mul_i32 s55, s94, 131072
    s_add_u32 m0, s58, 0
    s_add_u32 s55, s55, 163840
    buffer_load_dwordx4 v244, s[36:39], s55 offen lds
    s_addk_i32 m0, 0x400
    s_addk_i32 s55, 0x2000
    buffer_load_dwordx4 v244, s[36:39], s55 offen lds
    s_addk_i32 m0, 0x400
    s_addk_i32 s55, 0x2000
    buffer_load_dwordx4 v244, s[36:39], s55 offen lds
    s_addk_i32 m0, 0x400
    s_addk_i32 s55, 0x2000
    buffer_load_dwordx4 v244, s[36:39], s55 offen lds
    s_addk_i32 m0, 0x400
    s_add_u32 s55, s55, 40960
    buffer_load_dwordx4 v244, s[36:39], s55 offen lds
    s_addk_i32 m0, 0x400
    s_addk_i32 s55, 0x2000
    buffer_load_dwordx4 v244, s[36:39], s55 offen lds
    s_addk_i32 m0, 0x400
    s_addk_i32 s55, 0x2000
    buffer_load_dwordx4 v244, s[36:39], s55 offen lds
    s_addk_i32 m0, 0x400
    s_addk_i32 s55, 0x2000
    buffer_load_dwordx4 v244, s[36:39], s55 offen lds
    s_mul_i32 s55, s94, 131072
    s_add_u32 m0, s58, 131072
    s_add_u32 s55, s55, 425984
    buffer_load_dwordx4 v244, s[36:39], s55 offen lds
    s_addk_i32 m0, 0x400
    s_addk_i32 s55, 0x2000
    buffer_load_dwordx4 v244, s[36:39], s55 offen lds
    s_addk_i32 m0, 0x400
    s_addk_i32 s55, 0x2000
    buffer_load_dwordx4 v244, s[36:39], s55 offen lds
    s_addk_i32 m0, 0x400
    s_addk_i32 s55, 0x2000
    buffer_load_dwordx4 v244, s[36:39], s55 offen lds
    s_addk_i32 m0, 0x400
    s_add_u32 s55, s55, 40960
    buffer_load_dwordx4 v244, s[36:39], s55 offen lds
    s_addk_i32 m0, 0x400
    s_addk_i32 s55, 0x2000
    buffer_load_dwordx4 v244, s[36:39], s55 offen lds
    s_addk_i32 m0, 0x400
    s_addk_i32 s55, 0x2000
    buffer_load_dwordx4 v244, s[36:39], s55 offen lds
    s_addk_i32 m0, 0x400
    s_addk_i32 s55, 0x2000
    buffer_load_dwordx4 v244, s[36:39], s55 offen lds
    s_mul_i32 s55, s94, 131072
    s_add_u32 m0, s58, 32768
    s_add_u32 s55, s55, 688128
    buffer_load_dwordx4 v244, s[36:39], s55 offen lds
    s_addk_i32 m0, 0x400
    s_addk_i32 s55, 0x2000
    buffer_load_dwordx4 v244, s[36:39], s55 offen lds
    s_addk_i32 m0, 0x400
    s_addk_i32 s55, 0x2000
    buffer_load_dwordx4 v244, s[36:39], s55 offen lds
    s_addk_i32 m0, 0x400
    s_addk_i32 s55, 0x2000
    buffer_load_dwordx4 v244, s[36:39], s55 offen lds
    s_addk_i32 m0, 0x400
    s_add_u32 s55, s55, 40960
    buffer_load_dwordx4 v244, s[36:39], s55 offen lds
    s_addk_i32 m0, 0x400
    s_addk_i32 s55, 0x2000
    buffer_load_dwordx4 v244, s[36:39], s55 offen lds
    s_addk_i32 m0, 0x400
    s_addk_i32 s55, 0x2000
    buffer_load_dwordx4 v244, s[36:39], s55 offen lds
    s_mov_b32 s50, 0
    s_mov_b64 exec, 0x3fff
L_sp_l:
    buffer_load_dwordx2 v[8:9], v2, s[44:47], s20 offen offset:3072 sc1
    s_add_u32 s50, s50, 1
    s_cmp_gt_u32 s50, 65536
    s_waitcnt vmcnt(0)
    s_cbranch_scc1 L_sp_x
    v_cmp_ne_u64 vcc, s[48:49], v[8:9]
    s_nop 0
    s_cbranch_vccnz L_sp_l
L_sp_x:
    s_mov_b64 exec, -1
    s_barrier
    buffer_load_dwordx4 a[128:131], v1, s[44:47], s15 offen offset:0 sc1
    buffer_load_dwordx4 a[132:135], v1, s[44:47], s14 offen offset:0 sc1
    buffer_load_dwordx4 a[136:139], v1, s[44:47], s15 offen offset:1024 sc1
    buffer_load_dwordx4 a[140:143], v1, s[44:47], s14 offen offset:1024 sc1
    buffer_load_dwordx4 a[144:147], v1, s[44:47], s15 offen offset:2048 sc1
    buffer_load_dwordx4 a[148:151], v1, s[44:47], s14 offen offset:2048 sc1
    buffer_load_dwordx4 a[152:155], v1, s[44:47], s15 offen offset:3072 sc1
    s_addk_i32 s15, 0x1000
    buffer_load_dwordx4 a[156:159], v1, s[44:47], s14 offen offset:3072 sc1
    s_addk_i32 s14, 0x1000
    buffer_load_dwordx4 a[160:163], v1, s[44:47], s15 offen offset:0 sc1
    buffer_load_dwordx4 a[164:167], v1, s[44:47], s14 offen offset:0 sc1
    buffer_load_dwordx4 a[168:171], v1, s[44:47], s15 offen offset:1024 sc1
    buffer_load_dwordx4 a[172:175], v1, s[44:47], s14 offen offset:1024 sc1
    buffer_load_dwordx4 a[176:179], v1, s[44:47], s15 offen offset:2048 sc1
    buffer_load_dwordx4 a[180:183], v1, s[44:47], s14 offen offset:2048 sc1
    s_waitcnt vmcnt(0)
    s_branch L_p4e
L_af1:
    s_waitcnt vmcnt(0)
    buffer_wbl2 sc1
    s_waitcnt vmcnt(0)
    s_mov_b64 exec, 1
    buffer_store_dwordx2 v[246:247], off, s[44:47], s19 offset:0 sc1
    s_branch L_ag1
L_cb_s:
    s_mov_b32 s50, 0
    s_mov_b64 exec, 0x3fff
L_cb_l:
    buffer_load_dwordx2 v[8:9], v2, s[44:47], s20 offen offset:0 sc1
    s_add_u32 s50, s50, 1
    s_cmp_gt_u32 s50, 65536
    s_waitcnt vmcnt(0)
    s_cbranch_scc1 L_cb_x
    v_cmp_ne_u64 vcc, s[48:49], v[8:9]
    s_nop 0
    s_cbranch_vccnz L_cb_l
L_cb_x:
    s_mov_b64 exec, -1
    s_branch L_cb
L_cend:
L_kv:
    s_cmp_gt_u32 s50, 65536
    s_cbranch_scc1 L_kd
    s_mov_b64 exec, 15
    buffer_load_dwordx4 v[32:35], v1, s[44:47], s101 offen sc1
    s_waitcnt vmcnt(0)
    s_mov_b64 exec, -1
    v_readlane_b32 s8, v32, 0
    v_readlane_b32 s9, v33, 0
    v_readlane_b32 s10, v34, 0
    v_readlane_b32 s11, v35, 0
    v_readlane_b32 s12, v32, 1
    v_readlane_b32 s13, v33, 1
    v_readlane_b32 s14, v34, 1
    v_readlane_b32 s15, v35, 1
    v_readlane_b32 s16, v32, 2
    v_readlane_b32 s17, v33, 2
    v_readlane_b32 s18, v34, 2
    v_readlane_b32 s19, v35, 2
    v_readlane_b32 s20, v32, 3
    v_readlane_b32 s21, v33, 3
    v_readlane_b32 s22, v34, 3
    v_readlane_b32 s23, v35, 3
    s_nop 4
    s_branch L_kc
L_fb:
    v_mfma_f32_32x32x16_bf16 v[48:63], v[240:243], v[112:115], v[128:143]
    s_nop 11
    v_max_f32 v14, v48, v49
    v_max3_f32 v14, v50, v51, v14
    v_max3_f32 v14, v52, v53, v14
    v_max3_f32 v14, v54, v55, v14
    v_max3_f32 v14, v56, v57, v14
    v_max3_f32 v14, v58, v59, v14
    v_max3_f32 v14, v60, v61, v14
    v_max3_f32 v14, v62, v63, v14
    s_cmp_lt_u32 s54, 1
    s_cbranch_scc1 L_fb00
    v_mfma_f32_32x32x16_bf16 v[48:63], a[136:139], v[112:115], 0
    s_nop 11
    v_max3_f32 v14, v48, v49, v14
    v_max3_f32 v14, v50, v51, v14
    v_max3_f32 v14, v52, v53, v14
    v_max3_f32 v14, v54, v55, v14
    v_max3_f32 v14, v56, v57, v14
    v_max3_f32 v14, v58, v59, v14
    v_max3_f32 v14, v60, v61, v14
    v_max3_f32 v14, v62, v63, v14
    v_mfma_f32_32x32x16_bf16 v[48:63], a[140:143], v[112:115], 0
    s_nop 11
    v_max3_f32 v14, v48, v49, v14
    v_max3_f32 v14, v50, v51, v14
    v_max3_f32 v14, v52, v53, v14
    v_max3_f32 v14, v54, v55, v14
    v_max3_f32 v14, v56, v57, v14
    v_max3_f32 v14, v58, v59, v14
    v_max3_f32 v14, v60, v61, v14
    v_max3_f32 v14, v62, v63, v14
    s_cmp_lt_u32 s54, 2
    s_cbranch_scc1 L_fb00
    v_mfma_f32_32x32x16_bf16 v[48:63], a[144:147], v[112:115], 0
    s_nop 11
    v_max3_f32 v14, v48, v49, v14
    v_max3_f32 v14, v50, v51, v14
    v_max3_f32 v14, v52, v53, v14
    v_max3_f32 v14, v54, v55, v14
    v_max3_f32 v14, v56, v57, v14
    v_max3_f32 v14, v58, v59, v14
    v_max3_f32 v14, v60, v61, v14
    v_max3_f32 v14, v62, v63, v14
    v_mfma_f32_32x32x16_bf16 v[48:63], a[148:151], v[112:115], 0
    s_nop 11
    v_max3_f32 v14, v48, v49, v14
    v_max3_f32 v14, v50, v51, v14
    v_max3_f32 v14, v52, v53, v14
    v_max3_f32 v14, v54, v55, v14
    v_max3_f32 v14, v56, v57, v14
    v_max3_f32 v14, v58, v59, v14
    v_max3_f32 v14, v60, v61, v14
    v_max3_f32 v14, v62, v63, v14
    s_cmp_lt_u32 s54, 3
    s_cbranch_scc1 L_fb00
    v_mfma_f32_32x32x16_bf16 v[48:63], a[152:155], v[112:115], 0
    s_nop 11
    v_max3_f32 v14, v48, v49, v14
    v_max3_f32 v14, v50, v51, v14
    v_max3_f32 v14, v52, v53, v14
    v_max3_f32 v14, v54, v55, v14
    v_max3_f32 v14, v56, v57, v14
    v_max3_f32 v14, v58, v59, v14
    v_max3_f32 v14, v60, v61, v14
    v_max3_f32 v14, v62, v63, v14
    v_mfma_f32_32x32x16_bf16 v[48:63], a[156:159], v[112:115], 0
    s_nop 11
    v_max3_f32 v14, v48, v49, v14
    v_max3_f32 v14, v50, v51, v14
    v_max3_f32 v14, v52, v53, v14
    v_max3_f32 v14, v54, v55, v14
    v_max3_f32 v14, v56, v57, v14
    v_max3_f32 v14, v58, v59, v14
    v_max3_f32 v14, v60, v61, v14
    v_max3_f32 v14, v62, v63, v14
    s_cmp_lt_u32 s54, 4
    s_cbranch_scc1 L_fb00
    v_mfma_f32_32x32x16_bf16 v[48:63], a[160:163], v[112:115], 0
    s_nop 11
    v_max3_f32 v14, v48, v49, v14
    v_max3_f32 v14, v50, v51, v14
    v_max3_f32 v14, v52, v53, v14
    v_max3_f32 v14, v54, v55, v14
    v_max3_f32 v14, v56, v57, v14
    v_max3_f32 v14, v58, v59, v14
    v_max3_f32 v14, v60, v61, v14
    v_max3_f32 v14, v62, v63, v14
    v_mfma_f32_32x32x16_bf16 v[48:63], a[164:167], v[112:115], v[144:159]
    s_nop 11
    v_max3_f32 v14, v48, v49, v14
    v_max3_f32 v14, v50, v51, v14
    v_max3_f32 v14, v52, v53, v14
    v_max3_f32 v14, v54, v55, v14
    v_max3_f32 v14, v56, v57, v14
    v_max3_f32 v14, v58, v59, v14
    v_max3_f32 v14, v60, v61, v14
    v_max3_f32 v14, v62, v63, v14
L_fb00:
    v_mov_b32 v15, v14
    s_nop 1
    v_permlane32_swap_b32 v15, v14
    v_max_f32 v14, v15, v14
    v_sub_f32 v64, v128, v14
    v_sub_f32 v65, v129, v14
    v_sub_f32 v66, v130, v14
    v_sub_f32 v67, v131, v14
    v_sub_f32 v68, v132, v14
    v_sub_f32 v69, v133, v14
    v_sub_f32 v70, v134, v14
    v_sub_f32 v71, v135, v14
    v_sub_f32 v72, v136, v14
    v_sub_f32 v73, v137, v14
    v_sub_f32 v74, v138, v14
    v_sub_f32 v75, v139, v14
    v_sub_f32 v76, v140, v14
    v_sub_f32 v77, v141, v14
    v_sub_f32 v78, v142, v14
    v_sub_f32 v79, v143, v14
    s_nop 1
    v_mfma_f32_32x32x16_bf16 v[48:63], v[240:243], v[112:115], v[64:79]
    s_nop 11
    v_exp_f32 v48, v48
    v_exp_f32 v49, v49
    v_exp_f32 v50, v50
    v_exp_f32 v51, v51
    v_cvt_pk_bf16_f32 v32, v48, v49
    v_exp_f32 v52, v52
    v_exp_f32 v53, v53
    v_cvt_pk_bf16_f32 v33, v50, v51
    v_exp_f32 v54, v54
    v_exp_f32 v55, v55
    v_cvt_pk_bf16_f32 v34, v52, v53
    v_exp_f32 v56, v56
    v_exp_f32 v57, v57
    v_cvt_pk_bf16_f32 v35, v54, v55
    v_exp_f32 v58, v58
    v_exp_f32 v59, v59
    v_cvt_pk_bf16_f32 v36, v56, v57
    v_exp_f32 v60, v60
    v_exp_f32 v61, v61
    v_cvt_pk_bf16_f32 v37, v58, v59
    v_exp_f32 v62, v62
    v_exp_f32 v63, v63
    v_cvt_pk_bf16_f32 v38, v60, v61
    v_cvt_pk_bf16_f32 v39, v62, v63
    v_mfma_f32_32x32x16_bf16 v[80:95], v[168:171], v[32:35], 0
    s_nop 0
    v_mfma_f32_32x32x16_bf16 v[80:95], v[172:175], v[36:39], v[80:95]
    s_cmp_lt_u32 s54, 1
    s_cbranch_scc1 L_fb01
    v_sub_f32 v64, 0, v14
    v_sub_f32 v65, 0, v14
    v_sub_f32 v66, 0, v14
    v_sub_f32 v67, 0, v14
    v_sub_f32 v68, 0, v14
    v_sub_f32 v69, 0, v14
    v_sub_f32 v70, 0, v14
    v_sub_f32 v71, 0, v14
    v_sub_f32 v72, 0, v14
    v_sub_f32 v73, 0, v14
    v_sub_f32 v74, 0, v14
    v_sub_f32 v75, 0, v14
    v_sub_f32 v76, 0, v14
    v_sub_f32 v77, 0, v14
    v_sub_f32 v78, 0, v14
    v_sub_f32 v79, 0, v14
    s_nop 1
    v_mfma_f32_32x32x16_bf16 v[48:63], a[136:139], v[112:115], v[64:79]
    s_nop 11
    v_exp_f32 v48, v48
    v_exp_f32 v49, v49
    v_exp_f32 v50, v50
    v_exp_f32 v51, v51
    v_cvt_pk_bf16_f32 v32, v48, v49
    v_exp_f32 v52, v52
    v_exp_f32 v53, v53
    v_cvt_pk_bf16_f32 v33, v50, v51
    v_exp_f32 v54, v54
    v_exp_f32 v55, v55
    v_cvt_pk_bf16_f32 v34, v52, v53
    v_exp_f32 v56, v56
    v_exp_f32 v57, v57
    v_cvt_pk_bf16_f32 v35, v54, v55
    v_exp_f32 v58, v58
    v_exp_f32 v59, v59
    v_cvt_pk_bf16_f32 v36, v56, v57
    v_exp_f32 v60, v60
    v_exp_f32 v61, v61
    v_cvt_pk_bf16_f32 v37, v58, v59
    v_exp_f32 v62, v62
    v_exp_f32 v63, v63
    v_cvt_pk_bf16_f32 v38, v60, v61
    v_cvt_pk_bf16_f32 v39, v62, v63
    v_mfma_f32_32x32x16_bf16 v[80:95], v[176:179], v[32:35], v[80:95]
    s_nop 0
    v_mfma_f32_32x32x16_bf16 v[80:95], v[180:183], v[36:39], v[80:95]
    v_sub_f32 v64, 0, v14
    v_sub_f32 v65, 0, v14
    v_sub_f32 v66, 0, v14
    v_sub_f32 v67, 0, v14
    v_sub_f32 v68, 0, v14
    v_sub_f32 v69, 0, v14
    v_sub_f32 v70, 0, v14
    v_sub_f32 v71, 0, v14
    v_sub_f32 v72, 0, v14
    v_sub_f32 v73, 0, v14
    v_sub_f32 v74, 0, v14
    v_sub_f32 v75, 0, v14
    v_sub_f32 v76, 0, v14
    v_sub_f32 v77, 0, v14
    v_sub_f32 v78, 0, v14
    v_sub_f32 v79, 0, v14
    s_nop 1
    v_mfma_f32_32x32x16_bf16 v[48:63], a[140:143], v[112:115], v[64:79]
    s_nop 11
    v_exp_f32 v48, v48
    v_exp_f32 v49, v49
    v_exp_f32 v50, v50
    v_exp_f32 v51, v51
    v_cvt_pk_bf16_f32 v32, v48, v49
    v_exp_f32 v52, v52
    v_exp_f32 v53, v53
    v_cvt_pk_bf16_f32 v33, v50, v51
    v_exp_f32 v54, v54
    v_exp_f32 v55, v55
    v_cvt_pk_bf16_f32 v34, v52, v53
    v_exp_f32 v56, v56
    v_exp_f32 v57, v57
    v_cvt_pk_bf16_f32 v35, v54, v55
    v_exp_f32 v58, v58
    v_exp_f32 v59, v59
    v_cvt_pk_bf16_f32 v36, v56, v57
    v_exp_f32 v60, v60
    v_exp_f32 v61, v61
    v_cvt_pk_bf16_f32 v37, v58, v59
    v_exp_f32 v62, v62
    v_exp_f32 v63, v63
    v_cvt_pk_bf16_f32 v38, v60, v61
    v_cvt_pk_bf16_f32 v39, v62, v63
    v_mfma_f32_32x32x16_bf16 v[80:95], v[184:187], v[32:35], v[80:95]
    s_nop 0
    v_mfma_f32_32x32x16_bf16 v[80:95], v[188:191], v[36:39], v[80:95]
    s_cmp_lt_u32 s54, 2
    s_cbranch_scc1 L_fb01
    v_sub_f32 v64, 0, v14
    v_sub_f32 v65, 0, v14
    v_sub_f32 v66, 0, v14
    v_sub_f32 v67, 0, v14
    v_sub_f32 v68, 0, v14
    v_sub_f32 v69, 0, v14
    v_sub_f32 v70, 0, v14
    v_sub_f32 v71, 0, v14
    v_sub_f32 v72, 0, v14
    v_sub_f32 v73, 0, v14
    v_sub_f32 v74, 0, v14
    v_sub_f32 v75, 0, v14
    v_sub_f32 v76, 0, v14
    v_sub_f32 v77, 0, v14
    v_sub_f32 v78, 0, v14
    v_sub_f32 v79, 0, v14
    s_nop 1
    v_mfma_f32_32x32x16_bf16 v[48:63], a[144:147], v[112:115], v[64:79]
    s_nop 11
    v_exp_f32 v48, v48
    v_exp_f32 v49, v49
    v_exp_f32 v50, v50
    v_exp_f32 v51, v51
    v_cvt_pk_bf16_f32 v32, v48, v49
    v_exp_f32 v52, v52
    v_exp_f32 v53, v53
    v_cvt_pk_bf16_f32 v33, v50, v51
    v_exp_f32 v54, v54
    v_exp_f32 v55, v55
    v_cvt_pk_bf16_f32 v34, v52, v53
    v_exp_f32 v56, v56
    v_exp_f32 v57, v57
    v_cvt_pk_bf16_f32 v35, v54, v55
    v_exp_f32 v58, v58
    v_exp_f32 v59, v59
    v_cvt_pk_bf16_f32 v36, v56, v57
    v_exp_f32 v60, v60
    v_exp_f32 v61, v61
    v_cvt_pk_bf16_f32 v37, v58, v59
    v_exp_f32 v62, v62
    v_exp_f32 v63, v63
    v_cvt_pk_bf16_f32 v38, v60, v61
    v_cvt_pk_bf16_f32 v39, v62, v63
    v_mfma_f32_32x32x16_bf16 v[80:95], v[192:195], v[32:35], v[80:95]
    s_nop 0
    v_mfma_f32_32x32x16_bf16 v[80:95], v[196:199], v[36:39], v[80:95]
    v_sub_f32 v64, 0, v14
    v_sub_f32 v65, 0, v14
    v_sub_f32 v66, 0, v14
    v_sub_f32 v67, 0, v14
    v_sub_f32 v68, 0, v14
    v_sub_f32 v69, 0, v14
    v_sub_f32 v70, 0, v14
    v_sub_f32 v71, 0, v14
    v_sub_f32 v72, 0, v14
    v_sub_f32 v73, 0, v14
    v_sub_f32 v74, 0, v14
    v_sub_f32 v75, 0, v14
    v_sub_f32 v76, 0, v14
    v_sub_f32 v77, 0, v14
    v_sub_f32 v78, 0, v14
    v_sub_f32 v79, 0, v14
    s_nop 1
    v_mfma_f32_32x32x16_bf16 v[48:63], a[148:151], v[112:115], v[64:79]
    s_nop 11
    v_exp_f32 v48, v48
    v_exp_f32 v49, v49
    v_exp_f32 v50, v50
    v_exp_f32 v51, v51
    v_cvt_pk_bf16_f32 v32, v48, v49
    v_exp_f32 v52, v52
    v_exp_f32 v53, v53
    v_cvt_pk_bf16_f32 v33, v50, v51
    v_exp_f32 v54, v54
    v_exp_f32 v55, v55
    v_cvt_pk_bf16_f32 v34, v52, v53
    v_exp_f32 v56, v56
    v_exp_f32 v57, v57
    v_cvt_pk_bf16_f32 v35, v54, v55
    v_exp_f32 v58, v58
    v_exp_f32 v59, v59
    v_cvt_pk_bf16_f32 v36, v56, v57
    v_exp_f32 v60, v60
    v_exp_f32 v61, v61
    v_cvt_pk_bf16_f32 v37, v58, v59
    v_exp_f32 v62, v62
    v_exp_f32 v63, v63
    v_cvt_pk_bf16_f32 v38, v60, v61
    v_cvt_pk_bf16_f32 v39, v62, v63
    v_mfma_f32_32x32x16_bf16 v[80:95], v[200:203], v[32:35], v[80:95]
    s_nop 0
    v_mfma_f32_32x32x16_bf16 v[80:95], v[204:207], v[36:39], v[80:95]
    s_cmp_lt_u32 s54, 3
    s_cbranch_scc1 L_fb01
    v_sub_f32 v64, 0, v14
    v_sub_f32 v65, 0, v14
    v_sub_f32 v66, 0, v14
    v_sub_f32 v67, 0, v14
    v_sub_f32 v68, 0, v14
    v_sub_f32 v69, 0, v14
    v_sub_f32 v70, 0, v14
    v_sub_f32 v71, 0, v14
    v_sub_f32 v72, 0, v14
    v_sub_f32 v73, 0, v14
    v_sub_f32 v74, 0, v14
    v_sub_f32 v75, 0, v14
    v_sub_f32 v76, 0, v14
    v_sub_f32 v77, 0, v14
    v_sub_f32 v78, 0, v14
    v_sub_f32 v79, 0, v14
    s_nop 1
    v_mfma_f32_32x32x16_bf16 v[48:63], a[152:155], v[112:115], v[64:79]
    s_nop 11
    v_exp_f32 v48, v48
    v_exp_f32 v49, v49
    v_exp_f32 v50, v50
    v_exp_f32 v51, v51
    v_cvt_pk_bf16_f32 v32, v48, v49
    v_exp_f32 v52, v52
    v_exp_f32 v53, v53
    v_cvt_pk_bf16_f32 v33, v50, v51
    v_exp_f32 v54, v54
    v_exp_f32 v55, v55
    v_cvt_pk_bf16_f32 v34, v52, v53
    v_exp_f32 v56, v56
    v_exp_f32 v57, v57
    v_cvt_pk_bf16_f32 v35, v54, v55
    v_exp_f32 v58, v58
    v_exp_f32 v59, v59
    v_cvt_pk_bf16_f32 v36, v56, v57
    v_exp_f32 v60, v60
    v_exp_f32 v61, v61
    v_cvt_pk_bf16_f32 v37, v58, v59
    v_exp_f32 v62, v62
    v_exp_f32 v63, v63
    v_cvt_pk_bf16_f32 v38, v60, v61
    v_cvt_pk_bf16_f32 v39, v62, v63
    v_mfma_f32_32x32x16_bf16 v[80:95], v[208:211], v[32:35], v[80:95]
    s_nop 0
    v_mfma_f32_32x32x16_bf16 v[80:95], v[212:215], v[36:39], v[80:95]
    v_sub_f32 v64, 0, v14
    v_sub_f32 v65, 0, v14
    v_sub_f32 v66, 0, v14
    v_sub_f32 v67, 0, v14
    v_sub_f32 v68, 0, v14
    v_sub_f32 v69, 0, v14
    v_sub_f32 v70, 0, v14
    v_sub_f32 v71, 0, v14
    v_sub_f32 v72, 0, v14
    v_sub_f32 v73, 0, v14
    v_sub_f32 v74, 0, v14
    v_sub_f32 v75, 0, v14
    v_sub_f32 v76, 0, v14
    v_sub_f32 v77, 0, v14
    v_sub_f32 v78, 0, v14
    v_sub_f32 v79, 0, v14
    s_nop 1
    v_mfma_f32_32x32x16_bf16 v[48:63], a[156:159], v[112:115], v[64:79]
    s_nop 11
    v_exp_f32 v48, v48
    v_exp_f32 v49, v49
    v_exp_f32 v50, v50
    v_exp_f32 v51, v51
    v_cvt_pk_bf16_f32 v32, v48, v49
    v_exp_f32 v52, v52
    v_exp_f32 v53, v53
    v_cvt_pk_bf16_f32 v33, v50, v51
    v_exp_f32 v54, v54
    v_exp_f32 v55, v55
    v_cvt_pk_bf16_f32 v34, v52, v53
    v_exp_f32 v56, v56
    v_exp_f32 v57, v57
    v_cvt_pk_bf16_f32 v35, v54, v55
    v_exp_f32 v58, v58
    v_exp_f32 v59, v59
    v_cvt_pk_bf16_f32 v36, v56, v57
    v_exp_f32 v60, v60
    v_exp_f32 v61, v61
    v_cvt_pk_bf16_f32 v37, v58, v59
    v_exp_f32 v62, v62
    v_exp_f32 v63, v63
    v_cvt_pk_bf16_f32 v38, v60, v61
    v_cvt_pk_bf16_f32 v39, v62, v63
    v_mfma_f32_32x32x16_bf16 v[80:95], v[216:219], v[32:35], v[80:95]
    s_nop 0
    v_mfma_f32_32x32x16_bf16 v[80:95], v[220:223], v[36:39], v[80:95]
    s_cmp_lt_u32 s54, 4
    s_cbranch_scc1 L_fb01
    v_sub_f32 v64, 0, v14
    v_sub_f32 v65, 0, v14
    v_sub_f32 v66, 0, v14
    v_sub_f32 v67, 0, v14
    v_sub_f32 v68, 0, v14
    v_sub_f32 v69, 0, v14
    v_sub_f32 v70, 0, v14
    v_sub_f32 v71, 0, v14
    v_sub_f32 v72, 0, v14
    v_sub_f32 v73, 0, v14
    v_sub_f32 v74, 0, v14
    v_sub_f32 v75, 0, v14
    v_sub_f32 v76, 0, v14
    v_sub_f32 v77, 0, v14
    v_sub_f32 v78, 0, v14
    v_sub_f32 v79, 0, v14
    s_nop 1
    v_mfma_f32_32x32x16_bf16 v[48:63], a[160:163], v[112:115], v[64:79]
    s_nop 11
    v_exp_f32 v48, v48
    v_exp_f32 v49, v49
    v_exp_f32 v50, v50
    v_exp_f32 v51, v51
    v_cvt_pk_bf16_f32 v32, v48, v49
    v_exp_f32 v52, v52
    v_exp_f32 v53, v53
    v_cvt_pk_bf16_f32 v33, v50, v51
    v_exp_f32 v54, v54
    v_exp_f32 v55, v55
    v_cvt_pk_bf16_f32 v34, v52, v53
    v_exp_f32 v56, v56
    v_exp_f32 v57, v57
    v_cvt_pk_bf16_f32 v35, v54, v55
    v_exp_f32 v58, v58
    v_exp_f32 v59, v59
    v_cvt_pk_bf16_f32 v36, v56, v57
    v_exp_f32 v60, v60
    v_exp_f32 v61, v61
    v_cvt_pk_bf16_f32 v37, v58, v59
    v_exp_f32 v62, v62
    v_exp_f32 v63, v63
    v_cvt_pk_bf16_f32 v38, v60, v61
    v_cvt_pk_bf16_f32 v39, v62, v63
    v_mfma_f32_32x32x16_bf16 v[80:95], v[224:227], v[32:35], v[80:95]
    s_nop 0
    v_mfma_f32_32x32x16_bf16 v[80:95], v[228:231], v[36:39], v[80:95]
    v_sub_f32 v64, v144, v14
    v_sub_f32 v65, v145, v14
    v_sub_f32 v66, v146, v14
    v_sub_f32 v67, v147, v14
    v_sub_f32 v68, v148, v14
    v_sub_f32 v69, v149, v14
    v_sub_f32 v70, v150, v14
    v_sub_f32 v71, v151, v14
    v_sub_f32 v72, v152, v14
    v_sub_f32 v73, v153, v14
    v_sub_f32 v74, v154, v14
    v_sub_f32 v75, v155, v14
    v_sub_f32 v76, v156, v14
    v_sub_f32 v77, v157, v14
    v_sub_f32 v78, v158, v14
    v_sub_f32 v79, v159, v14
    s_nop 1
    v_mfma_f32_32x32x16_bf16 v[48:63], a[164:167], v[112:115], v[64:79]
    s_nop 11
    v_exp_f32 v48, v48
    v_exp_f32 v49, v49
    v_exp_f32 v50, v50
    v_exp_f32 v51, v51
    v_cvt_pk_bf16_f32 v32, v48, v49
    v_exp_f32 v52, v52
    v_exp_f32 v53, v53
    v_cvt_pk_bf16_f32 v33, v50, v51
    v_exp_f32 v54, v54
    v_exp_f32 v55, v55
    v_cvt_pk_bf16_f32 v34, v52, v53
    v_exp_f32 v56, v56
    v_exp_f32 v57, v57
    v_cvt_pk_bf16_f32 v35, v54, v55
    v_exp_f32 v58, v58
    v_exp_f32 v59, v59
    v_cvt_pk_bf16_f32 v36, v56, v57
    v_exp_f32 v60, v60
    v_exp_f32 v61, v61
    v_cvt_pk_bf16_f32 v37, v58, v59
    v_exp_f32 v62, v62
    v_exp_f32 v63, v63
    v_cvt_pk_bf16_f32 v38, v60, v61
    v_cvt_pk_bf16_f32 v39, v62, v63
    v_mfma_f32_32x32x16_bf16 v[80:95], v[232:235], v[32:35], v[80:95]
    s_nop 0
    v_mfma_f32_32x32x16_bf16 v[80:95], v[236:239], v[36:39], v[80:95]
L_fb01:
    v_mfma_f32_32x32x16_bf16 v[48:63], v[244:247], v[116:119], v[128:143]
    s_nop 11
    v_max_f32 v14, v48, v49
    v_max3_f32 v14, v50, v51, v14
    v_max3_f32 v14, v52, v53, v14
    v_max3_f32 v14, v54, v55, v14
    v_max3_f32 v14, v56, v57, v14
    v_max3_f32 v14, v58, v59, v14
    v_max3_f32 v14, v60, v61, v14
    v_max3_f32 v14, v62, v63, v14
    v_mfma_f32_32x32x16_bf16 v[48:63], v[240:243], v[116:119], 0
    s_nop 11
    v_max3_f32 v14, v48, v49, v14
    v_max3_f32 v14, v50, v51, v14
    v_max3_f32 v14, v52, v53, v14
    v_max3_f32 v14, v54, v55, v14
    v_max3_f32 v14, v56, v57, v14
    v_max3_f32 v14, v58, v59, v14
    v_max3_f32 v14, v60, v61, v14
    v_max3_f32 v14, v62, v63, v14
    s_cmp_lt_u32 s54, 1
    s_cbranch_scc1 L_fb10
    v_mfma_f32_32x32x16_bf16 v[48:63], a[136:139], v[116:119], 0
    s_nop 11
    v_max3_f32 v14, v48, v49, v14
    v_max3_f32 v14, v50, v51, v14
    v_max3_f32 v14, v52, v53, v14
    v_max3_f32 v14, v54, v55, v14
    v_max3_f32 v14, v56, v57, v14
    v_max3_f32 v14, v58, v59, v14
    v_max3_f32 v14, v60, v61, v14
    v_max3_f32 v14, v62, v63, v14
    v_mfma_f32_32x32x16_bf16 v[48:63], a[140:143], v[116:119], 0
    s_nop 11
    v_max3_f32 v14, v48, v49, v14
    v_max3_f32 v14, v50, v51, v14
    v_max3_f32 v14, v52, v53, v14
    v_max3_f32 v14, v54, v55, v14
    v_max3_f32 v14, v56, v57, v14
    v_max3_f32 v14, v58, v59, v14
    v_max3_f32 v14, v60, v61, v14
    v_max3_f32 v14, v62, v63, v14
    s_cmp_lt_u32 s54, 2
    s_cbranch_scc1 L_fb10
    v_mfma_f32_32x32x16_bf16 v[48:63], a[144:147], v[116:119], 0
    s_nop 11
    v_max3_f32 v14, v48, v49, v14
    v_max3_f32 v14, v50, v51, v14
    v_max3_f32 v14, v52, v53, v14
    v_max3_f32 v14, v54, v55, v14
    v_max3_f32 v14, v56, v57, v14
    v_max3_f32 v14, v58, v59, v14
    v_max3_f32 v14, v60, v61, v14
    v_max3_f32 v14, v62, v63, v14
    v_mfma_f32_32x32x16_bf16 v[48:63], a[148:151], v[116:119], 0
    s_nop 11
    v_max3_f32 v14, v48, v49, v14
    v_max3_f32 v14, v50, v51, v14
    v_max3_f32 v14, v52, v53, v14
    v_max3_f32 v14, v54, v55, v14
    v_max3_f32 v14, v56, v57, v14
    v_max3_f32 v14, v58, v59, v14
    v_max3_f32 v14, v60, v61, v14
    v_max3_f32 v14, v62, v63, v14
    s_cmp_lt_u32 s54, 3
    s_cbranch_scc1 L_fb10
    v_mfma_f32_32x32x16_bf16 v[48:63], a[152:155], v[116:119], 0
    s_nop 11
    v_max3_f32 v14, v48, v49, v14
    v_max3_f32 v14, v50, v51, v14
    v_max3_f32 v14, v52, v53, v14
    v_max3_f32 v14, v54, v55, v14
    v_max3_f32 v14, v56, v57, v14
    v_max3_f32 v14, v58, v59, v14
    v_max3_f32 v14, v60, v61, v14
    v_max3_f32 v14, v62, v63, v14
    v_mfma_f32_32x32x16_bf16 v[48:63], a[156:159], v[116:119], 0
    s_nop 11
    v_max3_f32 v14, v48, v49, v14
    v_max3_f32 v14, v50, v51, v14
    v_max3_f32 v14, v52, v53, v14
    v_max3_f32 v14, v54, v55, v14
    v_max3_f32 v14, v56, v57, v14
    v_max3_f32 v14, v58, v59, v14
    v_max3_f32 v14, v60, v61, v14
    v_max3_f32 v14, v62, v63, v14
    s_cmp_lt_u32 s54, 4
    s_cbranch_scc1 L_fb10
    v_mfma_f32_32x32x16_bf16 v[48:63], a[160:163], v[116:119], v[144:159]
    s_nop 11
    v_max3_f32 v14, v48, v49, v14
    v_max3_f32 v14, v50, v51, v14
    v_max3_f32 v14, v52, v53, v14
    v_max3_f32 v14, v54, v55, v14
    v_max3_f32 v14, v56, v57, v14
    v_max3_f32 v14, v58, v59, v14
    v_max3_f32 v14, v60, v61, v14
    v_max3_f32 v14, v62, v63, v14
L_fb10:
    v_mov_b32 v15, v14
    s_nop 1
    v_permlane32_swap_b32 v15, v14
    v_max_f32 v14, v15, v14
    v_sub_f32 v64, v128, v14
    v_sub_f32 v65, v129, v14
    v_sub_f32 v66, v130, v14
    v_sub_f32 v67, v131, v14
    v_sub_f32 v68, v132, v14
    v_sub_f32 v69, v133, v14
    v_sub_f32 v70, v134, v14
    v_sub_f32 v71, v135, v14
    v_sub_f32 v72, v136, v14
    v_sub_f32 v73, v137, v14
    v_sub_f32 v74, v138, v14
    v_sub_f32 v75, v139, v14
    v_sub_f32 v76, v140, v14
    v_sub_f32 v77, v141, v14
    v_sub_f32 v78, v142, v14
    v_sub_f32 v79, v143, v14
    s_nop 1
    v_mfma_f32_32x32x16_bf16 v[48:63], v[244:247], v[116:119], v[64:79]
    s_nop 11
    v_exp_f32 v48, v48
    v_exp_f32 v49, v49
    v_exp_f32 v50, v50
    v_exp_f32 v51, v51
    v_cvt_pk_bf16_f32 v32, v48, v49
    v_exp_f32 v52, v52
    v_exp_f32 v53, v53
    v_cvt_pk_bf16_f32 v33, v50, v51
    v_exp_f32 v54, v54
    v_exp_f32 v55, v55
    v_cvt_pk_bf16_f32 v34, v52, v53
    v_exp_f32 v56, v56
    v_exp_f32 v57, v57
    v_cvt_pk_bf16_f32 v35, v54, v55
    v_exp_f32 v58, v58
    v_exp_f32 v59, v59
    v_cvt_pk_bf16_f32 v36, v56, v57
    v_exp_f32 v60, v60
    v_exp_f32 v61, v61
    v_cvt_pk_bf16_f32 v37, v58, v59
    v_exp_f32 v62, v62
    v_exp_f32 v63, v63
    v_cvt_pk_bf16_f32 v38, v60, v61
    v_cvt_pk_bf16_f32 v39, v62, v63
    v_mfma_f32_32x32x16_bf16 v[96:111], v[160:163], v[32:35], 0
    s_nop 0
    v_mfma_f32_32x32x16_bf16 v[96:111], v[164:167], v[36:39], v[96:111]
    v_sub_f32 v64, 0, v14
    v_sub_f32 v65, 0, v14
    v_sub_f32 v66, 0, v14
    v_sub_f32 v67, 0, v14
    v_sub_f32 v68, 0, v14
    v_sub_f32 v69, 0, v14
    v_sub_f32 v70, 0, v14
    v_sub_f32 v71, 0, v14
    v_sub_f32 v72, 0, v14
    v_sub_f32 v73, 0, v14
    v_sub_f32 v74, 0, v14
    v_sub_f32 v75, 0, v14
    v_sub_f32 v76, 0, v14
    v_sub_f32 v77, 0, v14
    v_sub_f32 v78, 0, v14
    v_sub_f32 v79, 0, v14
    s_nop 1
    v_mfma_f32_32x32x16_bf16 v[48:63], v[240:243], v[116:119], v[64:79]
    s_nop 11
    v_exp_f32 v48, v48
    v_exp_f32 v49, v49
    v_exp_f32 v50, v50
    v_exp_f32 v51, v51
    v_cvt_pk_bf16_f32 v32, v48, v49
    v_exp_f32 v52, v52
    v_exp_f32 v53, v53
    v_cvt_pk_bf16_f32 v33, v50, v51
    v_exp_f32 v54, v54
    v_exp_f32 v55, v55
    v_cvt_pk_bf16_f32 v34, v52, v53
    v_exp_f32 v56, v56
    v_exp_f32 v57, v57
    v_cvt_pk_bf16_f32 v35, v54, v55
    v_exp_f32 v58, v58
    v_exp_f32 v59, v59
    v_cvt_pk_bf16_f32 v36, v56, v57
    v_exp_f32 v60, v60
    v_exp_f32 v61, v61
    v_cvt_pk_bf16_f32 v37, v58, v59
    v_exp_f32 v62, v62
    v_exp_f32 v63, v63
    v_cvt_pk_bf16_f32 v38, v60, v61
    v_cvt_pk_bf16_f32 v39, v62, v63
    v_mfma_f32_32x32x16_bf16 v[96:111], v[168:171], v[32:35], v[96:111]
    s_nop 0
    v_mfma_f32_32x32x16_bf16 v[96:111], v[172:175], v[36:39], v[96:111]
    s_cmp_lt_u32 s54, 1
    s_cbranch_scc1 L_fb11
    v_sub_f32 v64, 0, v14
    v_sub_f32 v65, 0, v14
    v_sub_f32 v66, 0, v14
    v_sub_f32 v67, 0, v14
    v_sub_f32 v68, 0, v14
    v_sub_f32 v69, 0, v14
    v_sub_f32 v70, 0, v14
    v_sub_f32 v71, 0, v14
    v_sub_f32 v72, 0, v14
    v_sub_f32 v73, 0, v14
    v_sub_f32 v74, 0, v14
    v_sub_f32 v75, 0, v14
    v_sub_f32 v76, 0, v14
    v_sub_f32 v77, 0, v14
    v_sub_f32 v78, 0, v14
    v_sub_f32 v79, 0, v14
    s_nop 1
    v_mfma_f32_32x32x16_bf16 v[48:63], a[136:139], v[116:119], v[64:79]
    s_nop 11
    v_exp_f32 v48, v48
    v_exp_f32 v49, v49
    v_exp_f32 v50, v50
    v_exp_f32 v51, v51
    v_cvt_pk_bf16_f32 v32, v48, v49
    v_exp_f32 v52, v52
    v_exp_f32 v53, v53
    v_cvt_pk_bf16_f32 v33, v50, v51
    v_exp_f32 v54, v54
    v_exp_f32 v55, v55
    v_cvt_pk_bf16_f32 v34, v52, v53
    v_exp_f32 v56, v56
    v_exp_f32 v57, v57
    v_cvt_pk_bf16_f32 v35, v54, v55
    v_exp_f32 v58, v58
    v_exp_f32 v59, v59
    v_cvt_pk_bf16_f32 v36, v56, v57
    v_exp_f32 v60, v60
    v_exp_f32 v61, v61
    v_cvt_pk_bf16_f32 v37, v58, v59
    v_exp_f32 v62, v62
    v_exp_f32 v63, v63
    v_cvt_pk_bf16_f32 v38, v60, v61
    v_cvt_pk_bf16_f32 v39, v62, v63
    v_mfma_f32_32x32x16_bf16 v[96:111], v[176:179], v[32:35], v[96:111]
    s_nop 0
    v_mfma_f32_32x32x16_bf16 v[96:111], v[180:183], v[36:39], v[96:111]
    v_sub_f32 v64, 0, v14
    v_sub_f32 v65, 0, v14
    v_sub_f32 v66, 0, v14
    v_sub_f32 v67, 0, v14
    v_sub_f32 v68, 0, v14
    v_sub_f32 v69, 0, v14
    v_sub_f32 v70, 0, v14
    v_sub_f32 v71, 0, v14
    v_sub_f32 v72, 0, v14
    v_sub_f32 v73, 0, v14
    v_sub_f32 v74, 0, v14
    v_sub_f32 v75, 0, v14
    v_sub_f32 v76, 0, v14
    v_sub_f32 v77, 0, v14
    v_sub_f32 v78, 0, v14
    v_sub_f32 v79, 0, v14
    s_nop 1
    v_mfma_f32_32x32x16_bf16 v[48:63], a[140:143], v[116:119], v[64:79]
    s_nop 11
    v_exp_f32 v48, v48
    v_exp_f32 v49, v49
    v_exp_f32 v50, v50
    v_exp_f32 v51, v51
    v_cvt_pk_bf16_f32 v32, v48, v49
    v_exp_f32 v52, v52
    v_exp_f32 v53, v53
    v_cvt_pk_bf16_f32 v33, v50, v51
    v_exp_f32 v54, v54
    v_exp_f32 v55, v55
    v_cvt_pk_bf16_f32 v34, v52, v53
    v_exp_f32 v56, v56
    v_exp_f32 v57, v57
    v_cvt_pk_bf16_f32 v35, v54, v55
    v_exp_f32 v58, v58
    v_exp_f32 v59, v59
    v_cvt_pk_bf16_f32 v36, v56, v57
    v_exp_f32 v60, v60
    v_exp_f32 v61, v61
    v_cvt_pk_bf16_f32 v37, v58, v59
    v_exp_f32 v62, v62
    v_exp_f32 v63, v63
    v_cvt_pk_bf16_f32 v38, v60, v61
    v_cvt_pk_bf16_f32 v39, v62, v63
    v_mfma_f32_32x32x16_bf16 v[96:111], v[184:187], v[32:35], v[96:111]
    s_nop 0
    v_mfma_f32_32x32x16_bf16 v[96:111], v[188:191], v[36:39], v[96:111]
    s_cmp_lt_u32 s54, 2
    s_cbranch_scc1 L_fb11
    v_sub_f32 v64, 0, v14
    v_sub_f32 v65, 0, v14
    v_sub_f32 v66, 0, v14
    v_sub_f32 v67, 0, v14
    v_sub_f32 v68, 0, v14
    v_sub_f32 v69, 0, v14
    v_sub_f32 v70, 0, v14
    v_sub_f32 v71, 0, v14
    v_sub_f32 v72, 0, v14
    v_sub_f32 v73, 0, v14
    v_sub_f32 v74, 0, v14
    v_sub_f32 v75, 0, v14
    v_sub_f32 v76, 0, v14
    v_sub_f32 v77, 0, v14
    v_sub_f32 v78, 0, v14
    v_sub_f32 v79, 0, v14
    s_nop 1
    v_mfma_f32_32x32x16_bf16 v[48:63], a[144:147], v[116:119], v[64:79]
    s_nop 11
    v_exp_f32 v48, v48
    v_exp_f32 v49, v49
    v_exp_f32 v50, v50
    v_exp_f32 v51, v51
    v_cvt_pk_bf16_f32 v32, v48, v49
    v_exp_f32 v52, v52
    v_exp_f32 v53, v53
    v_cvt_pk_bf16_f32 v33, v50, v51
    v_exp_f32 v54, v54
    v_exp_f32 v55, v55
    v_cvt_pk_bf16_f32 v34, v52, v53
    v_exp_f32 v56, v56
    v_exp_f32 v57, v57
    v_cvt_pk_bf16_f32 v35, v54, v55
    v_exp_f32 v58, v58
    v_exp_f32 v59, v59
    v_cvt_pk_bf16_f32 v36, v56, v57
    v_exp_f32 v60, v60
    v_exp_f32 v61, v61
    v_cvt_pk_bf16_f32 v37, v58, v59
    v_exp_f32 v62, v62
    v_exp_f32 v63, v63
    v_cvt_pk_bf16_f32 v38, v60, v61
    v_cvt_pk_bf16_f32 v39, v62, v63
    v_mfma_f32_32x32x16_bf16 v[96:111], v[192:195], v[32:35], v[96:111]
    s_nop 0
    v_mfma_f32_32x32x16_bf16 v[96:111], v[196:199], v[36:39], v[96:111]
    v_sub_f32 v64, 0, v14
    v_sub_f32 v65, 0, v14
    v_sub_f32 v66, 0, v14
    v_sub_f32 v67, 0, v14
    v_sub_f32 v68, 0, v14
    v_sub_f32 v69, 0, v14
    v_sub_f32 v70, 0, v14
    v_sub_f32 v71, 0, v14
    v_sub_f32 v72, 0, v14
    v_sub_f32 v73, 0, v14
    v_sub_f32 v74, 0, v14
    v_sub_f32 v75, 0, v14
    v_sub_f32 v76, 0, v14
    v_sub_f32 v77, 0, v14
    v_sub_f32 v78, 0, v14
    v_sub_f32 v79, 0, v14
    s_nop 1
    v_mfma_f32_32x32x16_bf16 v[48:63], a[148:151], v[116:119], v[64:79]
    s_nop 11
    v_exp_f32 v48, v48
    v_exp_f32 v49, v49
    v_exp_f32 v50, v50
    v_exp_f32 v51, v51
    v_cvt_pk_bf16_f32 v32, v48, v49
    v_exp_f32 v52, v52
    v_exp_f32 v53, v53
    v_cvt_pk_bf16_f32 v33, v50, v51
    v_exp_f32 v54, v54
    v_exp_f32 v55, v55
    v_cvt_pk_bf16_f32 v34, v52, v53
    v_exp_f32 v56, v56
    v_exp_f32 v57, v57
    v_cvt_pk_bf16_f32 v35, v54, v55
    v_exp_f32 v58, v58
    v_exp_f32 v59, v59
    v_cvt_pk_bf16_f32 v36, v56, v57
    v_exp_f32 v60, v60
    v_exp_f32 v61, v61
    v_cvt_pk_bf16_f32 v37, v58, v59
    v_exp_f32 v62, v62
    v_exp_f32 v63, v63
    v_cvt_pk_bf16_f32 v38, v60, v61
    v_cvt_pk_bf16_f32 v39, v62, v63
    v_mfma_f32_32x32x16_bf16 v[96:111], v[200:203], v[32:35], v[96:111]
    s_nop 0
    v_mfma_f32_32x32x16_bf16 v[96:111], v[204:207], v[36:39], v[96:111]
    s_cmp_lt_u32 s54, 3
    s_cbranch_scc1 L_fb11
    v_sub_f32 v64, 0, v14
    v_sub_f32 v65, 0, v14
    v_sub_f32 v66, 0, v14
    v_sub_f32 v67, 0, v14
    v_sub_f32 v68, 0, v14
    v_sub_f32 v69, 0, v14
    v_sub_f32 v70, 0, v14
    v_sub_f32 v71, 0, v14
    v_sub_f32 v72, 0, v14
    v_sub_f32 v73, 0, v14
    v_sub_f32 v74, 0, v14
    v_sub_f32 v75, 0, v14
    v_sub_f32 v76, 0, v14
    v_sub_f32 v77, 0, v14
    v_sub_f32 v78, 0, v14
    v_sub_f32 v79, 0, v14
    s_nop 1
    v_mfma_f32_32x32x16_bf16 v[48:63], a[152:155], v[116:119], v[64:79]
    s_nop 11
    v_exp_f32 v48, v48
    v_exp_f32 v49, v49
    v_exp_f32 v50, v50
    v_exp_f32 v51, v51
    v_cvt_pk_bf16_f32 v32, v48, v49
    v_exp_f32 v52, v52
    v_exp_f32 v53, v53
    v_cvt_pk_bf16_f32 v33, v50, v51
    v_exp_f32 v54, v54
    v_exp_f32 v55, v55
    v_cvt_pk_bf16_f32 v34, v52, v53
    v_exp_f32 v56, v56
    v_exp_f32 v57, v57
    v_cvt_pk_bf16_f32 v35, v54, v55
    v_exp_f32 v58, v58
    v_exp_f32 v59, v59
    v_cvt_pk_bf16_f32 v36, v56, v57
    v_exp_f32 v60, v60
    v_exp_f32 v61, v61
    v_cvt_pk_bf16_f32 v37, v58, v59
    v_exp_f32 v62, v62
    v_exp_f32 v63, v63
    v_cvt_pk_bf16_f32 v38, v60, v61
    v_cvt_pk_bf16_f32 v39, v62, v63
    v_mfma_f32_32x32x16_bf16 v[96:111], v[208:211], v[32:35], v[96:111]
    s_nop 0
    v_mfma_f32_32x32x16_bf16 v[96:111], v[212:215], v[36:39], v[96:111]
    v_sub_f32 v64, 0, v14
    v_sub_f32 v65, 0, v14
    v_sub_f32 v66, 0, v14
    v_sub_f32 v67, 0, v14
    v_sub_f32 v68, 0, v14
    v_sub_f32 v69, 0, v14
    v_sub_f32 v70, 0, v14
    v_sub_f32 v71, 0, v14
    v_sub_f32 v72, 0, v14
    v_sub_f32 v73, 0, v14
    v_sub_f32 v74, 0, v14
    v_sub_f32 v75, 0, v14
    v_sub_f32 v76, 0, v14
    v_sub_f32 v77, 0, v14
    v_sub_f32 v78, 0, v14
    v_sub_f32 v79, 0, v14
    s_nop 1
    v_mfma_f32_32x32x16_bf16 v[48:63], a[156:159], v[116:119], v[64:79]
    s_nop 11
    v_exp_f32 v48, v48
    v_exp_f32 v49, v49
    v_exp_f32 v50, v50
    v_exp_f32 v51, v51
    v_cvt_pk_bf16_f32 v32, v48, v49
    v_exp_f32 v52, v52
    v_exp_f32 v53, v53
    v_cvt_pk_bf16_f32 v33, v50, v51
    v_exp_f32 v54, v54
    v_exp_f32 v55, v55
    v_cvt_pk_bf16_f32 v34, v52, v53
    v_exp_f32 v56, v56
    v_exp_f32 v57, v57
    v_cvt_pk_bf16_f32 v35, v54, v55
    v_exp_f32 v58, v58
    v_exp_f32 v59, v59
    v_cvt_pk_bf16_f32 v36, v56, v57
    v_exp_f32 v60, v60
    v_exp_f32 v61, v61
    v_cvt_pk_bf16_f32 v37, v58, v59
    v_exp_f32 v62, v62
    v_exp_f32 v63, v63
    v_cvt_pk_bf16_f32 v38, v60, v61
    v_cvt_pk_bf16_f32 v39, v62, v63
    v_mfma_f32_32x32x16_bf16 v[96:111], v[216:219], v[32:35], v[96:111]
    s_nop 0
    v_mfma_f32_32x32x16_bf16 v[96:111], v[220:223], v[36:39], v[96:111]
    s_cmp_lt_u32 s54, 4
    s_cbranch_scc1 L_fb11
    v_sub_f32 v64, v144, v14
    v_sub_f32 v65, v145, v14
    v_sub_f32 v66, v146, v14
    v_sub_f32 v67, v147, v14
    v_sub_f32 v68, v148, v14
    v_sub_f32 v69, v149, v14
    v_sub_f32 v70, v150, v14
    v_sub_f32 v71, v151, v14
    v_sub_f32 v72, v152, v14
    v_sub_f32 v73, v153, v14
    v_sub_f32 v74, v154, v14
    v_sub_f32 v75, v155, v14
    v_sub_f32 v76, v156, v14
    v_sub_f32 v77, v157, v14
    v_sub_f32 v78, v158, v14
    v_sub_f32 v79, v159, v14
    s_nop 1
    v_mfma_f32_32x32x16_bf16 v[48:63], a[160:163], v[116:119], v[64:79]
    s_nop 11
    v_exp_f32 v48, v48
    v_exp_f32 v49, v49
    v_exp_f32 v50, v50
    v_exp_f32 v51, v51
    v_cvt_pk_bf16_f32 v32, v48, v49
    v_exp_f32 v52, v52
    v_exp_f32 v53, v53
    v_cvt_pk_bf16_f32 v33, v50, v51
    v_exp_f32 v54, v54
    v_exp_f32 v55, v55
    v_cvt_pk_bf16_f32 v34, v52, v53
    v_exp_f32 v56, v56
    v_exp_f32 v57, v57
    v_cvt_pk_bf16_f32 v35, v54, v55
    v_exp_f32 v58, v58
    v_exp_f32 v59, v59
    v_cvt_pk_bf16_f32 v36, v56, v57
    v_exp_f32 v60, v60
    v_exp_f32 v61, v61
    v_cvt_pk_bf16_f32 v37, v58, v59
    v_exp_f32 v62, v62
    v_exp_f32 v63, v63
    v_cvt_pk_bf16_f32 v38, v60, v61
    v_cvt_pk_bf16_f32 v39, v62, v63
    v_mfma_f32_32x32x16_bf16 v[96:111], v[224:227], v[32:35], v[96:111]
    s_nop 0
    v_mfma_f32_32x32x16_bf16 v[96:111], v[228:231], v[36:39], v[96:111]
L_fb11:
    s_branch L_fbd
.section .rodata,"a"
.p2align 6
.amdhsa_kernel sequential_preLN__sliding_block__glu_gated_reglu__prompt_kernel
  .amdhsa_next_free_vgpr 512
  .amdhsa_next_free_sgpr 102
  .amdhsa_accum_offset 256
  .amdhsa_group_segment_fixed_size 0
  .amdhsa_kernarg_size 80
  .amdhsa_user_sgpr_count 2
  .amdhsa_user_sgpr_kernarg_segment_ptr 1
  .amdhsa_system_sgpr_workgroup_id_x 1
  .amdhsa_float_denorm_mode_32 3
  .amdhsa_float_denorm_mode_16_64 3
.end_amdhsa_kernel
```
